```python
import torch

def _softmax(x, axis=-1):
    return torch.softmax(x, dim=axis)
def _gelu(x):
    return torch.nn.functional.gelu(x, approximate="tanh")
def _silu(x):
    return torch.nn.functional.silu(x)
def _sigmoid(x):
    return torch.sigmoid(x)
def _layernorm(x, axis=-1, eps=1e-5):
    m = x.mean(dim=axis, keepdim=True)
    v = x.var(dim=axis, keepdim=True, unbiased=False)
    return (x - m) / torch.sqrt(v + eps)
def _scatter_add(tgt, idx, src, axis=0):
    return tgt.clone().index_add_(axis, idx, src)
def _segment_sum(src, seg, n):
    out = torch.zeros((n,) + src.shape[1:], dtype=src.dtype)
    return out.index_add_(0, seg, src)
def _pad(x, pw):
    flat = tuple(v for pair in reversed(pw) for v in pair)
    return torch.nn.functional.pad(x, flat)

kernel_name = 'gated_mix__mha_block__dense_activation_squared_relu__prompt'

def setup_inputs():

    _w = (lambda a: (lambda t: t.to(torch.bfloat16) if t.is_floating_point() else t)(torch.as_tensor(a)))
    def _A_setup():
        B, S, D, H = 1, 2048, 512, 32
        return {
            "x": _w((lambda *s: torch.randn(*s, dtype=torch.bfloat16) * 0.05)(B, S, D)),
            "wqkv": _w((lambda *s: torch.randn(*s, dtype=torch.bfloat16) * 0.8)(D, 3 * D)),
            "wo": _w((lambda *s: torch.randn(*s, dtype=torch.bfloat16) * 0.1)(D, D)),
        }
    _A_in = _A_setup()

    def _B_setup():
        B, S, D, F = 1, 2048, 512, 1792
        return {
            "x": _w((lambda *s: torch.randn(*s, dtype=torch.bfloat16) * 0.05)(B, S, D)),
            "w1": _w((lambda *s: torch.randn(*s, dtype=torch.bfloat16) * 0.1)(D, F)),
            "b1": _w((lambda *s: torch.randn(*s, dtype=torch.bfloat16) * 0.05)(F)),
            "w2": _w((lambda *s: torch.randn(*s, dtype=torch.bfloat16) * 0.05)(F, D)),
            "b2": _w((lambda *s: torch.randn(*s, dtype=torch.bfloat16) * 0.05)(D)),
        }
    _B_in = _B_setup()

    return {
        "A_x": _A_in["x"],
        "A_wqkv": _A_in["wqkv"],
        "A_wo": _A_in["wo"],
        "B_x": _B_in["x"],
        "B_w1": _B_in["w1"],
        "B_b1": _B_in["b1"],
        "B_w2": _B_in["w2"],
        "B_b2": _B_in["b2"],
        "gate_w": _w((lambda *s: torch.randn(*s, dtype=torch.bfloat16) * 0.05)(512) * 16.0),
    }

def reference(A_x, A_wqkv, A_wo, B_x, B_w1, B_b1, B_w2, B_b2, gate_w):
    def _A_ref(x, wqkv, wo):
        B, S, D = x.shape
        H = 32
        Dh = D // H
        qkv = (lambda x, *d: x.permute(*d))((x @ wqkv).reshape(B, S, 3, H, Dh), 2, 0, 3, 1, 4)
        q, k, v = qkv[0], qkv[1], qkv[2]
        scores = torch.einsum("bhqd,bhkd->bhqk", q, k) * (Dh ** -0.5)
        p = _softmax(scores, axis=-1)
        o = torch.einsum("bhqk,bhkd->bhqd", p, v)
        return (lambda x, *d: x.permute(*d))(o, 0, 2, 1, 3).reshape(B, S, D) @ wo

    def _B_ref(x, w1, b1, w2, b2):
        h = torch.einsum("bsd,df->bsf", x, w1) + b1
        zero = torch.zeros_like(h)
        r = torch.where(h > zero, h, zero)
        h = r * r
        out = torch.einsum("bsf,fd->bsd", h, w2) + b2
        return out

    x = A_x
    g = _sigmoid((x * gate_w).sum(-1, keepdims=True))
    a = _A_ref(x, A_wqkv, A_wo)
    b = _B_ref(x, B_w1, B_b1, B_w2, B_b2)
    return g * a + (1 - g) * b
```

```asm
; @launch grid=(256,1,1) block=(512,1,1) lds=163840
.amdgcn_target "amdgcn-amd-amdhsa--gfx950"
.text
.globl gated_mix__mha_block__dense_activation_squared_relu__prompt_kernel
.type gated_mix__mha_block__dense_activation_squared_relu__prompt_kernel,@function
.p2align 12
gated_mix__mha_block__dense_activation_squared_relu__prompt_kernel:
    s_cmp_ge_u32 s2, 256
    s_cbranch_scc1 k_exit
    s_load_dwordx16 s[40:55], s[0:1], 0
    s_load_dwordx8 s[56:63], s[0:1], 64
    v_and_b32 v1, 63, v0
    v_lshrrev_b32 v2, 6, v0
    s_and_b32 s28, s2, 7
    s_lshl_b32 s28, s28, 2
    s_lshr_b32 s28, 0x73625140, s28
    s_and_b32 s28, s28, 7
    v_readfirstlane_b32 s30, v2
    s_lshr_b32 s29, s2, 3
    s_getpc_b64 s[98:99]
k_gpc:
    s_sub_u32 s98, s98, k_gpc - gated_mix__mha_block__dense_activation_squared_relu__prompt_kernel
    s_subb_u32 s99, s99, 0
    s_lshl_b32 s20, s29, 7
    v_lshl_add_u32 v23, v0, 7, s20
    v_min_u32 v23, k_exit - gated_mix__mha_block__dense_activation_squared_relu__prompt_kernel, v23
    s_mov_b32 exec_lo, 1
    s_mov_b32 exec_hi, 1
    global_load_dword v23, v23, s[98:99]
    s_mov_b64 exec, -1
    v_lshlrev_b32 v3, 4, v1
    s_and_b32 s20, s28, 1
    s_lshl_b32 s20, s20, 3
    s_and_b32 s21, s29, 7
    s_add_u32 s31, s20, s21
    s_lshr_b32 s20, s28, 1
    s_lshl_b32 s20, s20, 2
    s_lshr_b32 s22, s29, 3
    s_add_u32 s32, s20, s22
    s_lshl_b32 s22, s22, 1
    s_add_u32 s33, s21, s22
    s_and_b32 s33, s33, 7
    s_cmp_ge_u32 s30, 4
    s_cbranch_scc1 k_g
    v_lshrrev_b32 v8, 3, v1
    v_lshrrev_b32 v5, 1, v8
    s_and_b32 s20, s30, 1
    s_lshl_b32 s20, s20, 2
    v_add_u32 v5, s20, v5
    v_and_b32 v6, 7, v1
    v_xor_b32 v5, v5, v6
    v_lshlrev_b32 v5, 4, v5
    v_lshl_add_u32 v4, v8, 10, v5
    v_lshrrev_b32 v8, 2, v1
    v_and_b32 v9, 3, v1
    v_lshlrev_b32 v9, 4, v9
    v_mul_u32_u24 v5, 3072, v8
    v_add_u32 v5, v5, v9
    v_mul_u32_u24 v85, 3584, v8
    v_add_u32 v85, v85, v9
    s_lshl_b32 s34, s31, 17
    s_lshl_b32 s20, s30, 13
    s_add_u32 s34, s34, s20
    s_mul_i32 s35, s30, 49152
    s_xor_b32 s20, s32, 2
    s_lshl_b32 s20, s20, 6
    s_add_u32 s37, s35, s20
    s_lshr_b32 s20, s32, 1
    s_lshl_b32 s20, s20, 7
    s_add_u32 s35, s35, s20
    s_and_b32 s20, s32, 1
    s_add_u32 s20, s20, 1
    s_lshl_b32 s20, s20, 10
    s_add_u32 s35, s35, s20
    s_lshl_b32 s38, s30, 10
    v_mov_b32 v9, 0
    v_mov_b32 v11, 143360
    v_mov_b32 v12, 1
    s_waitcnt lgkmcnt(0)
    s_mov_b32 s4, s40
    s_and_b32 s5, s41, 0xffff
    s_mov_b32 s6, 2097152
    s_mov_b32 s7, 0x00020000
    s_mov_b32 s8, s42
    s_and_b32 s9, s43, 0xffff
    s_mov_b32 s10, 1572864
    s_mov_b32 s11, 0x00020000
    s_add_u32 s21, s33, 0
    s_and_b32 s21, s21, 7
    s_lshl_b32 s22, s21, 7
    s_add_u32 s22, s22, s34
    s_mul_i32 s23, s21, 196608
    s_add_u32 m0, s38, 0
    s_add_u32 s20, s22, 0
    buffer_load_dwordx4 v4, s[4:7], s20 offen lds
    s_add_u32 m0, s38, 16384
    s_add_u32 s20, s23, s35
    buffer_load_dwordx4 v5, s[8:11], s20 offen lds
    s_add_u32 m0, s38, 20416
    s_add_u32 s20, s23, s35
    buffer_load_dwordx4 v5, s[8:11], s20 offen offset:64 lds
    s_add_u32 m0, s38, 4096
    s_add_u32 s20, s22, 32768
    buffer_load_dwordx4 v4, s[4:7], s20 offen lds
    s_add_u32 m0, s38, 8192
    s_add_u32 s20, s22, 65536
    buffer_load_dwordx4 v4, s[4:7], s20 offen lds
    s_add_u32 m0, s38, 24576
    s_add_u32 s20, s23, s37
    buffer_load_dwordx4 v5, s[8:11], s20 offen lds
    s_add_u32 m0, s38, 12288
    s_add_u32 s20, s22, 98304
    buffer_load_dwordx4 v4, s[4:7], s20 offen lds
    s_add_u32 s21, s33, 1
    s_and_b32 s21, s21, 7
    s_lshl_b32 s22, s21, 7
    s_add_u32 s22, s22, s34
    s_mul_i32 s23, s21, 196608
    s_add_u32 m0, s38, 28672
    s_add_u32 s20, s22, 0
    buffer_load_dwordx4 v4, s[4:7], s20 offen lds
    s_add_u32 m0, s38, 45056
    s_add_u32 s20, s23, s35
    buffer_load_dwordx4 v5, s[8:11], s20 offen lds
    s_add_u32 m0, s38, 49088
    s_add_u32 s20, s23, s35
    buffer_load_dwordx4 v5, s[8:11], s20 offen offset:64 lds
    s_add_u32 m0, s38, 32768
    s_add_u32 s20, s22, 32768
    buffer_load_dwordx4 v4, s[4:7], s20 offen lds
    s_add_u32 m0, s38, 36864
    s_add_u32 s20, s22, 65536
    buffer_load_dwordx4 v4, s[4:7], s20 offen lds
    s_add_u32 m0, s38, 53248
    s_add_u32 s20, s23, s37
    buffer_load_dwordx4 v5, s[8:11], s20 offen lds
    s_add_u32 m0, s38, 40960
    s_add_u32 s20, s22, 98304
    buffer_load_dwordx4 v4, s[4:7], s20 offen lds
    s_cmp_ge_u32 s32, 8
    s_cbranch_scc1 a_short
    s_waitcnt vmcnt(7)
    s_barrier
    s_add_u32 s21, s33, 2
    s_and_b32 s21, s21, 7
    s_lshl_b32 s22, s21, 7
    s_add_u32 s22, s22, s34
    s_mul_i32 s23, s21, 196608
    s_add_u32 m0, s38, 57344
    s_add_u32 s20, s22, 0
    buffer_load_dwordx4 v4, s[4:7], s20 offen lds
    s_add_u32 m0, s38, 73728
    s_add_u32 s20, s23, s35
    buffer_load_dwordx4 v5, s[8:11], s20 offen lds
    s_add_u32 m0, s38, 77760
    s_add_u32 s20, s23, s35
    buffer_load_dwordx4 v5, s[8:11], s20 offen offset:64 lds
    s_add_u32 m0, s38, 61440
    s_add_u32 s20, s22, 32768
    buffer_load_dwordx4 v4, s[4:7], s20 offen lds
    s_add_u32 m0, s38, 65536
    s_add_u32 s20, s22, 65536
    buffer_load_dwordx4 v4, s[4:7], s20 offen lds
    s_add_u32 m0, s38, 81920
    s_add_u32 s20, s23, s37
    buffer_load_dwordx4 v5, s[8:11], s20 offen lds
    s_add_u32 m0, s38, 69632
    s_add_u32 s20, s22, 98304
    buffer_load_dwordx4 v4, s[4:7], s20 offen lds
    s_mov_b32 s96, s56
    s_and_b32 s97, s57, 0xffff
    s_mov_b32 s98, 1024
    s_mov_b32 s99, 0x00020000
    s_cmp_lt_u32 s32, 4
    s_cselect_b32 s98, 1024, 0
    s_lshl_b32 s20, s30, 1
    s_add_u32 s20, s20, s33
    s_lshl_b32 s20, s20, 7
    v_lshl_add_u32 v13, v1, 2, s20
    v_and_b32 v13, 0x3ff, v13
    s_lshl_b32 s20, s32, 12
    s_add_u32 s20, s20, s38
    v_add_u32 v14, s20, v3
    v_add_u32 v15, 86016, v14
    s_cmp_ge_u32 s32, 4
    s_cbranch_scc1 a_ng0
    ds_read_b128 v[16:19], v14 offset:0
    s_waitcnt lgkmcnt(0)
a_ng0:
    s_waitcnt vmcnt(7)
    s_barrier
    s_add_u32 s21, s33, 3
    s_and_b32 s21, s21, 7
    s_lshl_b32 s22, s21, 7
    s_add_u32 s22, s22, s34
    s_mul_i32 s23, s21, 196608
    s_add_u32 m0, s38, 86016
    s_add_u32 s20, s22, 0
    buffer_load_dwordx4 v4, s[4:7], s20 offen lds
    s_add_u32 m0, s38, 102400
    s_add_u32 s20, s23, s35
    buffer_load_dwordx4 v5, s[8:11], s20 offen lds
    s_add_u32 m0, s38, 106432
    s_add_u32 s20, s23, s35
    buffer_load_dwordx4 v5, s[8:11], s20 offen offset:64 lds
    s_add_u32 m0, s38, 90112
    s_add_u32 s20, s22, 32768
    buffer_load_dwordx4 v4, s[4:7], s20 offen lds
    s_add_u32 m0, s38, 94208
    s_add_u32 s20, s22, 65536
    buffer_load_dwordx4 v4, s[4:7], s20 offen lds
    s_add_u32 m0, s38, 110592
    s_add_u32 s20, s23, s37
    buffer_load_dwordx4 v5, s[8:11], s20 offen lds
    s_add_u32 m0, s38, 98304
    s_add_u32 s20, s22, 98304
    buffer_load_dwordx4 v4, s[4:7], s20 offen lds
    s_add_u32 s21, s33, 4
    s_and_b32 s21, s21, 7
    s_lshl_b32 s22, s21, 7
    s_add_u32 s22, s22, s34
    s_mul_i32 s23, s21, 196608
    s_add_u32 m0, s38, 114688
    s_add_u32 s20, s22, 0
    buffer_load_dwordx4 v4, s[4:7], s20 offen lds
    s_add_u32 m0, s38, 131072
    s_add_u32 s20, s23, s35
    buffer_load_dwordx4 v5, s[8:11], s20 offen lds
    s_add_u32 m0, s38, 135104
    s_add_u32 s20, s23, s35
    buffer_load_dwordx4 v5, s[8:11], s20 offen offset:64 lds
    s_add_u32 m0, s38, 118784
    s_add_u32 s20, s22, 32768
    buffer_load_dwordx4 v4, s[4:7], s20 offen lds
    s_add_u32 m0, s38, 122880
    s_add_u32 s20, s22, 65536
    buffer_load_dwordx4 v4, s[4:7], s20 offen lds
    s_add_u32 m0, s38, 139264
    s_add_u32 s20, s23, s37
    buffer_load_dwordx4 v5, s[8:11], s20 offen lds
    s_add_u32 m0, s38, 126976
    s_add_u32 s20, s22, 98304
    buffer_load_dwordx4 v4, s[4:7], s20 offen lds
    s_cmp_ge_u32 s32, 4
    s_cbranch_scc1 a_ng1
    ds_read_b128 v[20:23], v14 offset:28672
    s_waitcnt lgkmcnt(0)
a_ng1:
    s_waitcnt vmcnt(14)
    s_barrier
    s_add_u32 s21, s33, 5
    s_and_b32 s21, s21, 7
    s_lshl_b32 s22, s21, 7
    s_add_u32 s22, s22, s34
    s_mul_i32 s23, s21, 196608
    s_add_u32 m0, s38, 0
    s_add_u32 s20, s22, 0
    buffer_load_dwordx4 v4, s[4:7], s20 offen lds
    s_add_u32 m0, s38, 16384
    s_add_u32 s20, s23, s35
    buffer_load_dwordx4 v5, s[8:11], s20 offen lds
    s_add_u32 m0, s38, 20416
    s_add_u32 s20, s23, s35
    buffer_load_dwordx4 v5, s[8:11], s20 offen offset:64 lds
    s_add_u32 m0, s38, 4096
    s_add_u32 s20, s22, 32768
    buffer_load_dwordx4 v4, s[4:7], s20 offen lds
    s_add_u32 m0, s38, 8192
    s_add_u32 s20, s22, 65536
    buffer_load_dwordx4 v4, s[4:7], s20 offen lds
    s_add_u32 m0, s38, 24576
    s_add_u32 s20, s23, s37
    buffer_load_dwordx4 v5, s[8:11], s20 offen lds
    s_add_u32 m0, s38, 12288
    s_add_u32 s20, s22, 98304
    buffer_load_dwordx4 v4, s[4:7], s20 offen lds
    s_mov_b32 s12, s62
    s_and_b32 s13, s63, 0xffff
    s_mov_b32 s14, 59768832
    s_mov_b32 s15, 0x00020000
    s_mov_b32 s3, 0
    s_mov_b32 s16, s48
    s_and_b32 s17, s49, 0xffff
    s_mov_b32 s18, 1835008
    s_mov_b32 s19, 0x00020000
    s_cmp_lt_u32 s32, 8
    s_cselect_b32 s20, s33, s32
    s_cselect_b32 s21, 1, 0
    s_and_b32 s20, s20, 1
    s_lshl_b32 s90, s20, s21
    s_lshl_b32 s20, s20, 1
    s_sub_u32 s91, 2, s20
    s_mul_i32 s20, s32, 3
    s_min_u32 s21, s32, 8
    s_add_u32 s20, s20, s21
    s_add_u32 s90, s90, s20
    s_add_u32 s91, s91, s20
    s_lshl_b32 s90, s90, 6
    s_lshl_b32 s91, s91, 6
    s_mov_b32 s80, s50
    s_and_b32 s81, s51, 0xffff
    s_mov_b32 s82, 3584
    s_mov_b32 s83, 0x00020000
    s_sub_u32 s20, s91, 128
    v_mov_b32 v10, s20
    v_mov_b32 v7, s90
    v_cmp_gt_u32 vcc, 32, v1
    v_cndmask_b32 v10, v10, v7, vcc
    v_lshl_add_u32 v10, v1, 2, v10
    s_mul_i32 s20, s30, 57344
    s_add_u32 s90, s90, s20
    s_add_u32 s91, s91, s20
    s_mov_b32 s87, s33
    s_mov_b32 s88, s38
    s_mov_b32 s89, s32
    s_cmp_ge_u32 s32, 4
    s_cbranch_scc1 a_ng2
    ds_read_b128 v[24:27], v14 offset:57344
    s_waitcnt lgkmcnt(0)
a_ng2:
    s_waitcnt vmcnt(14)
    s_barrier
    s_add_u32 s21, s33, 6
    s_and_b32 s21, s21, 7
    s_lshl_b32 s22, s21, 7
    s_add_u32 s22, s22, s34
    s_mul_i32 s23, s21, 196608
    s_add_u32 m0, s38, 28672
    s_add_u32 s20, s22, 0
    buffer_load_dwordx4 v4, s[4:7], s20 offen lds
    s_add_u32 m0, s38, 45056
    s_add_u32 s20, s23, s35
    buffer_load_dwordx4 v5, s[8:11], s20 offen lds
    s_add_u32 m0, s38, 49088
    s_add_u32 s20, s23, s35
    buffer_load_dwordx4 v5, s[8:11], s20 offen offset:64 lds
    s_add_u32 m0, s38, 32768
    s_add_u32 s20, s22, 32768
    buffer_load_dwordx4 v4, s[4:7], s20 offen lds
    s_add_u32 m0, s38, 36864
    s_add_u32 s20, s22, 65536
    buffer_load_dwordx4 v4, s[4:7], s20 offen lds
    s_add_u32 m0, s38, 53248
    s_add_u32 s20, s23, s37
    buffer_load_dwordx4 v5, s[8:11], s20 offen lds
    s_add_u32 m0, s38, 40960
    s_add_u32 s20, s22, 98304
    buffer_load_dwordx4 v4, s[4:7], s20 offen lds
    s_cmp_ge_u32 s32, 4
    s_cbranch_scc1 a_ng3
    ds_read_b128 v[28:31], v15 offset:0
    s_waitcnt lgkmcnt(0)
a_ng3:
    s_waitcnt vmcnt(14)
    s_barrier
    s_add_u32 s21, s33, 7
    s_and_b32 s21, s21, 7
    s_lshl_b32 s22, s21, 7
    s_add_u32 s22, s22, s34
    s_mul_i32 s23, s21, 196608
    s_add_u32 m0, s38, 57344
    s_add_u32 s20, s22, 0
    buffer_load_dwordx4 v4, s[4:7], s20 offen lds
    s_add_u32 m0, s38, 73728
    s_add_u32 s20, s23, s35
    buffer_load_dwordx4 v5, s[8:11], s20 offen lds
    s_add_u32 m0, s38, 77760
    s_add_u32 s20, s23, s35
    buffer_load_dwordx4 v5, s[8:11], s20 offen offset:64 lds
    s_add_u32 m0, s38, 61440
    s_add_u32 s20, s22, 32768
    buffer_load_dwordx4 v4, s[4:7], s20 offen lds
    s_add_u32 m0, s38, 65536
    s_add_u32 s20, s22, 65536
    buffer_load_dwordx4 v4, s[4:7], s20 offen lds
    s_add_u32 m0, s38, 81920
    s_add_u32 s20, s23, s37
    buffer_load_dwordx4 v5, s[8:11], s20 offen lds
    s_add_u32 m0, s38, 69632
    s_add_u32 s20, s22, 98304
    buffer_load_dwordx4 v4, s[4:7], s20 offen lds
    s_cmp_ge_u32 s32, 4
    s_cbranch_scc1 a_ng4
    ds_read_b128 v[32:35], v15 offset:28672
    s_waitcnt lgkmcnt(0)
a_ng4:
    s_waitcnt vmcnt(14)
    s_barrier
    s_lshr_b32 s20, s38, 1
    s_add_u32 m0, s20, 144640
    s_nop 0
    buffer_load_dword v13, s[96:99], 0 offen lds
    s_mov_b32 m0, 143616
    s_nop 0
    buffer_load_dword v10, s[80:83], 0 offen lds
    s_add_u32 s21, s87, 0
    s_and_b32 s21, s21, 7
    s_mul_i32 s23, s21, 229376
    s_add_u32 s23, s23, s90
    s_add_u32 m0, s88, 147456
    s_add_u32 s20, s23, 0
    buffer_load_dwordx4 v85, s[16:19], s20 offen lds
    s_add_u32 m0, s88, 151552
    s_add_u32 s20, s23, 64
    buffer_load_dwordx4 v85, s[16:19], s20 offen lds
    s_add_u32 s21, s21, 1
    s_and_b32 s21, s21, 7
    s_mul_i32 s23, s21, 229376
    s_add_u32 s23, s23, s90
    s_add_u32 m0, s88, 155648
    s_add_u32 s20, s23, 0
    buffer_load_dwordx4 v85, s[16:19], s20 offen lds
    s_add_u32 m0, s88, 159744
    s_add_u32 s20, s23, 64
    buffer_load_dwordx4 v85, s[16:19], s20 offen lds
    s_cmp_ge_u32 s32, 4
    s_cbranch_scc1 a_ng5
    ds_read_b128 v[36:39], v14 offset:0
    s_waitcnt lgkmcnt(0)
a_ng5:
    s_waitcnt vmcnt(13)
    s_barrier
    s_mov_b32 s80, s60
    s_and_b32 s81, s61, 0xffff
    s_mov_b32 s82, 256
    s_mov_b32 s83, 0x00020000
    buffer_load_dword v86, v9, s[80:83], 0 offen sc1
    s_add_u32 s21, s87, 2
    s_and_b32 s21, s21, 7
    s_mul_i32 s23, s21, 229376
    s_add_u32 s23, s23, s90
    s_add_u32 m0, s88, 86016
    s_add_u32 s20, s23, 0
    buffer_load_dwordx4 v85, s[16:19], s20 offen lds
    s_add_u32 m0, s88, 90112
    s_add_u32 s20, s23, 64
    buffer_load_dwordx4 v85, s[16:19], s20 offen lds
    s_add_u32 s21, s21, 1
    s_and_b32 s21, s21, 7
    s_mul_i32 s23, s21, 229376
    s_add_u32 s23, s23, s90
    s_add_u32 m0, s88, 94208
    s_add_u32 s20, s23, 0
    buffer_load_dwordx4 v85, s[16:19], s20 offen lds
    s_add_u32 m0, s88, 98304
    s_add_u32 s20, s23, 64
    buffer_load_dwordx4 v85, s[16:19], s20 offen lds
    s_cmp_ge_u32 s32, 4
    s_cbranch_scc1 a_ng6
    ds_read_b128 v[40:43], v14 offset:28672
    s_waitcnt lgkmcnt(0)
a_ng6:
    s_waitcnt vmcnt(11)
    s_barrier
    s_add_u32 s21, s87, 4
    s_and_b32 s21, s21, 7
    s_mul_i32 s23, s21, 229376
    s_add_u32 s23, s23, s90
    s_add_u32 m0, s88, 102400
    s_add_u32 s20, s23, 0
    buffer_load_dwordx4 v85, s[16:19], s20 offen lds
    s_add_u32 m0, s88, 106496
    s_add_u32 s20, s23, 64
    buffer_load_dwordx4 v85, s[16:19], s20 offen lds
    s_add_u32 s21, s21, 1
    s_and_b32 s21, s21, 7
    s_mul_i32 s23, s21, 229376
    s_add_u32 s23, s23, s90
    s_add_u32 m0, s88, 110592
    s_add_u32 s20, s23, 0
    buffer_load_dwordx4 v85, s[16:19], s20 offen lds
    s_add_u32 m0, s88, 114688
    s_add_u32 s20, s23, 64
    buffer_load_dwordx4 v85, s[16:19], s20 offen lds
    s_cmp_ge_u32 s32, 4
    s_cbranch_scc1 a_ng7
    ds_read_b128 v[44:47], v14 offset:57344
    v_and_b32 v13, 0x70, v4
    v_add_u32 v13, 144640, v13
    s_lshl_b32 s20, s30, 5
    s_add_u32 s20, s20, 143872
    v_lshrrev_b32 v84, 3, v1
    v_lshl_add_u32 v84, v84, 2, s20
    s_waitcnt lgkmcnt(0)
a_ng7:
    s_branch a_p1done
a_short:
    s_waitcnt vmcnt(7)
    s_barrier
    s_add_u32 s21, s33, 2
    s_and_b32 s21, s21, 7
    s_lshl_b32 s22, s21, 7
    s_add_u32 s22, s22, s34
    s_mul_i32 s23, s21, 196608
    s_add_u32 m0, s38, 57344
    s_add_u32 s20, s22, 0
    buffer_load_dwordx4 v4, s[4:7], s20 offen lds
    s_add_u32 m0, s38, 73728
    s_add_u32 s20, s23, s35
    buffer_load_dwordx4 v5, s[8:11], s20 offen lds
    s_add_u32 m0, s38, 77760
    s_add_u32 s20, s23, s35
    buffer_load_dwordx4 v5, s[8:11], s20 offen offset:64 lds
    s_add_u32 m0, s38, 61440
    s_add_u32 s20, s22, 32768
    buffer_load_dwordx4 v4, s[4:7], s20 offen lds
    s_add_u32 m0, s38, 65536
    s_add_u32 s20, s22, 65536
    buffer_load_dwordx4 v4, s[4:7], s20 offen lds
    s_add_u32 m0, s38, 81920
    s_add_u32 s20, s23, s37
    buffer_load_dwordx4 v5, s[8:11], s20 offen lds
    s_add_u32 m0, s38, 69632
    s_add_u32 s20, s22, 98304
    buffer_load_dwordx4 v4, s[4:7], s20 offen lds
    s_waitcnt vmcnt(7)
    s_barrier
    s_add_u32 s21, s33, 3
    s_and_b32 s21, s21, 7
    s_lshl_b32 s22, s21, 7
    s_add_u32 s22, s22, s34
    s_mul_i32 s23, s21, 196608
    s_add_u32 m0, s38, 86016
    s_add_u32 s20, s22, 0
    buffer_load_dwordx4 v4, s[4:7], s20 offen lds
    s_add_u32 m0, s38, 102400
    s_add_u32 s20, s23, s35
    buffer_load_dwordx4 v5, s[8:11], s20 offen lds
    s_add_u32 m0, s38, 106432
    s_add_u32 s20, s23, s35
    buffer_load_dwordx4 v5, s[8:11], s20 offen offset:64 lds
    s_add_u32 m0, s38, 90112
    s_add_u32 s20, s22, 32768
    buffer_load_dwordx4 v4, s[4:7], s20 offen lds
    s_add_u32 m0, s38, 94208
    s_add_u32 s20, s22, 65536
    buffer_load_dwordx4 v4, s[4:7], s20 offen lds
    s_add_u32 m0, s38, 110592
    s_add_u32 s20, s23, s37
    buffer_load_dwordx4 v5, s[8:11], s20 offen lds
    s_add_u32 m0, s38, 98304
    s_add_u32 s20, s22, 98304
    buffer_load_dwordx4 v4, s[4:7], s20 offen lds
    s_add_u32 s21, s33, 4
    s_and_b32 s21, s21, 7
    s_lshl_b32 s22, s21, 7
    s_add_u32 s22, s22, s34
    s_mul_i32 s23, s21, 196608
    s_add_u32 m0, s38, 114688
    s_add_u32 s20, s22, 0
    buffer_load_dwordx4 v4, s[4:7], s20 offen lds
    s_add_u32 m0, s38, 131072
    s_add_u32 s20, s23, s35
    buffer_load_dwordx4 v5, s[8:11], s20 offen lds
    s_add_u32 m0, s38, 135104
    s_add_u32 s20, s23, s35
    buffer_load_dwordx4 v5, s[8:11], s20 offen offset:64 lds
    s_add_u32 m0, s38, 118784
    s_add_u32 s20, s22, 32768
    buffer_load_dwordx4 v4, s[4:7], s20 offen lds
    s_add_u32 m0, s38, 122880
    s_add_u32 s20, s22, 65536
    buffer_load_dwordx4 v4, s[4:7], s20 offen lds
    s_add_u32 m0, s38, 139264
    s_add_u32 s20, s23, s37
    buffer_load_dwordx4 v5, s[8:11], s20 offen lds
    s_add_u32 m0, s38, 126976
    s_add_u32 s20, s22, 98304
    buffer_load_dwordx4 v4, s[4:7], s20 offen lds
    s_waitcnt vmcnt(14)
    s_barrier
    s_add_u32 s21, s33, 5
    s_and_b32 s21, s21, 7
    s_lshl_b32 s22, s21, 7
    s_add_u32 s22, s22, s34
    s_mul_i32 s23, s21, 196608
    s_add_u32 m0, s38, 0
    s_add_u32 s20, s22, 0
    buffer_load_dwordx4 v4, s[4:7], s20 offen lds
    s_add_u32 m0, s38, 16384
    s_add_u32 s20, s23, s35
    buffer_load_dwordx4 v5, s[8:11], s20 offen lds
    s_add_u32 m0, s38, 20416
    s_add_u32 s20, s23, s35
    buffer_load_dwordx4 v5, s[8:11], s20 offen offset:64 lds
    s_add_u32 m0, s38, 4096
    s_add_u32 s20, s22, 32768
    buffer_load_dwordx4 v4, s[4:7], s20 offen lds
    s_add_u32 m0, s38, 8192
    s_add_u32 s20, s22, 65536
    buffer_load_dwordx4 v4, s[4:7], s20 offen lds
    s_add_u32 m0, s38, 24576
    s_add_u32 s20, s23, s37
    buffer_load_dwordx4 v5, s[8:11], s20 offen lds
    s_add_u32 m0, s38, 12288
    s_add_u32 s20, s22, 98304
    buffer_load_dwordx4 v4, s[4:7], s20 offen lds
    s_mov_b32 s12, s62
    s_and_b32 s13, s63, 0xffff
    s_mov_b32 s14, 59768832
    s_mov_b32 s15, 0x00020000
    s_mov_b32 s3, 0
    s_mov_b32 s16, s48
    s_and_b32 s17, s49, 0xffff
    s_mov_b32 s18, 1835008
    s_mov_b32 s19, 0x00020000
    s_cmp_lt_u32 s32, 8
    s_cselect_b32 s20, s33, s32
    s_cselect_b32 s21, 1, 0
    s_and_b32 s20, s20, 1
    s_lshl_b32 s90, s20, s21
    s_lshl_b32 s20, s20, 1
    s_sub_u32 s91, 2, s20
    s_mul_i32 s20, s32, 3
    s_min_u32 s21, s32, 8
    s_add_u32 s20, s20, s21
    s_add_u32 s90, s90, s20
    s_add_u32 s91, s91, s20
    s_lshl_b32 s90, s90, 6
    s_lshl_b32 s91, s91, 6
    s_mov_b32 s80, s50
    s_and_b32 s81, s51, 0xffff
    s_mov_b32 s82, 3584
    s_mov_b32 s83, 0x00020000
    s_sub_u32 s20, s91, 128
    v_mov_b32 v10, s20
    v_mov_b32 v7, s90
    v_cmp_gt_u32 vcc, 32, v1
    v_cndmask_b32 v10, v10, v7, vcc
    v_lshl_add_u32 v10, v1, 2, v10
    s_mul_i32 s20, s30, 57344
    s_add_u32 s90, s90, s20
    s_add_u32 s91, s91, s20
    s_mov_b32 s87, s33
    s_mov_b32 s88, s38
    s_mov_b32 s89, s32
    s_waitcnt vmcnt(14)
    s_barrier
    s_add_u32 s21, s33, 6
    s_and_b32 s21, s21, 7
    s_lshl_b32 s22, s21, 7
    s_add_u32 s22, s22, s34
    s_mul_i32 s23, s21, 196608
    s_add_u32 m0, s38, 28672
    s_add_u32 s20, s22, 0
    buffer_load_dwordx4 v4, s[4:7], s20 offen lds
    s_add_u32 m0, s38, 45056
    s_add_u32 s20, s23, s35
    buffer_load_dwordx4 v5, s[8:11], s20 offen lds
    s_add_u32 m0, s38, 49088
    s_add_u32 s20, s23, s35
    buffer_load_dwordx4 v5, s[8:11], s20 offen offset:64 lds
    s_add_u32 m0, s38, 32768
    s_add_u32 s20, s22, 32768
    buffer_load_dwordx4 v4, s[4:7], s20 offen lds
    s_add_u32 m0, s38, 36864
    s_add_u32 s20, s22, 65536
    buffer_load_dwordx4 v4, s[4:7], s20 offen lds
    s_add_u32 m0, s38, 53248
    s_add_u32 s20, s23, s37
    buffer_load_dwordx4 v5, s[8:11], s20 offen lds
    s_add_u32 m0, s38, 40960
    s_add_u32 s20, s22, 98304
    buffer_load_dwordx4 v4, s[4:7], s20 offen lds
    s_waitcnt vmcnt(14)
    s_barrier
    s_add_u32 s21, s33, 7
    s_and_b32 s21, s21, 7
    s_lshl_b32 s22, s21, 7
    s_add_u32 s22, s22, s34
    s_mul_i32 s23, s21, 196608
    s_add_u32 m0, s38, 57344
    s_add_u32 s20, s22, 0
    buffer_load_dwordx4 v4, s[4:7], s20 offen lds
    s_add_u32 m0, s38, 73728
    s_add_u32 s20, s23, s35
    buffer_load_dwordx4 v5, s[8:11], s20 offen lds
    s_add_u32 m0, s38, 77760
    s_add_u32 s20, s23, s35
    buffer_load_dwordx4 v5, s[8:11], s20 offen offset:64 lds
    s_add_u32 m0, s38, 61440
    s_add_u32 s20, s22, 32768
    buffer_load_dwordx4 v4, s[4:7], s20 offen lds
    s_add_u32 m0, s38, 65536
    s_add_u32 s20, s22, 65536
    buffer_load_dwordx4 v4, s[4:7], s20 offen lds
    s_add_u32 m0, s38, 81920
    s_add_u32 s20, s23, s37
    buffer_load_dwordx4 v5, s[8:11], s20 offen lds
    s_add_u32 m0, s38, 69632
    s_add_u32 s20, s22, 98304
    buffer_load_dwordx4 v4, s[4:7], s20 offen lds
    s_waitcnt vmcnt(14)
    s_barrier
    s_mov_b32 m0, 143616
    s_nop 0
    buffer_load_dword v10, s[80:83], 0 offen lds
    s_add_u32 s21, s87, 0
    s_and_b32 s21, s21, 7
    s_mul_i32 s23, s21, 229376
    s_add_u32 s23, s23, s90
    s_add_u32 m0, s88, 147456
    s_add_u32 s20, s23, 0
    buffer_load_dwordx4 v85, s[16:19], s20 offen lds
    s_add_u32 m0, s88, 151552
    s_add_u32 s20, s23, 64
    buffer_load_dwordx4 v85, s[16:19], s20 offen lds
    s_add_u32 s21, s21, 1
    s_and_b32 s21, s21, 7
    s_mul_i32 s23, s21, 229376
    s_add_u32 s23, s23, s90
    s_add_u32 m0, s88, 155648
    s_add_u32 s20, s23, 0
    buffer_load_dwordx4 v85, s[16:19], s20 offen lds
    s_add_u32 m0, s88, 159744
    s_add_u32 s20, s23, 64
    buffer_load_dwordx4 v85, s[16:19], s20 offen lds
    s_and_b32 s20, s29, 7
    s_mul_i32 s20, s20, 229376
    s_add_u32 s20, s20, s91
    s_mov_b32 exec_lo, 0x11111111
    s_mov_b32 exec_hi, 0x11111111
    buffer_load_dword v13, v85, s[16:19], s20 offen
    s_mov_b64 exec, -1
    s_waitcnt vmcnt(13)
    s_barrier
    s_mov_b32 s80, s60
    s_and_b32 s81, s61, 0xffff
    s_mov_b32 s82, 256
    s_mov_b32 s83, 0x00020000
    buffer_load_dword v86, v9, s[80:83], 0 offen sc1
    s_add_u32 s21, s87, 2
    s_and_b32 s21, s21, 7
    s_mul_i32 s23, s21, 229376
    s_add_u32 s23, s23, s90
    s_add_u32 m0, s88, 86016
    s_add_u32 s20, s23, 0
    buffer_load_dwordx4 v85, s[16:19], s20 offen lds
    s_add_u32 m0, s88, 90112
    s_add_u32 s20, s23, 64
    buffer_load_dwordx4 v85, s[16:19], s20 offen lds
    s_add_u32 s21, s21, 1
    s_and_b32 s21, s21, 7
    s_mul_i32 s23, s21, 229376
    s_add_u32 s23, s23, s90
    s_add_u32 m0, s88, 94208
    s_add_u32 s20, s23, 0
    buffer_load_dwordx4 v85, s[16:19], s20 offen lds
    s_add_u32 m0, s88, 98304
    s_add_u32 s20, s23, 64
    buffer_load_dwordx4 v85, s[16:19], s20 offen lds
    s_waitcnt vmcnt(11)
    s_barrier
    s_add_u32 s21, s87, 4
    s_and_b32 s21, s21, 7
    s_mul_i32 s23, s21, 229376
    s_add_u32 s23, s23, s90
    s_add_u32 m0, s88, 102400
    s_add_u32 s20, s23, 0
    buffer_load_dwordx4 v85, s[16:19], s20 offen lds
    s_add_u32 m0, s88, 106496
    s_add_u32 s20, s23, 64
    buffer_load_dwordx4 v85, s[16:19], s20 offen lds
    s_add_u32 s21, s21, 1
    s_and_b32 s21, s21, 7
    s_mul_i32 s23, s21, 229376
    s_add_u32 s23, s23, s90
    s_add_u32 m0, s88, 110592
    s_add_u32 s20, s23, 0
    buffer_load_dwordx4 v85, s[16:19], s20 offen lds
    s_add_u32 m0, s88, 114688
    s_add_u32 s20, s23, 64
    buffer_load_dwordx4 v85, s[16:19], s20 offen lds
a_p1done:
    s_lshl_b32 s31, s28, 2
    s_lshr_b32 s20, s29, 3
    s_add_u32 s31, s31, s20
    s_and_b32 s32, s29, 7
    s_lshl_b32 s33, s32, 2
    s_add_u32 s33, s33, s30
    s_and_b32 s21, s29, 7
    s_lshl_b32 s21, s21, 1
    s_add_u32 s21, s21, s30
    s_and_b32 s21, s21, 15
    s_lshl_b32 s24, s21, 7
    s_lshl_b32 s21, s21, 12
    s_lshl_b32 s22, s31, 17
    s_add_u32 s22, s22, 2097152
    s_add_u32 s22, s21, s22
    s_lshr_b32 s27, s30, 1
    s_cmp_eq_u32 s27, 0
    s_mov_b32 s26, 0xfeda98bc
    s_cselect_b32 s26, 0xfeda98cb, s26
    s_lshl_b32 s27, s27, 4
    s_and_b32 s5, s30, 1
    s_lshl_b32 s5, s5, 13
    s_add_u32 s4, s30, 6
    s_lshl_b32 s4, s4, 13
    v_and_b32 v6, 31, v1
    v_and_b32 v7, 27, v1
    v_cmp_eq_u32 vcc, 16, v7
    v_mov_b32 v4, 143504
    v_mov_b32 v5, 143488
    v_cndmask_b32 v4, v4, v5, vcc
    v_and_b32 v5, 3, v1
    v_lshlrev_b32 v5, 4, v5
    v_xor_b32 v7, s27, v5
    v_cmp_gt_u32 vcc, 32, v5
    v_cndmask_b32 v5, v5, v7, vcc
    v_add_u32 v5, 143520, v5
    v_cmp_lt_u32 vcc, 55, v1
    v_cndmask_b32 v4, v4, v5, vcc
    v_lshrrev_b32 v7, 5, v1
    v_lshlrev_b32 v7, 8, v7
    v_lshl_add_u32 v7, v6, 4, v7
    v_add_u32 v7, 4096, v7
    v_add_u32 v7, s5, v7
    v_cmp_gt_u32 vcc, 16, v6
    v_mov_b32 v5, 0x4000
    v_cndmask_b32 v151, v4, v7, vcc
    v_cndmask_b32 v146, 0, v5, vcc
    v_lshrrev_b32 v149, 1, v146
    v_add_u32 v150, s5, v3
    v_and_b32 v5, 7, v1
    v_lshrrev_b32 v4, 3, v1
    v_lshlrev_b32 v4, 9, v4
    v_lshl_add_u32 v4, v5, 4, v4
    v_cmp_eq_u32 vcc, 0, v5
    v_mov_b32 v5, 0x3f803f80
    v_cndmask_b32 v128, 0, v5, vcc
    v_mov_b32 v129, v128
    v_mov_b32 v130, v128
    v_mov_b32 v131, v128
    v_add_u32 v4, 143488, v4
    ds_write_b128 v4, v[128:131]
    s_mov_b32 s36, 0
    s_lshr_b32 s8, s30, 1
    s_sub_u32 s9, 4, s8
    s_add_u32 s8, s8, 3
    v_lshl_add_u32 v164, s8, 14, v150
    v_xor_b32 v165, 0x2000, v164
    v_lshl_add_u32 v166, s9, 14, v150
    v_xor_b32 v167, 0x2000, v166
    v_lshl_add_u32 v168, 0, 14, v150
    v_xor_b32 v169, 0x2000, v168
    v_lshl_add_u32 v170, 5, 14, v150
    v_xor_b32 v171, 0x2000, v170
    v_mad_u32_u24 v172, s8, v146, v151
    v_xor_b32 v173, v149, v172
    v_mad_u32_u24 v174, s9, v146, v151
    v_xor_b32 v175, v149, v174
    v_mad_u32_u24 v176, 0, v146, v151
    v_xor_b32 v177, v149, v176
    v_mad_u32_u24 v178, 1, v146, v151
    v_xor_b32 v179, v149, v178
    v_mad_u32_u24 v180, 2, v146, v151
    v_xor_b32 v181, v149, v180
    v_mad_u32_u24 v182, 5, v146, v151
    v_xor_b32 v183, v149, v182
    v_mad_u32_u24 v184, 6, v146, v151
    v_xor_b32 v185, v149, v184
    v_mad_u32_u24 v186, 7, v146, v151
    v_xor_b32 v187, v149, v186
    s_add_u32 s20, s27, 145568
    v_lshlrev_b32 v2, 2, v1
    v_add_u32 v2, 146688, v2
    s_mov_b32 s21, 143448
    v_mov_b32 v154, 0
    v_writelane_b32 v2, s20, 0
    v_writelane_b32 v2, s21, 1
    v_writelane_b32 v154, 2, 0
    v_writelane_b32 v154, 1, 1
    s_lshr_b32 s38, s31, 2
    s_lshl_b32 s38, s38, 11
    v_lshl_add_u32 v4, v1, 6, s24
    v_and_b32 v4, 0x7ff, v4
    v_add_u32 v4, s38, v4
    s_lshr_b32 s21, s31, 1
    s_xor_b32 s21, s21, 2
    s_lshr_b32 s38, s21, 1
    s_lshl_b32 s38, s38, 11
    s_and_b32 s21, s21, 1
    s_lshl_b32 s21, s21, 6
    s_add_u32 s21, s21, s38
    s_lshr_b32 s20, s33, 1
    s_lshl_b32 s20, s20, 7
    s_add_u32 s20, s20, s21
    v_mov_b32 v5, s20
    v_cmp_gt_u32 vcc, 2, v1
    s_sub_u32 s38, 56639488, s3
    v_cndmask_b32 v4, v5, v4, vcc
    s_lshl_b32 s34, s31, 5
    s_add_u32 s34, s34, s33
    s_lshl_b32 s34, s34, 11
    s_add_u32 s34, s34, 0
    s_add_u32 s35, s22, 65536
    s_waitcnt vmcnt(4) lgkmcnt(0)
    s_mov_b32 s96, 0
    s_branch a_ctr_chk
a_ctr_ld:
    buffer_load_dword v86, v9, s[80:83], 0 offen sc1
    s_waitcnt vmcnt(0)
a_ctr_chk:
    v_cmp_ne_u32 vcc, 32, v86
    s_nop 4
    s_cbranch_vccz a_ctr_ok
    s_add_u32 s96, s96, 1
    s_cmp_gt_u32 s96, 32768
    s_cbranch_scc1 a_ctr_ok
    s_sleep 8
    s_branch a_ctr_ld
a_ctr_ok:
    s_barrier
    s_cmp_ge_u32 s89, 8
    s_cbranch_scc1 a_short8
    s_add_u32 s21, s87, 6
    s_and_b32 s21, s21, 7
    s_mul_i32 s23, s21, 229376
    s_add_u32 s23, s23, s90
    s_add_u32 m0, s88, 118784
    s_add_u32 s20, s23, 0
    buffer_load_dwordx4 v85, s[16:19], s20 offen lds
    s_add_u32 m0, s88, 122880
    s_add_u32 s20, s23, 64
    buffer_load_dwordx4 v85, s[16:19], s20 offen lds
    s_add_u32 s21, s21, 1
    s_and_b32 s21, s21, 7
    s_mul_i32 s23, s21, 229376
    s_add_u32 s23, s23, s90
    s_add_u32 m0, s88, 126976
    s_add_u32 s20, s23, 0
    buffer_load_dwordx4 v85, s[16:19], s20 offen lds
    s_add_u32 m0, s88, 131072
    s_add_u32 s20, s23, 64
    buffer_load_dwordx4 v85, s[16:19], s20 offen lds
    s_add_u32 s21, s87, 0
    s_and_b32 s21, s21, 7
    s_mul_i32 s23, s21, 229376
    s_add_u32 s23, s23, s91
    s_add_u32 m0, s88, 135168
    s_add_u32 s20, s23, 0
    buffer_load_dwordx4 v85, s[16:19], s20 offen lds
    s_add_u32 m0, s88, 139264
    s_add_u32 s20, s23, 64
    buffer_load_dwordx4 v85, s[16:19], s20 offen lds
    s_add_u32 s21, s21, 1
    s_and_b32 s21, s21, 7
    s_mul_i32 s23, s21, 229376
    s_add_u32 s23, s23, s91
    s_add_u32 m0, s88, 0
    s_add_u32 s20, s23, 0
    buffer_load_dwordx4 v85, s[16:19], s20 offen lds
    s_add_u32 m0, s88, 4096
    s_add_u32 s20, s23, 64
    buffer_load_dwordx4 v85, s[16:19], s20 offen lds
    s_waitcnt vmcnt(4)
    s_mov_b64 exec, 1
    ds_add_u32 v11, v12 offset:52
    s_mov_b64 exec, -1
    s_add_u32 s21, s87, 2
    s_and_b32 s21, s21, 7
    s_mul_i32 s23, s21, 229376
    s_add_u32 s23, s23, s91
    s_add_u32 m0, s88, 8192
    s_add_u32 s20, s23, 0
    buffer_load_dwordx4 v85, s[16:19], s20 offen lds
    s_add_u32 m0, s88, 12288
    s_add_u32 s20, s23, 64
    buffer_load_dwordx4 v85, s[16:19], s20 offen lds
    s_add_u32 s21, s21, 1
    s_and_b32 s21, s21, 7
    s_mul_i32 s23, s21, 229376
    s_add_u32 s23, s23, s91
    s_add_u32 m0, s88, 16384
    s_add_u32 s20, s23, 0
    buffer_load_dwordx4 v85, s[16:19], s20 offen lds
    s_add_u32 m0, s88, 20480
    s_add_u32 s20, s23, 64
    buffer_load_dwordx4 v85, s[16:19], s20 offen lds
    s_add_u32 s21, s87, 4
    s_and_b32 s21, s21, 7
    s_mul_i32 s23, s21, 229376
    s_add_u32 s23, s23, s91
    s_add_u32 m0, s88, 24576
    s_add_u32 s20, s23, 0
    buffer_load_dwordx4 v85, s[16:19], s20 offen lds
    s_add_u32 m0, s88, 28672
    s_add_u32 s20, s23, 64
    buffer_load_dwordx4 v85, s[16:19], s20 offen lds
    s_add_u32 s21, s21, 1
    s_and_b32 s21, s21, 7
    s_mul_i32 s23, s21, 229376
    s_add_u32 s23, s23, s91
    s_add_u32 m0, s88, 32768
    s_add_u32 s20, s23, 0
    buffer_load_dwordx4 v85, s[16:19], s20 offen lds
    s_add_u32 m0, s88, 36864
    s_add_u32 s20, s23, 64
    buffer_load_dwordx4 v85, s[16:19], s20 offen lds
    s_add_u32 s21, s87, 6
    s_and_b32 s21, s21, 7
    s_mul_i32 s23, s21, 229376
    s_add_u32 s23, s23, s91
    s_add_u32 m0, s88, 40960
    s_add_u32 s20, s23, 0
    buffer_load_dwordx4 v85, s[16:19], s20 offen lds
    s_add_u32 m0, s88, 45056
    s_add_u32 s20, s23, 64
    buffer_load_dwordx4 v85, s[16:19], s20 offen lds
    s_add_u32 s21, s21, 1
    s_and_b32 s21, s21, 7
    s_mul_i32 s23, s21, 229376
    s_add_u32 s23, s23, s91
    s_add_u32 m0, s88, 81920
    s_add_u32 s20, s23, 0
    buffer_load_dwordx4 v85, s[16:19], s20 offen lds
    s_cmp_ge_u32 s89, 4
    s_cbranch_scc1 a_ng8
    ds_read_b128 v[48:51], v13 offset:0
    ds_read_b128 v[52:55], v13 offset:128
    ds_read_b128 v[56:59], v13 offset:512
    ds_read_b128 v[60:63], v13 offset:640
    ds_read_b128 v[64:67], v13 offset:1024
    ds_read_b128 v[68:71], v13 offset:1152
    ds_read_b128 v[72:75], v13 offset:1536
    ds_read_b128 v[76:79], v13 offset:1664
    s_waitcnt lgkmcnt(7)
    v_dot2_f32_bf16 v80, v16, v48, 0
    v_dot2_f32_bf16 v81, v17, v49, 0
    v_dot2_f32_bf16 v82, v18, v50, 0
    v_dot2_f32_bf16 v83, v19, v51, 0
    s_waitcnt lgkmcnt(6)
    v_dot2_f32_bf16 v80, v20, v52, v80
    v_dot2_f32_bf16 v81, v21, v53, v81
    v_dot2_f32_bf16 v82, v22, v54, v82
    v_dot2_f32_bf16 v83, v23, v55, v83
    s_waitcnt lgkmcnt(5)
    v_dot2_f32_bf16 v80, v24, v56, v80
    v_dot2_f32_bf16 v81, v25, v57, v81
    v_dot2_f32_bf16 v82, v26, v58, v82
    v_dot2_f32_bf16 v83, v27, v59, v83
    s_waitcnt lgkmcnt(4)
    v_dot2_f32_bf16 v80, v28, v60, v80
    v_dot2_f32_bf16 v81, v29, v61, v81
    v_dot2_f32_bf16 v82, v30, v62, v82
    v_dot2_f32_bf16 v83, v31, v63, v83
    s_waitcnt lgkmcnt(3)
    v_dot2_f32_bf16 v80, v32, v64, v80
    v_dot2_f32_bf16 v81, v33, v65, v81
    v_dot2_f32_bf16 v82, v34, v66, v82
    v_dot2_f32_bf16 v83, v35, v67, v83
    s_waitcnt lgkmcnt(2)
    v_dot2_f32_bf16 v80, v36, v68, v80
    v_dot2_f32_bf16 v81, v37, v69, v81
    v_dot2_f32_bf16 v82, v38, v70, v82
    v_dot2_f32_bf16 v83, v39, v71, v83
    s_waitcnt lgkmcnt(1)
    v_dot2_f32_bf16 v80, v40, v72, v80
    v_dot2_f32_bf16 v81, v41, v73, v81
    v_dot2_f32_bf16 v82, v42, v74, v82
    v_dot2_f32_bf16 v83, v43, v75, v83
    s_waitcnt lgkmcnt(0)
    v_dot2_f32_bf16 v80, v44, v76, v80
    v_dot2_f32_bf16 v81, v45, v77, v81
    v_dot2_f32_bf16 v82, v46, v78, v82
    v_dot2_f32_bf16 v83, v47, v79, v83
    s_nop 3
    v_add_f32 v80, v80, v81
    v_add_f32 v82, v82, v83
    v_add_f32 v80, v80, v82
    s_nop 1
    v_add_f32_dpp v80, v80, v80 quad_perm:[1,0,3,2] row_mask:0xf bank_mask:0xf
    s_nop 1
    v_add_f32_dpp v80, v80, v80 quad_perm:[2,3,0,1] row_mask:0xf bank_mask:0xf
    s_nop 1
    v_add_f32_dpp v80, v80, v80 row_half_mirror row_mask:0xf bank_mask:0xf
    ds_write_b32 v84, v80
a_ng8:
    s_waitcnt vmcnt(7)
    s_mov_b64 exec, 1
    ds_add_u32 v11, v12 offset:64
    s_mov_b64 exec, -1
    s_branch a_w1done
a_short8:
    s_add_u32 s21, s87, 6
    s_and_b32 s21, s21, 7
    s_mul_i32 s23, s21, 229376
    s_add_u32 s23, s23, s90
    s_add_u32 m0, s88, 118784
    s_add_u32 s20, s23, 0
    buffer_load_dwordx4 v85, s[16:19], s20 offen lds
    s_add_u32 m0, s88, 122880
    s_add_u32 s20, s23, 64
    buffer_load_dwordx4 v85, s[16:19], s20 offen lds
    s_add_u32 s21, s21, 1
    s_and_b32 s21, s21, 7
    s_mul_i32 s23, s21, 229376
    s_add_u32 s23, s23, s90
    s_add_u32 m0, s88, 126976
    s_add_u32 s20, s23, 0
    buffer_load_dwordx4 v85, s[16:19], s20 offen lds
    s_add_u32 m0, s88, 131072
    s_add_u32 s20, s23, 64
    buffer_load_dwordx4 v85, s[16:19], s20 offen lds
    s_add_u32 s21, s87, 0
    s_and_b32 s21, s21, 7
    s_mul_i32 s23, s21, 229376
    s_add_u32 s23, s23, s91
    s_add_u32 m0, s88, 135168
    s_add_u32 s20, s23, 0
    buffer_load_dwordx4 v85, s[16:19], s20 offen lds
    s_add_u32 s21, s21, 1
    s_and_b32 s21, s21, 7
    s_mul_i32 s23, s21, 229376
    s_add_u32 s23, s23, s91
    s_add_u32 m0, s88, 0
    s_add_u32 s20, s23, 0
    buffer_load_dwordx4 v85, s[16:19], s20 offen lds
    s_add_u32 s21, s87, 2
    s_and_b32 s21, s21, 7
    s_mul_i32 s23, s21, 229376
    s_add_u32 s23, s23, s91
    s_add_u32 m0, s88, 8192
    s_add_u32 s20, s23, 0
    buffer_load_dwordx4 v85, s[16:19], s20 offen lds
    s_add_u32 s21, s21, 1
    s_and_b32 s21, s21, 7
    s_mul_i32 s23, s21, 229376
    s_add_u32 s23, s23, s91
    s_add_u32 m0, s88, 16384
    s_add_u32 s20, s23, 0
    buffer_load_dwordx4 v85, s[16:19], s20 offen lds
    s_waitcnt vmcnt(4)
    s_mov_b64 exec, 1
    ds_add_u32 v11, v12 offset:52
    s_mov_b64 exec, -1
    s_add_u32 s21, s87, 4
    s_and_b32 s21, s21, 7
    s_mul_i32 s23, s21, 229376
    s_add_u32 s23, s23, s91
    s_add_u32 m0, s88, 24576
    s_add_u32 s20, s23, 0
    buffer_load_dwordx4 v85, s[16:19], s20 offen lds
    s_add_u32 s21, s21, 1
    s_and_b32 s21, s21, 7
    s_mul_i32 s23, s21, 229376
    s_add_u32 s23, s23, s91
    s_add_u32 m0, s88, 32768
    s_add_u32 s20, s23, 0
    buffer_load_dwordx4 v85, s[16:19], s20 offen lds
    s_add_u32 s21, s87, 6
    s_and_b32 s21, s21, 7
    s_mul_i32 s23, s21, 229376
    s_add_u32 s23, s23, s91
    s_add_u32 m0, s88, 40960
    s_add_u32 s20, s23, 0
    buffer_load_dwordx4 v85, s[16:19], s20 offen lds
    s_add_u32 s21, s21, 1
    s_and_b32 s21, s21, 7
    s_mul_i32 s23, s21, 229376
    s_add_u32 s23, s23, s91
    s_add_u32 m0, s88, 81920
    s_add_u32 s20, s23, 0
    buffer_load_dwordx4 v85, s[16:19], s20 offen lds
    s_waitcnt vmcnt(4)
    s_mov_b64 exec, 1
    ds_add_u32 v11, v12 offset:64
    s_mov_b64 exec, -1
a_w1done:
    s_mov_b64 exec, 0
    s_cmp_eq_u32 s30, 0
    s_cbranch_scc1 a_pad0
    s_cmp_eq_u32 s30, 1
    s_cbranch_scc1 a_pad1
    s_cmp_eq_u32 s30, 2
    s_cbranch_scc1 a_pad2
    s_cmp_eq_u32 s30, 3
    s_cbranch_scc1 a_pad3
a_ret0:
    s_cmp_eq_u32 s30, 0
    s_cbranch_scc1 a_pad4
    s_cmp_eq_u32 s30, 1
    s_cbranch_scc1 a_pad5
a_ret1:
    s_mov_b64 exec, -1
    s_mov_b32 m0, s4
    s_waitcnt vmcnt(0)
    s_mov_b64 exec, 1
    ds_add_u32 v11, v12 offset:68
    s_mov_b64 exec, -1
    v_mov_b32 v7, 143416
    s_mov_b32 s97, 0
a_st_ld:
    ds_read_b32 v5, v7
    s_waitcnt lgkmcnt(0)
    v_readfirstlane_b32 s20, v5
    s_nop 3
    s_cmp_ge_u32 s20, 4
    s_cbranch_scc1 a_st_ok
    s_add_u32 s97, s97, 1
    s_cmp_gt_u32 s97, 262144
    s_cbranch_scc1 a_st_ok
    s_sleep 2
    s_branch a_st_ld
a_st_ok:
    s_mov_b32 s96, 0
a_kv_ld:
    buffer_load_dword v6, v4, s[12:15], s38 offen sc1
    s_waitcnt vmcnt(0)
a_kv_chk:
    v_cmp_ne_u32 vcc, 1, v6
    s_nop 4
    s_cbranch_vccz a_kv_ok
    s_add_u32 s96, s96, 1
    s_cmp_gt_u32 s96, 32768
    s_cbranch_scc1 a_kv_ok
    s_sleep 1
    s_branch a_kv_ld
a_kv_ok:
    buffer_load_dwordx4 v[120:123], v3, s[12:15], s22 offen sc1
    buffer_load_dwordx4 v[8:11], v3, s[12:15], s34 offen sc1
    buffer_load_dwordx4 v[12:15], v3, s[12:15], s34 offen offset:1024 sc1
    buffer_load_dwordx4 v3, s[12:15], s22 offen offset:0 sc1 lds
    buffer_load_dwordx4 v3, s[12:15], s22 offen offset:1024 sc1 lds
    buffer_load_dwordx4 v3, s[12:15], s22 offen offset:2048 sc1 lds
    buffer_load_dwordx4 v3, s[12:15], s22 offen offset:3072 sc1 lds
    s_add_u32 m0, s4, 4096
    s_nop 0
    buffer_load_dwordx4 v3, s[12:15], s35 offen offset:0 sc1 lds
    buffer_load_dwordx4 v3, s[12:15], s35 offen offset:1024 sc1 lds
    buffer_load_dwordx4 v3, s[12:15], s35 offen offset:2048 sc1 lds
    buffer_load_dwordx4 v3, s[12:15], s35 offen offset:3072 sc1 lds
    s_lshl_b32 s34, s33, 6
    s_add_u32 s34, s34, s31
    s_lshl_b32 s34, s34, 10
    s_add_u32 s34, s34, 6291456
    s_add_u32 s35, s34, 32768
    v_mov_b32 v152, 1
    v_mov_b32 v153, 143360
    s_waitcnt vmcnt(9)
    v_mfma_f32_32x32x16_bf16 v[48:63], v[120:123], v[8:11], 0
    s_waitcnt vmcnt(8)
    v_mfma_f32_32x32x16_bf16 v[64:79], v[120:123], v[12:15], 0
    s_nop 10
    v_max3_f32 v4, v48, v49, v50
    v_max3_f32 v4, v4, v51, v52
    v_max3_f32 v4, v4, v53, v54
    v_max3_f32 v4, v4, v55, v56
    v_max3_f32 v4, v4, v57, v58
    v_max3_f32 v4, v4, v59, v60
    v_max3_f32 v4, v4, v61, v62
    v_max_f32 v4, v4, v63
    v_mov_b32 v5, v4
    s_nop 1
    v_permlane32_swap_b32 v4, v5
    s_nop 1
    v_min_f32 v4, -v4, -v5
    v_mov_b32 v5, v4
    v_mov_b64 v[16:17], v[4:5]
    v_mov_b64 v[18:19], v[4:5]
    v_mov_b64 v[20:21], v[4:5]
    v_mov_b64 v[22:23], v[4:5]
    v_mov_b64 v[24:25], v[4:5]
    v_mov_b64 v[26:27], v[4:5]
    v_mov_b64 v[28:29], v[4:5]
    v_mov_b64 v[30:31], v[4:5]
    v_max3_f32 v6, v64, v65, v66
    v_max3_f32 v6, v6, v67, v68
    v_max3_f32 v6, v6, v69, v70
    v_max3_f32 v6, v6, v71, v72
    v_max3_f32 v6, v6, v73, v74
    v_max3_f32 v6, v6, v75, v76
    v_max3_f32 v6, v6, v77, v78
    v_max_f32 v6, v6, v79
    v_mfma_f32_32x32x16_bf16 v[48:63], v[120:123], v[8:11], v[16:31]
    v_mov_b32 v7, v6
    s_nop 1
    v_permlane32_swap_b32 v6, v7
    s_nop 1
    v_min_f32 v6, -v6, -v7
    v_mov_b32 v7, v6
    v_mov_b64 v[32:33], v[6:7]
    v_mov_b64 v[34:35], v[6:7]
    v_mov_b64 v[36:37], v[6:7]
    v_mov_b64 v[38:39], v[6:7]
    v_mov_b64 v[40:41], v[6:7]
    v_mov_b64 v[42:43], v[6:7]
    v_mov_b64 v[44:45], v[6:7]
    v_mov_b64 v[46:47], v[6:7]
a_start:
    v_exp_f32 v48, v48
    v_exp_f32 v49, v49
    v_exp_f32 v50, v50
    v_mfma_f32_32x32x16_bf16 v[64:79], v[120:123], v[12:15], v[32:47]
    v_exp_f32 v51, v51
    v_exp_f32 v52, v52
    v_exp_f32 v53, v53
    v_exp_f32 v54, v54
    v_exp_f32 v55, v55
    v_cvt_pk_bf16_f32 v80, v48, v49
    v_cvt_pk_bf16_f32 v81, v50, v51
    v_cvt_pk_bf16_f32 v82, v52, v53
    v_cvt_pk_bf16_f32 v83, v54, v55
    v_exp_f32 v56, v56
    v_exp_f32 v57, v57
    v_exp_f32 v58, v58
    v_exp_f32 v59, v59
    v_exp_f32 v60, v60
    v_exp_f32 v61, v61
    v_exp_f32 v62, v62
    v_exp_f32 v63, v63
    v_cvt_pk_bf16_f32 v84, v56, v57
    v_cvt_pk_bf16_f32 v85, v58, v59
    v_cvt_pk_bf16_f32 v86, v60, v61
    v_cvt_pk_bf16_f32 v87, v62, v63
    v_exp_f32 v64, v64
    v_exp_f32 v65, v65
    v_exp_f32 v66, v66
    s_waitcnt vmcnt(0)
    ds_read_b128 v[124:127], v164 offset:1024
    ds_read_b128 v[128:131], v172 offset:0
    ds_read_b128 v[132:135], v172 offset:512
    ds_add_u32 v2, v154
    ds_read_b128 v[120:123], v164 offset:2048
    ds_read_b128 v[136:139], v172 offset:1024
    ds_read_b128 v[140:143], v172 offset:1536
    v_exp_f32 v67, v67
    v_exp_f32 v68, v68
    v_exp_f32 v69, v69
    v_exp_f32 v70, v70
    v_exp_f32 v71, v71
    v_cvt_pk_bf16_f32 v156, v64, v65
    v_cvt_pk_bf16_f32 v157, v66, v67
    v_cvt_pk_bf16_f32 v158, v68, v69
    v_cvt_pk_bf16_f32 v159, v70, v71
    v_exp_f32 v72, v72
    s_waitcnt lgkmcnt(4)
    v_mfma_f32_32x32x16_bf16 v[48:63], v[124:127], v[8:11], v[16:31]
    v_exp_f32 v73, v73
    v_exp_f32 v74, v74
    v_exp_f32 v75, v75
    v_mfma_f32_32x32x16_bf16 v[88:103], v[128:131], v[80:83], 0
    v_exp_f32 v76, v76
    v_exp_f32 v77, v77
    v_exp_f32 v78, v78
    v_mfma_f32_32x32x16_bf16 v[88:103], v[132:135], v[84:87], v[88:103]
    s_waitcnt lgkmcnt(0)
    v_exp_f32 v79, v79
    v_cvt_pk_bf16_f32 v160, v72, v73
    v_cvt_pk_bf16_f32 v161, v74, v75
    v_cvt_pk_bf16_f32 v162, v76, v77
    v_cvt_pk_bf16_f32 v163, v78, v79
    v_mfma_f32_32x32x16_bf16 v[64:79], v[124:127], v[12:15], v[32:47]
    ds_read_b128 v[124:127], v164 offset:3072
    v_exp_f32 v48, v48
    v_exp_f32 v49, v49
    v_exp_f32 v50, v50
    v_mfma_f32_32x32x16_bf16 v[104:119], v[128:131], v[156:159], 0
    ds_read_b128 v[128:131], v172 offset:2048
    v_exp_f32 v51, v51
    v_exp_f32 v52, v52
    v_exp_f32 v53, v53
    v_mfma_f32_32x32x16_bf16 v[104:119], v[132:135], v[160:163], v[104:119]
    ds_read_b128 v[132:135], v172 offset:2560
    v_exp_f32 v54, v54
    v_exp_f32 v55, v55
    v_cvt_pk_bf16_f32 v80, v48, v49
    v_cvt_pk_bf16_f32 v81, v50, v51
    v_cvt_pk_bf16_f32 v82, v52, v53
    v_cvt_pk_bf16_f32 v83, v54, v55
    v_exp_f32 v56, v56
    v_exp_f32 v57, v57
    v_exp_f32 v58, v58
    v_exp_f32 v59, v59
    v_exp_f32 v60, v60
    v_exp_f32 v61, v61
    v_exp_f32 v62, v62
    v_exp_f32 v63, v63
    v_cvt_pk_bf16_f32 v84, v56, v57
    v_cvt_pk_bf16_f32 v85, v58, v59
    v_cvt_pk_bf16_f32 v86, v60, v61
    v_cvt_pk_bf16_f32 v87, v62, v63
    v_mfma_f32_32x32x16_bf16 v[48:63], v[120:123], v[8:11], v[16:31]
    s_waitcnt lgkmcnt(0)
    v_exp_f32 v64, v64
    v_readlane_b32 s9, v128, 56
    v_exp_f32 v65, v65
    v_exp_f32 v66, v66
    v_mfma_f32_32x32x16_bf16 v[88:103], v[136:139], v[80:83], v[88:103]
    s_cmp_lt_u32 s9, 4
    v_exp_f32 v67, v67
    v_exp_f32 v68, v68
    v_exp_f32 v69, v69
    v_mfma_f32_32x32x16_bf16 v[88:103], v[140:143], v[84:87], v[88:103]
    s_cbranch_scc1 a_ck1
a_cb1:
    v_exp_f32 v70, v70
    v_exp_f32 v71, v71
    v_cvt_pk_bf16_f32 v156, v64, v65
    v_cvt_pk_bf16_f32 v157, v66, v67
    v_cvt_pk_bf16_f32 v158, v68, v69
    v_cvt_pk_bf16_f32 v159, v70, v71
    v_exp_f32 v72, v72
    v_exp_f32 v73, v73
    v_exp_f32 v74, v74
    v_exp_f32 v75, v75
    v_exp_f32 v76, v76
    v_exp_f32 v77, v77
    v_exp_f32 v78, v78
    v_exp_f32 v79, v79
    v_cvt_pk_bf16_f32 v160, v72, v73
    v_cvt_pk_bf16_f32 v161, v74, v75
    v_cvt_pk_bf16_f32 v162, v76, v77
    v_cvt_pk_bf16_f32 v163, v78, v79
    v_mfma_f32_32x32x16_bf16 v[64:79], v[120:123], v[12:15], v[32:47]
    ds_read_b128 v[120:123], v165 offset:0
    v_exp_f32 v48, v48
    v_exp_f32 v49, v49
    v_exp_f32 v50, v50
    v_mfma_f32_32x32x16_bf16 v[104:119], v[136:139], v[156:159], v[104:119]
    ds_read_b128 v[136:139], v172 offset:3072
    v_exp_f32 v51, v51
    v_exp_f32 v52, v52
    v_exp_f32 v53, v53
    v_mfma_f32_32x32x16_bf16 v[104:119], v[140:143], v[160:163], v[104:119]
    ds_read_b128 v[140:143], v172 offset:3584
    v_exp_f32 v54, v54
    v_exp_f32 v55, v55
    v_cvt_pk_bf16_f32 v80, v48, v49
a_pad0:
    s_cbranch_execz a_ret0
    v_cvt_pk_bf16_f32 v81, v50, v51
    v_cvt_pk_bf16_f32 v82, v52, v53
    v_cvt_pk_bf16_f32 v83, v54, v55
    v_exp_f32 v56, v56
    v_exp_f32 v57, v57
    v_exp_f32 v58, v58
    v_exp_f32 v59, v59
    v_exp_f32 v60, v60
    v_exp_f32 v61, v61
    v_exp_f32 v62, v62
    v_exp_f32 v63, v63
    v_cvt_pk_bf16_f32 v84, v56, v57
    v_cvt_pk_bf16_f32 v85, v58, v59
    v_cvt_pk_bf16_f32 v86, v60, v61
    v_cvt_pk_bf16_f32 v87, v62, v63
    v_mfma_f32_32x32x16_bf16 v[48:63], v[124:127], v[8:11], v[16:31]
    v_exp_f32 v64, v64
    v_exp_f32 v65, v65
    v_exp_f32 v66, v66
    v_mfma_f32_32x32x16_bf16 v[88:103], v[128:131], v[80:83], v[88:103]
    v_exp_f32 v67, v67
    v_exp_f32 v68, v68
    v_exp_f32 v69, v69
    v_mfma_f32_32x32x16_bf16 v[88:103], v[132:135], v[84:87], v[88:103]
    s_waitcnt lgkmcnt(0)
    v_exp_f32 v70, v70
    v_exp_f32 v71, v71
    v_cvt_pk_bf16_f32 v156, v64, v65
    v_cvt_pk_bf16_f32 v157, v66, v67
    v_cvt_pk_bf16_f32 v158, v68, v69
    v_cvt_pk_bf16_f32 v159, v70, v71
    v_exp_f32 v72, v72
    v_exp_f32 v73, v73
    v_exp_f32 v74, v74
    v_exp_f32 v75, v75
    v_exp_f32 v76, v76
    v_exp_f32 v77, v77
    v_exp_f32 v78, v78
    v_exp_f32 v79, v79
    v_cvt_pk_bf16_f32 v160, v72, v73
    v_cvt_pk_bf16_f32 v161, v74, v75
    v_cvt_pk_bf16_f32 v162, v76, v77
    v_cvt_pk_bf16_f32 v163, v78, v79
    v_mfma_f32_32x32x16_bf16 v[64:79], v[124:127], v[12:15], v[32:47]
    ds_read_b128 v[124:127], v165 offset:1024
    v_exp_f32 v48, v48
    v_exp_f32 v49, v49
    v_exp_f32 v50, v50
    v_mfma_f32_32x32x16_bf16 v[104:119], v[128:131], v[156:159], v[104:119]
    ds_read_b128 v[128:131], v173 offset:0
    v_exp_f32 v51, v51
    v_exp_f32 v52, v52
    v_exp_f32 v53, v53
    v_mfma_f32_32x32x16_bf16 v[104:119], v[132:135], v[160:163], v[104:119]
    ds_read_b128 v[132:135], v173 offset:512
    v_exp_f32 v54, v54
    v_exp_f32 v55, v55
    v_cvt_pk_bf16_f32 v80, v48, v49
    v_cvt_pk_bf16_f32 v81, v50, v51
    v_cvt_pk_bf16_f32 v82, v52, v53
    v_cvt_pk_bf16_f32 v83, v54, v55
    v_exp_f32 v56, v56
    v_exp_f32 v57, v57
    v_exp_f32 v58, v58
    v_exp_f32 v59, v59
    v_exp_f32 v60, v60
    v_exp_f32 v61, v61
    v_exp_f32 v62, v62
    v_exp_f32 v63, v63
    v_cvt_pk_bf16_f32 v84, v56, v57
    v_cvt_pk_bf16_f32 v85, v58, v59
    v_cvt_pk_bf16_f32 v86, v60, v61
    v_cvt_pk_bf16_f32 v87, v62, v63
    v_mfma_f32_32x32x16_bf16 v[48:63], v[120:123], v[8:11], v[16:31]
    v_exp_f32 v64, v64
    v_exp_f32 v65, v65
    v_exp_f32 v66, v66
    v_mfma_f32_32x32x16_bf16 v[88:103], v[136:139], v[80:83], v[88:103]
    v_exp_f32 v67, v67
    v_exp_f32 v68, v68
    v_exp_f32 v69, v69
    v_mfma_f32_32x32x16_bf16 v[88:103], v[140:143], v[84:87], v[88:103]
    s_waitcnt lgkmcnt(0)
    v_exp_f32 v70, v70
    v_exp_f32 v71, v71
    v_cvt_pk_bf16_f32 v156, v64, v65
    v_cvt_pk_bf16_f32 v157, v66, v67
    v_cvt_pk_bf16_f32 v158, v68, v69
    v_cvt_pk_bf16_f32 v159, v70, v71
    v_exp_f32 v72, v72
    v_exp_f32 v73, v73
    v_exp_f32 v74, v74
    v_exp_f32 v75, v75
    v_exp_f32 v76, v76
    v_exp_f32 v77, v77
    v_exp_f32 v78, v78
    v_exp_f32 v79, v79
    v_cvt_pk_bf16_f32 v160, v72, v73
    v_cvt_pk_bf16_f32 v161, v74, v75
    v_cvt_pk_bf16_f32 v162, v76, v77
    v_cvt_pk_bf16_f32 v163, v78, v79
    v_mfma_f32_32x32x16_bf16 v[64:79], v[120:123], v[12:15], v[32:47]
    ds_read_b128 v[120:123], v165 offset:2048
    v_exp_f32 v48, v48
    v_exp_f32 v49, v49
    v_exp_f32 v50, v50
    v_mfma_f32_32x32x16_bf16 v[104:119], v[136:139], v[156:159], v[104:119]
    ds_read_b128 v[136:139], v173 offset:1024
    v_exp_f32 v51, v51
    v_exp_f32 v52, v52
    v_exp_f32 v53, v53
    v_mfma_f32_32x32x16_bf16 v[104:119], v[140:143], v[160:163], v[104:119]
    ds_read_b128 v[140:143], v173 offset:1536
    v_exp_f32 v54, v54
    v_exp_f32 v55, v55
    v_cvt_pk_bf16_f32 v80, v48, v49
    v_cvt_pk_bf16_f32 v81, v50, v51
    v_cvt_pk_bf16_f32 v82, v52, v53
    v_cvt_pk_bf16_f32 v83, v54, v55
    v_exp_f32 v56, v56
    v_exp_f32 v57, v57
    v_exp_f32 v58, v58
    v_exp_f32 v59, v59
    v_exp_f32 v60, v60
    v_exp_f32 v61, v61
    v_exp_f32 v62, v62
    v_exp_f32 v63, v63
    v_cvt_pk_bf16_f32 v84, v56, v57
    v_cvt_pk_bf16_f32 v85, v58, v59
    v_cvt_pk_bf16_f32 v86, v60, v61
    v_cvt_pk_bf16_f32 v87, v62, v63
    v_mfma_f32_32x32x16_bf16 v[48:63], v[124:127], v[8:11], v[16:31]
    v_exp_f32 v64, v64
    v_exp_f32 v65, v65
    v_exp_f32 v66, v66
    v_mfma_f32_32x32x16_bf16 v[88:103], v[128:131], v[80:83], v[88:103]
    v_exp_f32 v67, v67
    v_exp_f32 v68, v68
    v_exp_f32 v69, v69
    v_mfma_f32_32x32x16_bf16 v[88:103], v[132:135], v[84:87], v[88:103]
    s_waitcnt lgkmcnt(0)
    v_exp_f32 v70, v70
    v_exp_f32 v71, v71
    v_cvt_pk_bf16_f32 v156, v64, v65
    v_cvt_pk_bf16_f32 v157, v66, v67
    v_cvt_pk_bf16_f32 v158, v68, v69
    v_cvt_pk_bf16_f32 v159, v70, v71
    v_exp_f32 v72, v72
    v_exp_f32 v73, v73
    v_exp_f32 v74, v74
    v_exp_f32 v75, v75
    v_exp_f32 v76, v76
    v_exp_f32 v77, v77
    v_exp_f32 v78, v78
    v_exp_f32 v79, v79
    v_cvt_pk_bf16_f32 v160, v72, v73
    v_cvt_pk_bf16_f32 v161, v74, v75
    v_cvt_pk_bf16_f32 v162, v76, v77
    v_cvt_pk_bf16_f32 v163, v78, v79
    v_mfma_f32_32x32x16_bf16 v[64:79], v[124:127], v[12:15], v[32:47]
    ds_read_b128 v[124:127], v165 offset:3072
    v_exp_f32 v48, v48
    v_exp_f32 v49, v49
    v_exp_f32 v50, v50
    v_mfma_f32_32x32x16_bf16 v[104:119], v[128:131], v[156:159], v[104:119]
    ds_read_b128 v[128:131], v173 offset:2048
    v_exp_f32 v51, v51
    v_exp_f32 v52, v52
    v_exp_f32 v53, v53
    v_mfma_f32_32x32x16_bf16 v[104:119], v[132:135], v[160:163], v[104:119]
    ds_read_b128 v[132:135], v173 offset:2560
    v_exp_f32 v54, v54
    v_exp_f32 v55, v55
    v_cvt_pk_bf16_f32 v80, v48, v49
    v_cvt_pk_bf16_f32 v81, v50, v51
    v_cvt_pk_bf16_f32 v82, v52, v53
    v_cvt_pk_bf16_f32 v83, v54, v55
    v_exp_f32 v56, v56
    v_exp_f32 v57, v57
    v_exp_f32 v58, v58
    v_exp_f32 v59, v59
    v_exp_f32 v60, v60
    v_exp_f32 v61, v61
    v_exp_f32 v62, v62
    v_exp_f32 v63, v63
    v_cvt_pk_bf16_f32 v84, v56, v57
    v_cvt_pk_bf16_f32 v85, v58, v59
    v_cvt_pk_bf16_f32 v86, v60, v61
    v_cvt_pk_bf16_f32 v87, v62, v63
    v_mfma_f32_32x32x16_bf16 v[48:63], v[120:123], v[8:11], v[16:31]
    s_waitcnt lgkmcnt(0)
    v_exp_f32 v64, v64
    v_readlane_b32 s9, v128, 57
    v_exp_f32 v65, v65
    v_exp_f32 v66, v66
    v_mfma_f32_32x32x16_bf16 v[88:103], v[136:139], v[80:83], v[88:103]
    s_cmp_lt_u32 s9, 4
    v_exp_f32 v67, v67
    v_exp_f32 v68, v68
    v_exp_f32 v69, v69
    v_mfma_f32_32x32x16_bf16 v[88:103], v[140:143], v[84:87], v[88:103]
    s_cbranch_scc1 a_ck5
a_cb5:
    v_exp_f32 v70, v70
    v_exp_f32 v71, v71
    v_cvt_pk_bf16_f32 v156, v64, v65
    v_cvt_pk_bf16_f32 v157, v66, v67
    v_cvt_pk_bf16_f32 v158, v68, v69
    v_cvt_pk_bf16_f32 v159, v70, v71
    v_exp_f32 v72, v72
    v_exp_f32 v73, v73
    v_exp_f32 v74, v74
    v_exp_f32 v75, v75
    v_exp_f32 v76, v76
    v_exp_f32 v77, v77
    v_exp_f32 v78, v78
    v_exp_f32 v79, v79
    v_cvt_pk_bf16_f32 v160, v72, v73
    v_cvt_pk_bf16_f32 v161, v74, v75
    v_cvt_pk_bf16_f32 v162, v76, v77
    v_cvt_pk_bf16_f32 v163, v78, v79
    v_mfma_f32_32x32x16_bf16 v[64:79], v[120:123], v[12:15], v[32:47]
    ds_read_b128 v[120:123], v166 offset:0
    v_exp_f32 v48, v48
    v_exp_f32 v49, v49
    v_exp_f32 v50, v50
    v_mfma_f32_32x32x16_bf16 v[104:119], v[136:139], v[156:159], v[104:119]
    ds_read_b128 v[136:139], v173 offset:3072
    v_exp_f32 v51, v51
    v_exp_f32 v52, v52
    v_exp_f32 v53, v53
    v_mfma_f32_32x32x16_bf16 v[104:119], v[140:143], v[160:163], v[104:119]
    ds_read_b128 v[140:143], v173 offset:3584
    v_exp_f32 v54, v54
    v_exp_f32 v55, v55
    v_cvt_pk_bf16_f32 v80, v48, v49
    v_cvt_pk_bf16_f32 v81, v50, v51
    v_cvt_pk_bf16_f32 v82, v52, v53
    v_cvt_pk_bf16_f32 v83, v54, v55
    v_exp_f32 v56, v56
    v_exp_f32 v57, v57
    v_exp_f32 v58, v58
    v_exp_f32 v59, v59
    v_exp_f32 v60, v60
    v_exp_f32 v61, v61
    v_exp_f32 v62, v62
    v_exp_f32 v63, v63
    v_cvt_pk_bf16_f32 v84, v56, v57
    v_cvt_pk_bf16_f32 v85, v58, v59
    v_cvt_pk_bf16_f32 v86, v60, v61
    v_cvt_pk_bf16_f32 v87, v62, v63
    v_mfma_f32_32x32x16_bf16 v[48:63], v[124:127], v[8:11], v[16:31]
    v_exp_f32 v64, v64
    v_exp_f32 v65, v65
    v_exp_f32 v66, v66
    v_mfma_f32_32x32x16_bf16 v[88:103], v[128:131], v[80:83], v[88:103]
    v_exp_f32 v67, v67
    v_exp_f32 v68, v68
    v_exp_f32 v69, v69
    v_mfma_f32_32x32x16_bf16 v[88:103], v[132:135], v[84:87], v[88:103]
    s_waitcnt lgkmcnt(0)
    v_exp_f32 v70, v70
    v_exp_f32 v71, v71
    v_cvt_pk_bf16_f32 v156, v64, v65
    v_cvt_pk_bf16_f32 v157, v66, v67
    v_cvt_pk_bf16_f32 v158, v68, v69
    v_cvt_pk_bf16_f32 v159, v70, v71
    v_exp_f32 v72, v72
    v_exp_f32 v73, v73
    v_exp_f32 v74, v74
    v_exp_f32 v75, v75
    v_exp_f32 v76, v76
    v_exp_f32 v77, v77
    v_exp_f32 v78, v78
    v_exp_f32 v79, v79
    v_cvt_pk_bf16_f32 v160, v72, v73
    v_cvt_pk_bf16_f32 v161, v74, v75
    v_cvt_pk_bf16_f32 v162, v76, v77
    v_cvt_pk_bf16_f32 v163, v78, v79
    v_mfma_f32_32x32x16_bf16 v[64:79], v[124:127], v[12:15], v[32:47]
    ds_read_b128 v[124:127], v166 offset:1024
    v_exp_f32 v48, v48
    v_exp_f32 v49, v49
    v_exp_f32 v50, v50
    v_mfma_f32_32x32x16_bf16 v[104:119], v[128:131], v[156:159], v[104:119]
    ds_read_b128 v[128:131], v174 offset:0
    v_exp_f32 v51, v51
    v_exp_f32 v52, v52
    v_exp_f32 v53, v53
    v_mfma_f32_32x32x16_bf16 v[104:119], v[132:135], v[160:163], v[104:119]
    ds_read_b128 v[132:135], v174 offset:512
    v_exp_f32 v54, v54
    v_exp_f32 v55, v55
    v_cvt_pk_bf16_f32 v80, v48, v49
    v_cvt_pk_bf16_f32 v81, v50, v51
    v_cvt_pk_bf16_f32 v82, v52, v53
    v_cvt_pk_bf16_f32 v83, v54, v55
    v_exp_f32 v56, v56
    v_exp_f32 v57, v57
    v_exp_f32 v58, v58
    v_exp_f32 v59, v59
    v_exp_f32 v60, v60
    v_exp_f32 v61, v61
    v_exp_f32 v62, v62
    v_exp_f32 v63, v63
    v_cvt_pk_bf16_f32 v84, v56, v57
    v_cvt_pk_bf16_f32 v85, v58, v59
    v_cvt_pk_bf16_f32 v86, v60, v61
    v_cvt_pk_bf16_f32 v87, v62, v63
    v_mfma_f32_32x32x16_bf16 v[48:63], v[120:123], v[8:11], v[16:31]
    v_exp_f32 v64, v64
    v_exp_f32 v65, v65
    v_exp_f32 v66, v66
    v_mfma_f32_32x32x16_bf16 v[88:103], v[136:139], v[80:83], v[88:103]
    v_exp_f32 v67, v67
    v_exp_f32 v68, v68
    v_exp_f32 v69, v69
    v_mfma_f32_32x32x16_bf16 v[88:103], v[140:143], v[84:87], v[88:103]
    s_waitcnt lgkmcnt(0)
    v_exp_f32 v70, v70
    v_exp_f32 v71, v71
    v_cvt_pk_bf16_f32 v156, v64, v65
    v_cvt_pk_bf16_f32 v157, v66, v67
    v_cvt_pk_bf16_f32 v158, v68, v69
    v_cvt_pk_bf16_f32 v159, v70, v71
    v_exp_f32 v72, v72
    v_exp_f32 v73, v73
    v_exp_f32 v74, v74
    v_exp_f32 v75, v75
    v_exp_f32 v76, v76
    v_exp_f32 v77, v77
    v_exp_f32 v78, v78
    v_exp_f32 v79, v79
    v_cvt_pk_bf16_f32 v160, v72, v73
    v_cvt_pk_bf16_f32 v161, v74, v75
    v_cvt_pk_bf16_f32 v162, v76, v77
    v_cvt_pk_bf16_f32 v163, v78, v79
    v_mfma_f32_32x32x16_bf16 v[64:79], v[120:123], v[12:15], v[32:47]
    ds_read_b128 v[120:123], v166 offset:2048
    v_exp_f32 v48, v48
    v_exp_f32 v49, v49
    v_exp_f32 v50, v50
    v_mfma_f32_32x32x16_bf16 v[104:119], v[136:139], v[156:159], v[104:119]
    ds_read_b128 v[136:139], v174 offset:1024
    v_exp_f32 v51, v51
    v_exp_f32 v52, v52
    v_exp_f32 v53, v53
    v_mfma_f32_32x32x16_bf16 v[104:119], v[140:143], v[160:163], v[104:119]
    ds_read_b128 v[140:143], v174 offset:1536
    v_exp_f32 v54, v54
    v_exp_f32 v55, v55
    v_cvt_pk_bf16_f32 v80, v48, v49
    v_cvt_pk_bf16_f32 v81, v50, v51
    v_cvt_pk_bf16_f32 v82, v52, v53
    v_cvt_pk_bf16_f32 v83, v54, v55
    v_exp_f32 v56, v56
    v_exp_f32 v57, v57
    v_exp_f32 v58, v58
    v_exp_f32 v59, v59
    v_exp_f32 v60, v60
    v_exp_f32 v61, v61
    v_exp_f32 v62, v62
    v_exp_f32 v63, v63
    v_cvt_pk_bf16_f32 v84, v56, v57
    v_cvt_pk_bf16_f32 v85, v58, v59
    v_cvt_pk_bf16_f32 v86, v60, v61
    v_cvt_pk_bf16_f32 v87, v62, v63
    v_mfma_f32_32x32x16_bf16 v[48:63], v[124:127], v[8:11], v[16:31]
    v_exp_f32 v64, v64
    v_exp_f32 v65, v65
    v_exp_f32 v66, v66
    v_mfma_f32_32x32x16_bf16 v[88:103], v[128:131], v[80:83], v[88:103]
    v_exp_f32 v67, v67
    v_exp_f32 v68, v68
    v_exp_f32 v69, v69
    v_mfma_f32_32x32x16_bf16 v[88:103], v[132:135], v[84:87], v[88:103]
    s_waitcnt lgkmcnt(0)
    v_exp_f32 v70, v70
    v_exp_f32 v71, v71
    v_cvt_pk_bf16_f32 v156, v64, v65
    v_cvt_pk_bf16_f32 v157, v66, v67
    v_cvt_pk_bf16_f32 v158, v68, v69
    v_cvt_pk_bf16_f32 v159, v70, v71
    v_exp_f32 v72, v72
    v_exp_f32 v73, v73
    v_exp_f32 v74, v74
    v_exp_f32 v75, v75
    v_exp_f32 v76, v76
    v_exp_f32 v77, v77
    v_exp_f32 v78, v78
    v_exp_f32 v79, v79
    v_cvt_pk_bf16_f32 v160, v72, v73
    v_cvt_pk_bf16_f32 v161, v74, v75
    v_cvt_pk_bf16_f32 v162, v76, v77
    v_cvt_pk_bf16_f32 v163, v78, v79
    v_mfma_f32_32x32x16_bf16 v[64:79], v[124:127], v[12:15], v[32:47]
    ds_read_b128 v[124:127], v166 offset:3072
    v_exp_f32 v48, v48
    v_exp_f32 v49, v49
    v_exp_f32 v50, v50
    v_mfma_f32_32x32x16_bf16 v[104:119], v[128:131], v[156:159], v[104:119]
    ds_read_b128 v[128:131], v174 offset:2048
    v_exp_f32 v51, v51
    v_exp_f32 v52, v52
    v_exp_f32 v53, v53
    v_mfma_f32_32x32x16_bf16 v[104:119], v[132:135], v[160:163], v[104:119]
    ds_read_b128 v[132:135], v174 offset:2560
    v_exp_f32 v54, v54
    v_exp_f32 v55, v55
    v_cvt_pk_bf16_f32 v80, v48, v49
    v_cvt_pk_bf16_f32 v81, v50, v51
    v_cvt_pk_bf16_f32 v82, v52, v53
    v_cvt_pk_bf16_f32 v83, v54, v55
    v_exp_f32 v56, v56
    v_exp_f32 v57, v57
    v_exp_f32 v58, v58
    v_exp_f32 v59, v59
    v_exp_f32 v60, v60
    v_exp_f32 v61, v61
    v_exp_f32 v62, v62
    v_exp_f32 v63, v63
    v_cvt_pk_bf16_f32 v84, v56, v57
    v_cvt_pk_bf16_f32 v85, v58, v59
    v_cvt_pk_bf16_f32 v86, v60, v61
    v_cvt_pk_bf16_f32 v87, v62, v63
    v_mfma_f32_32x32x16_bf16 v[48:63], v[120:123], v[8:11], v[16:31]
    v_exp_f32 v64, v64
    v_exp_f32 v65, v65
    v_exp_f32 v66, v66
    v_mfma_f32_32x32x16_bf16 v[88:103], v[136:139], v[80:83], v[88:103]
    v_exp_f32 v67, v67
    v_exp_f32 v68, v68
    v_exp_f32 v69, v69
    v_mfma_f32_32x32x16_bf16 v[88:103], v[140:143], v[84:87], v[88:103]
    s_waitcnt lgkmcnt(0)
    v_exp_f32 v70, v70
    v_exp_f32 v71, v71
    v_cvt_pk_bf16_f32 v156, v64, v65
    v_cvt_pk_bf16_f32 v157, v66, v67
    v_cvt_pk_bf16_f32 v158, v68, v69
    v_cvt_pk_bf16_f32 v159, v70, v71
    v_exp_f32 v72, v72
    v_exp_f32 v73, v73
    v_exp_f32 v74, v74
    v_exp_f32 v75, v75
    v_exp_f32 v76, v76
    v_exp_f32 v77, v77
    v_exp_f32 v78, v78
    v_exp_f32 v79, v79
    v_cvt_pk_bf16_f32 v160, v72, v73
    v_cvt_pk_bf16_f32 v161, v74, v75
    v_cvt_pk_bf16_f32 v162, v76, v77
    v_cvt_pk_bf16_f32 v163, v78, v79
    v_mfma_f32_32x32x16_bf16 v[64:79], v[120:123], v[12:15], v[32:47]
    ds_read_b128 v[120:123], v167 offset:0
    v_exp_f32 v48, v48
    v_exp_f32 v49, v49
    v_exp_f32 v50, v50
    v_mfma_f32_32x32x16_bf16 v[104:119], v[136:139], v[156:159], v[104:119]
    ds_read_b128 v[136:139], v174 offset:3072
    v_exp_f32 v51, v51
    v_exp_f32 v52, v52
    v_exp_f32 v53, v53
    v_mfma_f32_32x32x16_bf16 v[104:119], v[140:143], v[160:163], v[104:119]
    ds_read_b128 v[140:143], v174 offset:3584
    v_exp_f32 v54, v54
    v_exp_f32 v55, v55
    v_cvt_pk_bf16_f32 v80, v48, v49
    v_cvt_pk_bf16_f32 v81, v50, v51
    v_cvt_pk_bf16_f32 v82, v52, v53
    v_cvt_pk_bf16_f32 v83, v54, v55
    v_exp_f32 v56, v56
    v_exp_f32 v57, v57
    v_exp_f32 v58, v58
    v_exp_f32 v59, v59
    v_exp_f32 v60, v60
    v_exp_f32 v61, v61
    v_exp_f32 v62, v62
    v_exp_f32 v63, v63
    v_cvt_pk_bf16_f32 v84, v56, v57
    v_cvt_pk_bf16_f32 v85, v58, v59
    v_cvt_pk_bf16_f32 v86, v60, v61
    v_cvt_pk_bf16_f32 v87, v62, v63
    v_mfma_f32_32x32x16_bf16 v[48:63], v[124:127], v[8:11], v[16:31]
    v_exp_f32 v64, v64
    v_exp_f32 v65, v65
    v_exp_f32 v66, v66
    v_mfma_f32_32x32x16_bf16 v[88:103], v[128:131], v[80:83], v[88:103]
    v_exp_f32 v67, v67
    v_exp_f32 v68, v68
    v_exp_f32 v69, v69
    v_mfma_f32_32x32x16_bf16 v[88:103], v[132:135], v[84:87], v[88:103]
    s_waitcnt lgkmcnt(0)
    v_exp_f32 v70, v70
    v_exp_f32 v71, v71
    v_cvt_pk_bf16_f32 v156, v64, v65
    v_cvt_pk_bf16_f32 v157, v66, v67
    v_cvt_pk_bf16_f32 v158, v68, v69
    v_cvt_pk_bf16_f32 v159, v70, v71
    v_exp_f32 v72, v72
    v_exp_f32 v73, v73
    v_exp_f32 v74, v74
    v_exp_f32 v75, v75
    v_exp_f32 v76, v76
    v_exp_f32 v77, v77
    v_exp_f32 v78, v78
    v_exp_f32 v79, v79
    v_cvt_pk_bf16_f32 v160, v72, v73
    v_cvt_pk_bf16_f32 v161, v74, v75
    v_cvt_pk_bf16_f32 v162, v76, v77
    v_cvt_pk_bf16_f32 v163, v78, v79
    v_mfma_f32_32x32x16_bf16 v[64:79], v[124:127], v[12:15], v[32:47]
    ds_read_b128 v[124:127], v167 offset:1024
    v_exp_f32 v48, v48
    v_exp_f32 v49, v49
    v_exp_f32 v50, v50
    v_mfma_f32_32x32x16_bf16 v[104:119], v[128:131], v[156:159], v[104:119]
    ds_read_b128 v[128:131], v175 offset:0
    v_exp_f32 v51, v51
    v_exp_f32 v52, v52
    v_exp_f32 v53, v53
    v_mfma_f32_32x32x16_bf16 v[104:119], v[132:135], v[160:163], v[104:119]
    ds_read_b128 v[132:135], v175 offset:512
    v_exp_f32 v54, v54
    v_exp_f32 v55, v55
    v_cvt_pk_bf16_f32 v80, v48, v49
    v_cvt_pk_bf16_f32 v81, v50, v51
    v_cvt_pk_bf16_f32 v82, v52, v53
    v_cvt_pk_bf16_f32 v83, v54, v55
    v_exp_f32 v56, v56
    v_exp_f32 v57, v57
    v_exp_f32 v58, v58
    v_exp_f32 v59, v59
    v_exp_f32 v60, v60
    v_exp_f32 v61, v61
    v_exp_f32 v62, v62
    v_exp_f32 v63, v63
    v_cvt_pk_bf16_f32 v84, v56, v57
    v_cvt_pk_bf16_f32 v85, v58, v59
    v_cvt_pk_bf16_f32 v86, v60, v61
    v_cvt_pk_bf16_f32 v87, v62, v63
    v_mfma_f32_32x32x16_bf16 v[48:63], v[120:123], v[8:11], v[16:31]
    v_exp_f32 v64, v64
    v_exp_f32 v65, v65
    v_exp_f32 v66, v66
    v_mfma_f32_32x32x16_bf16 v[88:103], v[136:139], v[80:83], v[88:103]
    v_exp_f32 v67, v67
    v_exp_f32 v68, v68
    v_exp_f32 v69, v69
    v_mfma_f32_32x32x16_bf16 v[88:103], v[140:143], v[84:87], v[88:103]
    s_waitcnt lgkmcnt(0)
    v_exp_f32 v70, v70
    v_exp_f32 v71, v71
    v_cvt_pk_bf16_f32 v156, v64, v65
    v_cvt_pk_bf16_f32 v157, v66, v67
    v_cvt_pk_bf16_f32 v158, v68, v69
    v_cvt_pk_bf16_f32 v159, v70, v71
    v_exp_f32 v72, v72
    v_exp_f32 v73, v73
    v_exp_f32 v74, v74
    v_exp_f32 v75, v75
    v_exp_f32 v76, v76
    v_exp_f32 v77, v77
    v_exp_f32 v78, v78
    v_exp_f32 v79, v79
    v_cvt_pk_bf16_f32 v160, v72, v73
    v_cvt_pk_bf16_f32 v161, v74, v75
    v_cvt_pk_bf16_f32 v162, v76, v77
    v_cvt_pk_bf16_f32 v163, v78, v79
    v_mfma_f32_32x32x16_bf16 v[64:79], v[120:123], v[12:15], v[32:47]
    ds_read_b128 v[120:123], v167 offset:2048
    v_exp_f32 v48, v48
    v_exp_f32 v49, v49
    v_exp_f32 v50, v50
    v_mfma_f32_32x32x16_bf16 v[104:119], v[136:139], v[156:159], v[104:119]
    ds_read_b128 v[136:139], v175 offset:1024
    v_exp_f32 v51, v51
    v_exp_f32 v52, v52
    v_exp_f32 v53, v53
    v_mfma_f32_32x32x16_bf16 v[104:119], v[140:143], v[160:163], v[104:119]
    ds_read_b128 v[140:143], v175 offset:1536
    v_exp_f32 v54, v54
    v_exp_f32 v55, v55
    v_cvt_pk_bf16_f32 v80, v48, v49
    v_cvt_pk_bf16_f32 v81, v50, v51
    v_cvt_pk_bf16_f32 v82, v52, v53
    v_cvt_pk_bf16_f32 v83, v54, v55
    v_exp_f32 v56, v56
    v_exp_f32 v57, v57
    v_exp_f32 v58, v58
    v_exp_f32 v59, v59
    v_exp_f32 v60, v60
    v_exp_f32 v61, v61
    v_exp_f32 v62, v62
    v_exp_f32 v63, v63
    v_cvt_pk_bf16_f32 v84, v56, v57
    v_cvt_pk_bf16_f32 v85, v58, v59
    v_cvt_pk_bf16_f32 v86, v60, v61
    v_cvt_pk_bf16_f32 v87, v62, v63
    v_mfma_f32_32x32x16_bf16 v[48:63], v[124:127], v[8:11], v[16:31]
    v_exp_f32 v64, v64
    v_exp_f32 v65, v65
    v_exp_f32 v66, v66
    v_mfma_f32_32x32x16_bf16 v[88:103], v[128:131], v[80:83], v[88:103]
    v_exp_f32 v67, v67
    v_exp_f32 v68, v68
    v_exp_f32 v69, v69
    v_mfma_f32_32x32x16_bf16 v[88:103], v[132:135], v[84:87], v[88:103]
    s_waitcnt lgkmcnt(0)
    v_exp_f32 v70, v70
    v_exp_f32 v71, v71
    v_cvt_pk_bf16_f32 v156, v64, v65
    v_cvt_pk_bf16_f32 v157, v66, v67
    v_cvt_pk_bf16_f32 v158, v68, v69
    v_cvt_pk_bf16_f32 v159, v70, v71
    v_exp_f32 v72, v72
    v_exp_f32 v73, v73
    v_exp_f32 v74, v74
    v_exp_f32 v75, v75
    v_exp_f32 v76, v76
    v_exp_f32 v77, v77
    v_exp_f32 v78, v78
    v_exp_f32 v79, v79
    v_cvt_pk_bf16_f32 v160, v72, v73
    v_cvt_pk_bf16_f32 v161, v74, v75
    v_cvt_pk_bf16_f32 v162, v76, v77
    v_cvt_pk_bf16_f32 v163, v78, v79
    v_mfma_f32_32x32x16_bf16 v[64:79], v[124:127], v[12:15], v[32:47]
    ds_read_b128 v[124:127], v167 offset:3072
    v_exp_f32 v48, v48
    v_exp_f32 v49, v49
    v_exp_f32 v50, v50
    v_mfma_f32_32x32x16_bf16 v[104:119], v[128:131], v[156:159], v[104:119]
    ds_read_b128 v[128:131], v175 offset:2048
    v_exp_f32 v51, v51
    v_exp_f32 v52, v52
    v_exp_f32 v53, v53
    v_mfma_f32_32x32x16_bf16 v[104:119], v[132:135], v[160:163], v[104:119]
    ds_read_b128 v[132:135], v175 offset:2560
    v_exp_f32 v54, v54
    v_exp_f32 v55, v55
    v_cvt_pk_bf16_f32 v80, v48, v49
    v_cvt_pk_bf16_f32 v81, v50, v51
    v_cvt_pk_bf16_f32 v82, v52, v53
    v_cvt_pk_bf16_f32 v83, v54, v55
    v_exp_f32 v56, v56
    v_exp_f32 v57, v57
    v_exp_f32 v58, v58
    v_exp_f32 v59, v59
    v_exp_f32 v60, v60
    v_exp_f32 v61, v61
    v_exp_f32 v62, v62
    v_exp_f32 v63, v63
    v_cvt_pk_bf16_f32 v84, v56, v57
    v_cvt_pk_bf16_f32 v85, v58, v59
    v_cvt_pk_bf16_f32 v86, v60, v61
    v_cvt_pk_bf16_f32 v87, v62, v63
    v_mfma_f32_32x32x16_bf16 v[48:63], v[120:123], v[8:11], v[16:31]
    s_waitcnt lgkmcnt(0)
    v_exp_f32 v64, v64
    v_readlane_b32 s9, v128, 58
    v_exp_f32 v65, v65
    v_exp_f32 v66, v66
    v_mfma_f32_32x32x16_bf16 v[88:103], v[136:139], v[80:83], v[88:103]
    s_cmp_lt_u32 s9, 4
    v_exp_f32 v67, v67
    v_exp_f32 v68, v68
    v_exp_f32 v69, v69
    v_mfma_f32_32x32x16_bf16 v[88:103], v[140:143], v[84:87], v[88:103]
    s_cbranch_scc1 a_ck13
a_cb13:
    v_exp_f32 v70, v70
    v_exp_f32 v71, v71
    v_cvt_pk_bf16_f32 v156, v64, v65
    v_cvt_pk_bf16_f32 v157, v66, v67
    v_cvt_pk_bf16_f32 v158, v68, v69
    v_cvt_pk_bf16_f32 v159, v70, v71
    v_exp_f32 v72, v72
    v_exp_f32 v73, v73
    v_exp_f32 v74, v74
    v_exp_f32 v75, v75
    v_exp_f32 v76, v76
    v_exp_f32 v77, v77
    v_exp_f32 v78, v78
    v_exp_f32 v79, v79
    v_cvt_pk_bf16_f32 v160, v72, v73
    v_cvt_pk_bf16_f32 v161, v74, v75
    v_cvt_pk_bf16_f32 v162, v76, v77
    v_cvt_pk_bf16_f32 v163, v78, v79
    v_mfma_f32_32x32x16_bf16 v[64:79], v[120:123], v[12:15], v[32:47]
    ds_read_b128 v[120:123], v168 offset:0
    v_exp_f32 v48, v48
    v_exp_f32 v49, v49
    v_exp_f32 v50, v50
    v_mfma_f32_32x32x16_bf16 v[104:119], v[136:139], v[156:159], v[104:119]
    ds_read_b128 v[136:139], v175 offset:3072
    v_exp_f32 v51, v51
    v_exp_f32 v52, v52
    v_exp_f32 v53, v53
    v_mfma_f32_32x32x16_bf16 v[104:119], v[140:143], v[160:163], v[104:119]
    ds_read_b128 v[140:143], v175 offset:3584
    v_exp_f32 v54, v54
    v_exp_f32 v55, v55
    v_cvt_pk_bf16_f32 v80, v48, v49
    v_cvt_pk_bf16_f32 v81, v50, v51
    v_cvt_pk_bf16_f32 v82, v52, v53
    v_cvt_pk_bf16_f32 v83, v54, v55
    v_exp_f32 v56, v56
    v_exp_f32 v57, v57
    v_exp_f32 v58, v58
    v_exp_f32 v59, v59
    v_exp_f32 v60, v60
    v_exp_f32 v61, v61
    v_exp_f32 v62, v62
    v_exp_f32 v63, v63
    v_cvt_pk_bf16_f32 v84, v56, v57
    v_cvt_pk_bf16_f32 v85, v58, v59
    v_cvt_pk_bf16_f32 v86, v60, v61
    v_cvt_pk_bf16_f32 v87, v62, v63
    v_mfma_f32_32x32x16_bf16 v[48:63], v[124:127], v[8:11], v[16:31]
a_pad1:
    s_cbranch_execz a_ret0
    v_exp_f32 v64, v64
    v_exp_f32 v65, v65
    v_exp_f32 v66, v66
    v_mfma_f32_32x32x16_bf16 v[88:103], v[128:131], v[80:83], v[88:103]
    v_exp_f32 v67, v67
    v_exp_f32 v68, v68
    v_exp_f32 v69, v69
    v_mfma_f32_32x32x16_bf16 v[88:103], v[132:135], v[84:87], v[88:103]
    s_waitcnt lgkmcnt(0)
    v_exp_f32 v70, v70
    v_exp_f32 v71, v71
    v_cvt_pk_bf16_f32 v156, v64, v65
    v_cvt_pk_bf16_f32 v157, v66, v67
    v_cvt_pk_bf16_f32 v158, v68, v69
    v_cvt_pk_bf16_f32 v159, v70, v71
    v_exp_f32 v72, v72
    v_exp_f32 v73, v73
    v_exp_f32 v74, v74
    v_exp_f32 v75, v75
    v_exp_f32 v76, v76
    v_exp_f32 v77, v77
    v_exp_f32 v78, v78
    v_exp_f32 v79, v79
    v_cvt_pk_bf16_f32 v160, v72, v73
    v_cvt_pk_bf16_f32 v161, v74, v75
    v_cvt_pk_bf16_f32 v162, v76, v77
    v_cvt_pk_bf16_f32 v163, v78, v79
    v_mfma_f32_32x32x16_bf16 v[64:79], v[124:127], v[12:15], v[32:47]
    ds_read_b128 v[124:127], v168 offset:1024
    v_exp_f32 v48, v48
    v_exp_f32 v49, v49
    v_exp_f32 v50, v50
    v_mfma_f32_32x32x16_bf16 v[104:119], v[128:131], v[156:159], v[104:119]
    ds_read_b128 v[128:131], v176 offset:0
    v_exp_f32 v51, v51
    v_exp_f32 v52, v52
    v_exp_f32 v53, v53
    v_mfma_f32_32x32x16_bf16 v[104:119], v[132:135], v[160:163], v[104:119]
    ds_read_b128 v[132:135], v176 offset:512
    v_exp_f32 v54, v54
    v_exp_f32 v55, v55
    v_cvt_pk_bf16_f32 v80, v48, v49
    v_cvt_pk_bf16_f32 v81, v50, v51
    v_cvt_pk_bf16_f32 v82, v52, v53
    v_cvt_pk_bf16_f32 v83, v54, v55
    v_exp_f32 v56, v56
    v_exp_f32 v57, v57
    v_exp_f32 v58, v58
    v_exp_f32 v59, v59
    v_exp_f32 v60, v60
    v_exp_f32 v61, v61
    v_exp_f32 v62, v62
    v_exp_f32 v63, v63
    v_cvt_pk_bf16_f32 v84, v56, v57
    v_cvt_pk_bf16_f32 v85, v58, v59
    v_cvt_pk_bf16_f32 v86, v60, v61
    v_cvt_pk_bf16_f32 v87, v62, v63
    v_mfma_f32_32x32x16_bf16 v[48:63], v[120:123], v[8:11], v[16:31]
    v_exp_f32 v64, v64
    v_exp_f32 v65, v65
    v_exp_f32 v66, v66
    v_mfma_f32_32x32x16_bf16 v[88:103], v[136:139], v[80:83], v[88:103]
    v_exp_f32 v67, v67
    v_exp_f32 v68, v68
    v_exp_f32 v69, v69
    v_mfma_f32_32x32x16_bf16 v[88:103], v[140:143], v[84:87], v[88:103]
    s_waitcnt lgkmcnt(0)
    v_exp_f32 v70, v70
    v_exp_f32 v71, v71
    v_cvt_pk_bf16_f32 v156, v64, v65
    v_cvt_pk_bf16_f32 v157, v66, v67
    v_cvt_pk_bf16_f32 v158, v68, v69
    v_cvt_pk_bf16_f32 v159, v70, v71
    v_exp_f32 v72, v72
    v_exp_f32 v73, v73
    v_exp_f32 v74, v74
    v_exp_f32 v75, v75
    v_exp_f32 v76, v76
    v_exp_f32 v77, v77
    v_exp_f32 v78, v78
    v_exp_f32 v79, v79
    v_cvt_pk_bf16_f32 v160, v72, v73
    v_cvt_pk_bf16_f32 v161, v74, v75
    v_cvt_pk_bf16_f32 v162, v76, v77
    v_cvt_pk_bf16_f32 v163, v78, v79
    v_mfma_f32_32x32x16_bf16 v[64:79], v[120:123], v[12:15], v[32:47]
    ds_read_b128 v[120:123], v168 offset:2048
    v_exp_f32 v48, v48
    v_exp_f32 v49, v49
    v_exp_f32 v50, v50
    v_mfma_f32_32x32x16_bf16 v[104:119], v[136:139], v[156:159], v[104:119]
    ds_read_b128 v[136:139], v176 offset:1024
    v_exp_f32 v51, v51
    v_exp_f32 v52, v52
    v_exp_f32 v53, v53
    v_mfma_f32_32x32x16_bf16 v[104:119], v[140:143], v[160:163], v[104:119]
    ds_read_b128 v[140:143], v176 offset:1536
    v_exp_f32 v54, v54
    v_exp_f32 v55, v55
    v_cvt_pk_bf16_f32 v80, v48, v49
    v_cvt_pk_bf16_f32 v81, v50, v51
    v_cvt_pk_bf16_f32 v82, v52, v53
    v_cvt_pk_bf16_f32 v83, v54, v55
    v_exp_f32 v56, v56
    v_exp_f32 v57, v57
    v_exp_f32 v58, v58
    v_exp_f32 v59, v59
    v_exp_f32 v60, v60
    v_exp_f32 v61, v61
    v_exp_f32 v62, v62
    v_exp_f32 v63, v63
    v_cvt_pk_bf16_f32 v84, v56, v57
    v_cvt_pk_bf16_f32 v85, v58, v59
    v_cvt_pk_bf16_f32 v86, v60, v61
    v_cvt_pk_bf16_f32 v87, v62, v63
    v_mfma_f32_32x32x16_bf16 v[48:63], v[124:127], v[8:11], v[16:31]
    v_exp_f32 v64, v64
    v_exp_f32 v65, v65
    v_exp_f32 v66, v66
    v_mfma_f32_32x32x16_bf16 v[88:103], v[128:131], v[80:83], v[88:103]
    v_exp_f32 v67, v67
    v_exp_f32 v68, v68
    v_exp_f32 v69, v69
    v_mfma_f32_32x32x16_bf16 v[88:103], v[132:135], v[84:87], v[88:103]
    s_waitcnt lgkmcnt(0)
    v_exp_f32 v70, v70
    v_exp_f32 v71, v71
    v_cvt_pk_bf16_f32 v156, v64, v65
    v_cvt_pk_bf16_f32 v157, v66, v67
    v_cvt_pk_bf16_f32 v158, v68, v69
    v_cvt_pk_bf16_f32 v159, v70, v71
    v_exp_f32 v72, v72
    v_exp_f32 v73, v73
    v_exp_f32 v74, v74
    v_exp_f32 v75, v75
    v_exp_f32 v76, v76
    v_exp_f32 v77, v77
    v_exp_f32 v78, v78
    v_exp_f32 v79, v79
    v_cvt_pk_bf16_f32 v160, v72, v73
    v_cvt_pk_bf16_f32 v161, v74, v75
    v_cvt_pk_bf16_f32 v162, v76, v77
    v_cvt_pk_bf16_f32 v163, v78, v79
    v_mfma_f32_32x32x16_bf16 v[64:79], v[124:127], v[12:15], v[32:47]
    ds_read_b128 v[124:127], v168 offset:3072
    v_exp_f32 v48, v48
    v_exp_f32 v49, v49
    v_exp_f32 v50, v50
    v_mfma_f32_32x32x16_bf16 v[104:119], v[128:131], v[156:159], v[104:119]
    ds_read_b128 v[128:131], v176 offset:2048
    v_exp_f32 v51, v51
    v_exp_f32 v52, v52
    v_exp_f32 v53, v53
    v_mfma_f32_32x32x16_bf16 v[104:119], v[132:135], v[160:163], v[104:119]
    ds_read_b128 v[132:135], v176 offset:2560
    v_exp_f32 v54, v54
    v_exp_f32 v55, v55
    v_cvt_pk_bf16_f32 v80, v48, v49
    v_cvt_pk_bf16_f32 v81, v50, v51
    v_cvt_pk_bf16_f32 v82, v52, v53
    v_cvt_pk_bf16_f32 v83, v54, v55
    v_exp_f32 v56, v56
    v_exp_f32 v57, v57
    v_exp_f32 v58, v58
    v_exp_f32 v59, v59
    v_exp_f32 v60, v60
    v_exp_f32 v61, v61
    v_exp_f32 v62, v62
    v_exp_f32 v63, v63
    v_cvt_pk_bf16_f32 v84, v56, v57
    v_cvt_pk_bf16_f32 v85, v58, v59
    v_cvt_pk_bf16_f32 v86, v60, v61
    v_cvt_pk_bf16_f32 v87, v62, v63
    v_mfma_f32_32x32x16_bf16 v[48:63], v[120:123], v[8:11], v[16:31]
    v_exp_f32 v64, v64
    v_exp_f32 v65, v65
    v_exp_f32 v66, v66
    v_mfma_f32_32x32x16_bf16 v[88:103], v[136:139], v[80:83], v[88:103]
    v_exp_f32 v67, v67
    v_exp_f32 v68, v68
    v_exp_f32 v69, v69
    v_mfma_f32_32x32x16_bf16 v[88:103], v[140:143], v[84:87], v[88:103]
    s_waitcnt lgkmcnt(0)
    v_exp_f32 v70, v70
    v_exp_f32 v71, v71
    v_cvt_pk_bf16_f32 v156, v64, v65
    v_cvt_pk_bf16_f32 v157, v66, v67
    v_cvt_pk_bf16_f32 v158, v68, v69
    v_cvt_pk_bf16_f32 v159, v70, v71
    v_exp_f32 v72, v72
    v_exp_f32 v73, v73
    v_exp_f32 v74, v74
    v_exp_f32 v75, v75
    v_exp_f32 v76, v76
    v_exp_f32 v77, v77
    v_exp_f32 v78, v78
    v_exp_f32 v79, v79
    v_cvt_pk_bf16_f32 v160, v72, v73
    v_cvt_pk_bf16_f32 v161, v74, v75
    v_cvt_pk_bf16_f32 v162, v76, v77
    v_cvt_pk_bf16_f32 v163, v78, v79
    v_mfma_f32_32x32x16_bf16 v[64:79], v[120:123], v[12:15], v[32:47]
    ds_read_b128 v[120:123], v169 offset:0
    v_exp_f32 v48, v48
    v_exp_f32 v49, v49
    v_exp_f32 v50, v50
    v_mfma_f32_32x32x16_bf16 v[104:119], v[136:139], v[156:159], v[104:119]
    ds_read_b128 v[136:139], v176 offset:3072
    v_exp_f32 v51, v51
    v_exp_f32 v52, v52
    v_exp_f32 v53, v53
    v_mfma_f32_32x32x16_bf16 v[104:119], v[140:143], v[160:163], v[104:119]
    ds_read_b128 v[140:143], v176 offset:3584
    v_exp_f32 v54, v54
    v_exp_f32 v55, v55
    v_cvt_pk_bf16_f32 v80, v48, v49
    v_cvt_pk_bf16_f32 v81, v50, v51
    v_cvt_pk_bf16_f32 v82, v52, v53
    v_cvt_pk_bf16_f32 v83, v54, v55
    v_exp_f32 v56, v56
    v_exp_f32 v57, v57
    v_exp_f32 v58, v58
    v_exp_f32 v59, v59
    v_exp_f32 v60, v60
    v_exp_f32 v61, v61
    v_exp_f32 v62, v62
    v_exp_f32 v63, v63
    v_cvt_pk_bf16_f32 v84, v56, v57
    v_cvt_pk_bf16_f32 v85, v58, v59
    v_cvt_pk_bf16_f32 v86, v60, v61
    v_cvt_pk_bf16_f32 v87, v62, v63
    v_mfma_f32_32x32x16_bf16 v[48:63], v[124:127], v[8:11], v[16:31]
    v_exp_f32 v64, v64
    v_exp_f32 v65, v65
    v_exp_f32 v66, v66
    v_mfma_f32_32x32x16_bf16 v[88:103], v[128:131], v[80:83], v[88:103]
    v_exp_f32 v67, v67
    v_exp_f32 v68, v68
    v_exp_f32 v69, v69
    v_mfma_f32_32x32x16_bf16 v[88:103], v[132:135], v[84:87], v[88:103]
    s_waitcnt lgkmcnt(0)
    v_exp_f32 v70, v70
    v_exp_f32 v71, v71
    v_cvt_pk_bf16_f32 v156, v64, v65
    v_cvt_pk_bf16_f32 v157, v66, v67
    v_cvt_pk_bf16_f32 v158, v68, v69
    v_cvt_pk_bf16_f32 v159, v70, v71
    v_exp_f32 v72, v72
    v_exp_f32 v73, v73
    v_exp_f32 v74, v74
    v_exp_f32 v75, v75
    v_exp_f32 v76, v76
    v_exp_f32 v77, v77
    v_exp_f32 v78, v78
    v_exp_f32 v79, v79
    v_cvt_pk_bf16_f32 v160, v72, v73
    v_cvt_pk_bf16_f32 v161, v74, v75
    v_cvt_pk_bf16_f32 v162, v76, v77
    v_cvt_pk_bf16_f32 v163, v78, v79
    v_mfma_f32_32x32x16_bf16 v[64:79], v[124:127], v[12:15], v[32:47]
    ds_read_b128 v[124:127], v169 offset:1024
    v_exp_f32 v48, v48
    v_exp_f32 v49, v49
    v_exp_f32 v50, v50
    v_mfma_f32_32x32x16_bf16 v[104:119], v[128:131], v[156:159], v[104:119]
    ds_read_b128 v[128:131], v177 offset:0
    v_exp_f32 v51, v51
    v_exp_f32 v52, v52
    v_exp_f32 v53, v53
    v_mfma_f32_32x32x16_bf16 v[104:119], v[132:135], v[160:163], v[104:119]
    ds_read_b128 v[132:135], v177 offset:512
    v_exp_f32 v54, v54
    v_exp_f32 v55, v55
    v_cvt_pk_bf16_f32 v80, v48, v49
    v_cvt_pk_bf16_f32 v81, v50, v51
    v_cvt_pk_bf16_f32 v82, v52, v53
    v_cvt_pk_bf16_f32 v83, v54, v55
    v_exp_f32 v56, v56
    v_exp_f32 v57, v57
    v_exp_f32 v58, v58
    v_exp_f32 v59, v59
    v_exp_f32 v60, v60
    v_exp_f32 v61, v61
    v_exp_f32 v62, v62
    v_exp_f32 v63, v63
    v_cvt_pk_bf16_f32 v84, v56, v57
    v_cvt_pk_bf16_f32 v85, v58, v59
    v_cvt_pk_bf16_f32 v86, v60, v61
    v_cvt_pk_bf16_f32 v87, v62, v63
    v_mfma_f32_32x32x16_bf16 v[48:63], v[120:123], v[8:11], v[16:31]
    v_exp_f32 v64, v64
    v_exp_f32 v65, v65
    v_exp_f32 v66, v66
    v_mfma_f32_32x32x16_bf16 v[88:103], v[136:139], v[80:83], v[88:103]
    v_exp_f32 v67, v67
    v_exp_f32 v68, v68
    v_exp_f32 v69, v69
    v_mfma_f32_32x32x16_bf16 v[88:103], v[140:143], v[84:87], v[88:103]
    s_waitcnt lgkmcnt(0)
    v_exp_f32 v70, v70
    v_exp_f32 v71, v71
    v_cvt_pk_bf16_f32 v156, v64, v65
    v_cvt_pk_bf16_f32 v157, v66, v67
    v_cvt_pk_bf16_f32 v158, v68, v69
    v_cvt_pk_bf16_f32 v159, v70, v71
    v_exp_f32 v72, v72
    v_exp_f32 v73, v73
    v_exp_f32 v74, v74
    v_exp_f32 v75, v75
    v_exp_f32 v76, v76
    v_exp_f32 v77, v77
    v_exp_f32 v78, v78
    v_exp_f32 v79, v79
    v_cvt_pk_bf16_f32 v160, v72, v73
    v_cvt_pk_bf16_f32 v161, v74, v75
    v_cvt_pk_bf16_f32 v162, v76, v77
    v_cvt_pk_bf16_f32 v163, v78, v79
    v_mfma_f32_32x32x16_bf16 v[64:79], v[120:123], v[12:15], v[32:47]
    ds_read_b128 v[120:123], v169 offset:2048
    v_exp_f32 v48, v48
    v_exp_f32 v49, v49
    v_exp_f32 v50, v50
    v_mfma_f32_32x32x16_bf16 v[104:119], v[136:139], v[156:159], v[104:119]
    ds_read_b128 v[136:139], v177 offset:1024
    v_exp_f32 v51, v51
    v_exp_f32 v52, v52
    v_exp_f32 v53, v53
    v_mfma_f32_32x32x16_bf16 v[104:119], v[140:143], v[160:163], v[104:119]
    ds_read_b128 v[140:143], v177 offset:1536
    v_exp_f32 v54, v54
    v_exp_f32 v55, v55
    v_cvt_pk_bf16_f32 v80, v48, v49
    v_cvt_pk_bf16_f32 v81, v50, v51
    v_cvt_pk_bf16_f32 v82, v52, v53
    v_cvt_pk_bf16_f32 v83, v54, v55
    v_exp_f32 v56, v56
    v_exp_f32 v57, v57
    v_exp_f32 v58, v58
    v_exp_f32 v59, v59
    v_exp_f32 v60, v60
    v_exp_f32 v61, v61
    v_exp_f32 v62, v62
    v_exp_f32 v63, v63
    v_cvt_pk_bf16_f32 v84, v56, v57
    v_cvt_pk_bf16_f32 v85, v58, v59
    v_cvt_pk_bf16_f32 v86, v60, v61
    v_cvt_pk_bf16_f32 v87, v62, v63
    v_mfma_f32_32x32x16_bf16 v[48:63], v[124:127], v[8:11], v[16:31]
    v_exp_f32 v64, v64
    v_exp_f32 v65, v65
    v_exp_f32 v66, v66
    v_mfma_f32_32x32x16_bf16 v[88:103], v[128:131], v[80:83], v[88:103]
    v_exp_f32 v67, v67
    v_exp_f32 v68, v68
    v_exp_f32 v69, v69
    v_mfma_f32_32x32x16_bf16 v[88:103], v[132:135], v[84:87], v[88:103]
    s_waitcnt lgkmcnt(0)
    v_exp_f32 v70, v70
    v_exp_f32 v71, v71
    v_cvt_pk_bf16_f32 v156, v64, v65
    v_cvt_pk_bf16_f32 v157, v66, v67
    v_cvt_pk_bf16_f32 v158, v68, v69
    v_cvt_pk_bf16_f32 v159, v70, v71
    v_exp_f32 v72, v72
    v_exp_f32 v73, v73
    v_exp_f32 v74, v74
    v_exp_f32 v75, v75
    v_exp_f32 v76, v76
    v_exp_f32 v77, v77
    v_exp_f32 v78, v78
    v_exp_f32 v79, v79
    v_cvt_pk_bf16_f32 v160, v72, v73
    v_cvt_pk_bf16_f32 v161, v74, v75
    v_cvt_pk_bf16_f32 v162, v76, v77
    v_cvt_pk_bf16_f32 v163, v78, v79
    v_mfma_f32_32x32x16_bf16 v[64:79], v[124:127], v[12:15], v[32:47]
    ds_read_b128 v[124:127], v169 offset:3072
    v_exp_f32 v48, v48
    v_exp_f32 v49, v49
    v_exp_f32 v50, v50
    v_mfma_f32_32x32x16_bf16 v[104:119], v[128:131], v[156:159], v[104:119]
    ds_read_b128 v[128:131], v177 offset:2048
    v_exp_f32 v51, v51
    v_exp_f32 v52, v52
    v_exp_f32 v53, v53
    v_mfma_f32_32x32x16_bf16 v[104:119], v[132:135], v[160:163], v[104:119]
    ds_read_b128 v[132:135], v177 offset:2560
    v_exp_f32 v54, v54
    v_exp_f32 v55, v55
    v_cvt_pk_bf16_f32 v80, v48, v49
    v_cvt_pk_bf16_f32 v81, v50, v51
    v_cvt_pk_bf16_f32 v82, v52, v53
    v_cvt_pk_bf16_f32 v83, v54, v55
    v_exp_f32 v56, v56
    v_exp_f32 v57, v57
    v_exp_f32 v58, v58
    v_exp_f32 v59, v59
    v_exp_f32 v60, v60
    v_exp_f32 v61, v61
    v_exp_f32 v62, v62
    v_exp_f32 v63, v63
    v_cvt_pk_bf16_f32 v84, v56, v57
    v_cvt_pk_bf16_f32 v85, v58, v59
    v_cvt_pk_bf16_f32 v86, v60, v61
    v_cvt_pk_bf16_f32 v87, v62, v63
    v_mfma_f32_32x32x16_bf16 v[48:63], v[120:123], v[8:11], v[16:31]
    v_exp_f32 v64, v64
    v_exp_f32 v65, v65
    v_exp_f32 v66, v66
    v_mfma_f32_32x32x16_bf16 v[88:103], v[136:139], v[80:83], v[88:103]
    v_exp_f32 v67, v67
    v_exp_f32 v68, v68
    v_exp_f32 v69, v69
    v_mfma_f32_32x32x16_bf16 v[88:103], v[140:143], v[84:87], v[88:103]
    s_waitcnt lgkmcnt(0)
    v_exp_f32 v70, v70
    v_exp_f32 v71, v71
    v_cvt_pk_bf16_f32 v156, v64, v65
    v_cvt_pk_bf16_f32 v157, v66, v67
    v_cvt_pk_bf16_f32 v158, v68, v69
    v_cvt_pk_bf16_f32 v159, v70, v71
    v_exp_f32 v72, v72
    v_exp_f32 v73, v73
    v_exp_f32 v74, v74
    v_exp_f32 v75, v75
    v_exp_f32 v76, v76
    v_exp_f32 v77, v77
    v_exp_f32 v78, v78
    v_exp_f32 v79, v79
    v_cvt_pk_bf16_f32 v160, v72, v73
    v_cvt_pk_bf16_f32 v161, v74, v75
    v_cvt_pk_bf16_f32 v162, v76, v77
    v_cvt_pk_bf16_f32 v163, v78, v79
    v_mfma_f32_32x32x16_bf16 v[64:79], v[120:123], v[12:15], v[32:47]
    ds_read_b128 v[120:123], v168 offset:16384
    v_exp_f32 v48, v48
    v_exp_f32 v49, v49
    v_exp_f32 v50, v50
    v_mfma_f32_32x32x16_bf16 v[104:119], v[136:139], v[156:159], v[104:119]
    ds_read_b128 v[136:139], v177 offset:3072
    v_exp_f32 v51, v51
    v_exp_f32 v52, v52
    v_exp_f32 v53, v53
    v_mfma_f32_32x32x16_bf16 v[104:119], v[140:143], v[160:163], v[104:119]
    ds_read_b128 v[140:143], v177 offset:3584
    v_exp_f32 v54, v54
    v_exp_f32 v55, v55
    v_cvt_pk_bf16_f32 v80, v48, v49
    v_cvt_pk_bf16_f32 v81, v50, v51
    v_cvt_pk_bf16_f32 v82, v52, v53
    v_cvt_pk_bf16_f32 v83, v54, v55
    v_exp_f32 v56, v56
    v_exp_f32 v57, v57
    v_exp_f32 v58, v58
    v_exp_f32 v59, v59
    v_exp_f32 v60, v60
    v_exp_f32 v61, v61
    v_exp_f32 v62, v62
    v_exp_f32 v63, v63
    v_cvt_pk_bf16_f32 v84, v56, v57
    v_cvt_pk_bf16_f32 v85, v58, v59
    v_cvt_pk_bf16_f32 v86, v60, v61
    v_cvt_pk_bf16_f32 v87, v62, v63
    v_mfma_f32_32x32x16_bf16 v[48:63], v[124:127], v[8:11], v[16:31]
    v_exp_f32 v64, v64
    v_exp_f32 v65, v65
    v_exp_f32 v66, v66
    v_mfma_f32_32x32x16_bf16 v[88:103], v[128:131], v[80:83], v[88:103]
    v_exp_f32 v67, v67
    v_exp_f32 v68, v68
    v_exp_f32 v69, v69
    v_mfma_f32_32x32x16_bf16 v[88:103], v[132:135], v[84:87], v[88:103]
    s_waitcnt lgkmcnt(0)
    v_exp_f32 v70, v70
    v_exp_f32 v71, v71
    v_cvt_pk_bf16_f32 v156, v64, v65
    v_cvt_pk_bf16_f32 v157, v66, v67
    v_cvt_pk_bf16_f32 v158, v68, v69
    v_cvt_pk_bf16_f32 v159, v70, v71
    v_exp_f32 v72, v72
    v_exp_f32 v73, v73
    v_exp_f32 v74, v74
    v_exp_f32 v75, v75
    v_exp_f32 v76, v76
    v_exp_f32 v77, v77
    v_exp_f32 v78, v78
    v_exp_f32 v79, v79
    v_cvt_pk_bf16_f32 v160, v72, v73
    v_cvt_pk_bf16_f32 v161, v74, v75
    v_cvt_pk_bf16_f32 v162, v76, v77
    v_cvt_pk_bf16_f32 v163, v78, v79
    v_mfma_f32_32x32x16_bf16 v[64:79], v[124:127], v[12:15], v[32:47]
    ds_read_b128 v[124:127], v168 offset:17408
    v_exp_f32 v48, v48
    v_exp_f32 v49, v49
    v_exp_f32 v50, v50
    v_mfma_f32_32x32x16_bf16 v[104:119], v[128:131], v[156:159], v[104:119]
    ds_read_b128 v[128:131], v178 offset:0
    v_exp_f32 v51, v51
    v_exp_f32 v52, v52
    v_exp_f32 v53, v53
    v_mfma_f32_32x32x16_bf16 v[104:119], v[132:135], v[160:163], v[104:119]
    ds_read_b128 v[132:135], v178 offset:512
    v_exp_f32 v54, v54
    v_exp_f32 v55, v55
    v_cvt_pk_bf16_f32 v80, v48, v49
    v_cvt_pk_bf16_f32 v81, v50, v51
    v_cvt_pk_bf16_f32 v82, v52, v53
    v_cvt_pk_bf16_f32 v83, v54, v55
    v_exp_f32 v56, v56
    v_exp_f32 v57, v57
    v_exp_f32 v58, v58
    v_exp_f32 v59, v59
    v_exp_f32 v60, v60
    v_exp_f32 v61, v61
    v_exp_f32 v62, v62
    v_exp_f32 v63, v63
    v_cvt_pk_bf16_f32 v84, v56, v57
    v_cvt_pk_bf16_f32 v85, v58, v59
    v_cvt_pk_bf16_f32 v86, v60, v61
    v_cvt_pk_bf16_f32 v87, v62, v63
    v_mfma_f32_32x32x16_bf16 v[48:63], v[120:123], v[8:11], v[16:31]
    v_exp_f32 v64, v64
    v_exp_f32 v65, v65
    v_exp_f32 v66, v66
    v_mfma_f32_32x32x16_bf16 v[88:103], v[136:139], v[80:83], v[88:103]
    v_exp_f32 v67, v67
    v_exp_f32 v68, v68
    v_exp_f32 v69, v69
    v_mfma_f32_32x32x16_bf16 v[88:103], v[140:143], v[84:87], v[88:103]
    s_waitcnt lgkmcnt(0)
    v_exp_f32 v70, v70
    v_exp_f32 v71, v71
    v_cvt_pk_bf16_f32 v156, v64, v65
    v_cvt_pk_bf16_f32 v157, v66, v67
    v_cvt_pk_bf16_f32 v158, v68, v69
    v_cvt_pk_bf16_f32 v159, v70, v71
    v_exp_f32 v72, v72
    v_exp_f32 v73, v73
    v_exp_f32 v74, v74
    v_exp_f32 v75, v75
    v_exp_f32 v76, v76
    v_exp_f32 v77, v77
    v_exp_f32 v78, v78
    v_exp_f32 v79, v79
    v_cvt_pk_bf16_f32 v160, v72, v73
    v_cvt_pk_bf16_f32 v161, v74, v75
    v_cvt_pk_bf16_f32 v162, v76, v77
    v_cvt_pk_bf16_f32 v163, v78, v79
    v_mfma_f32_32x32x16_bf16 v[64:79], v[120:123], v[12:15], v[32:47]
    ds_read_b128 v[120:123], v168 offset:18432
    v_exp_f32 v48, v48
    v_exp_f32 v49, v49
    v_exp_f32 v50, v50
    v_mfma_f32_32x32x16_bf16 v[104:119], v[136:139], v[156:159], v[104:119]
    ds_read_b128 v[136:139], v178 offset:1024
    v_exp_f32 v51, v51
    v_exp_f32 v52, v52
    v_exp_f32 v53, v53
    v_mfma_f32_32x32x16_bf16 v[104:119], v[140:143], v[160:163], v[104:119]
    ds_read_b128 v[140:143], v178 offset:1536
    v_exp_f32 v54, v54
    v_exp_f32 v55, v55
    v_cvt_pk_bf16_f32 v80, v48, v49
    v_cvt_pk_bf16_f32 v81, v50, v51
    v_cvt_pk_bf16_f32 v82, v52, v53
    v_cvt_pk_bf16_f32 v83, v54, v55
    v_exp_f32 v56, v56
    v_exp_f32 v57, v57
    v_exp_f32 v58, v58
    v_exp_f32 v59, v59
    v_exp_f32 v60, v60
    v_exp_f32 v61, v61
    v_exp_f32 v62, v62
    v_exp_f32 v63, v63
    v_cvt_pk_bf16_f32 v84, v56, v57
    v_cvt_pk_bf16_f32 v85, v58, v59
    v_cvt_pk_bf16_f32 v86, v60, v61
    v_cvt_pk_bf16_f32 v87, v62, v63
    v_mfma_f32_32x32x16_bf16 v[48:63], v[124:127], v[8:11], v[16:31]
    v_exp_f32 v64, v64
    v_exp_f32 v65, v65
    v_exp_f32 v66, v66
    v_mfma_f32_32x32x16_bf16 v[88:103], v[128:131], v[80:83], v[88:103]
    v_exp_f32 v67, v67
    v_exp_f32 v68, v68
    v_exp_f32 v69, v69
    v_mfma_f32_32x32x16_bf16 v[88:103], v[132:135], v[84:87], v[88:103]
    s_waitcnt lgkmcnt(0)
    v_exp_f32 v70, v70
    v_exp_f32 v71, v71
    v_cvt_pk_bf16_f32 v156, v64, v65
    v_cvt_pk_bf16_f32 v157, v66, v67
    v_cvt_pk_bf16_f32 v158, v68, v69
    v_cvt_pk_bf16_f32 v159, v70, v71
    v_exp_f32 v72, v72
    v_exp_f32 v73, v73
    v_exp_f32 v74, v74
    v_exp_f32 v75, v75
    v_exp_f32 v76, v76
    v_exp_f32 v77, v77
    v_exp_f32 v78, v78
    v_exp_f32 v79, v79
    v_cvt_pk_bf16_f32 v160, v72, v73
    v_cvt_pk_bf16_f32 v161, v74, v75
    v_cvt_pk_bf16_f32 v162, v76, v77
    v_cvt_pk_bf16_f32 v163, v78, v79
    v_mfma_f32_32x32x16_bf16 v[64:79], v[124:127], v[12:15], v[32:47]
    ds_read_b128 v[124:127], v168 offset:19456
    v_exp_f32 v48, v48
    v_exp_f32 v49, v49
    v_exp_f32 v50, v50
    v_mfma_f32_32x32x16_bf16 v[104:119], v[128:131], v[156:159], v[104:119]
    ds_read_b128 v[128:131], v178 offset:2048
    v_exp_f32 v51, v51
    v_exp_f32 v52, v52
    v_exp_f32 v53, v53
    v_mfma_f32_32x32x16_bf16 v[104:119], v[132:135], v[160:163], v[104:119]
    ds_read_b128 v[132:135], v178 offset:2560
    v_exp_f32 v54, v54
    v_exp_f32 v55, v55
    v_cvt_pk_bf16_f32 v80, v48, v49
    v_cvt_pk_bf16_f32 v81, v50, v51
    v_cvt_pk_bf16_f32 v82, v52, v53
    v_cvt_pk_bf16_f32 v83, v54, v55
    v_exp_f32 v56, v56
    v_exp_f32 v57, v57
    v_exp_f32 v58, v58
    v_exp_f32 v59, v59
    v_exp_f32 v60, v60
    v_exp_f32 v61, v61
    v_exp_f32 v62, v62
    v_exp_f32 v63, v63
    v_cvt_pk_bf16_f32 v84, v56, v57
    v_cvt_pk_bf16_f32 v85, v58, v59
    v_cvt_pk_bf16_f32 v86, v60, v61
    v_cvt_pk_bf16_f32 v87, v62, v63
    v_mfma_f32_32x32x16_bf16 v[48:63], v[120:123], v[8:11], v[16:31]
    v_exp_f32 v64, v64
    v_exp_f32 v65, v65
    v_exp_f32 v66, v66
    v_mfma_f32_32x32x16_bf16 v[88:103], v[136:139], v[80:83], v[88:103]
    v_exp_f32 v67, v67
    v_exp_f32 v68, v68
    v_exp_f32 v69, v69
    v_mfma_f32_32x32x16_bf16 v[88:103], v[140:143], v[84:87], v[88:103]
    s_waitcnt lgkmcnt(0)
    v_exp_f32 v70, v70
    v_exp_f32 v71, v71
    v_cvt_pk_bf16_f32 v156, v64, v65
    v_cvt_pk_bf16_f32 v157, v66, v67
    v_cvt_pk_bf16_f32 v158, v68, v69
    v_cvt_pk_bf16_f32 v159, v70, v71
    v_exp_f32 v72, v72
    v_exp_f32 v73, v73
    v_exp_f32 v74, v74
    v_exp_f32 v75, v75
    v_exp_f32 v76, v76
    v_exp_f32 v77, v77
    v_exp_f32 v78, v78
    v_exp_f32 v79, v79
    v_cvt_pk_bf16_f32 v160, v72, v73
    v_cvt_pk_bf16_f32 v161, v74, v75
    v_cvt_pk_bf16_f32 v162, v76, v77
    v_cvt_pk_bf16_f32 v163, v78, v79
    v_mfma_f32_32x32x16_bf16 v[64:79], v[120:123], v[12:15], v[32:47]
    ds_read_b128 v[120:123], v169 offset:16384
    v_exp_f32 v48, v48
    v_exp_f32 v49, v49
    v_exp_f32 v50, v50
    v_mfma_f32_32x32x16_bf16 v[104:119], v[136:139], v[156:159], v[104:119]
    ds_read_b128 v[136:139], v178 offset:3072
    v_exp_f32 v51, v51
    v_exp_f32 v52, v52
    v_exp_f32 v53, v53
    v_mfma_f32_32x32x16_bf16 v[104:119], v[140:143], v[160:163], v[104:119]
    ds_read_b128 v[140:143], v178 offset:3584
    v_exp_f32 v54, v54
    v_exp_f32 v55, v55
    v_cvt_pk_bf16_f32 v80, v48, v49
    v_cvt_pk_bf16_f32 v81, v50, v51
    v_cvt_pk_bf16_f32 v82, v52, v53
    v_cvt_pk_bf16_f32 v83, v54, v55
    v_exp_f32 v56, v56
    v_exp_f32 v57, v57
    v_exp_f32 v58, v58
    v_exp_f32 v59, v59
    v_exp_f32 v60, v60
    v_exp_f32 v61, v61
    v_exp_f32 v62, v62
    v_exp_f32 v63, v63
    v_cvt_pk_bf16_f32 v84, v56, v57
    v_cvt_pk_bf16_f32 v85, v58, v59
    v_cvt_pk_bf16_f32 v86, v60, v61
    v_cvt_pk_bf16_f32 v87, v62, v63
    v_mfma_f32_32x32x16_bf16 v[48:63], v[124:127], v[8:11], v[16:31]
    v_exp_f32 v64, v64
    v_exp_f32 v65, v65
    v_exp_f32 v66, v66
    v_mfma_f32_32x32x16_bf16 v[88:103], v[128:131], v[80:83], v[88:103]
    v_exp_f32 v67, v67
    v_exp_f32 v68, v68
    v_exp_f32 v69, v69
    v_mfma_f32_32x32x16_bf16 v[88:103], v[132:135], v[84:87], v[88:103]
    s_waitcnt lgkmcnt(0)
    v_exp_f32 v70, v70
    v_exp_f32 v71, v71
    v_cvt_pk_bf16_f32 v156, v64, v65
a_pad2:
    s_cbranch_execz a_ret0
    v_cvt_pk_bf16_f32 v157, v66, v67
    v_cvt_pk_bf16_f32 v158, v68, v69
    v_cvt_pk_bf16_f32 v159, v70, v71
    v_exp_f32 v72, v72
    v_exp_f32 v73, v73
    v_exp_f32 v74, v74
    v_exp_f32 v75, v75
    v_exp_f32 v76, v76
    v_exp_f32 v77, v77
    v_exp_f32 v78, v78
    v_exp_f32 v79, v79
    v_cvt_pk_bf16_f32 v160, v72, v73
    v_cvt_pk_bf16_f32 v161, v74, v75
    v_cvt_pk_bf16_f32 v162, v76, v77
    v_cvt_pk_bf16_f32 v163, v78, v79
    v_mfma_f32_32x32x16_bf16 v[64:79], v[124:127], v[12:15], v[32:47]
    ds_read_b128 v[124:127], v169 offset:17408
    v_exp_f32 v48, v48
    v_exp_f32 v49, v49
    v_exp_f32 v50, v50
    v_mfma_f32_32x32x16_bf16 v[104:119], v[128:131], v[156:159], v[104:119]
    ds_read_b128 v[128:131], v179 offset:0
    v_exp_f32 v51, v51
    v_exp_f32 v52, v52
    v_exp_f32 v53, v53
    v_mfma_f32_32x32x16_bf16 v[104:119], v[132:135], v[160:163], v[104:119]
    ds_read_b128 v[132:135], v179 offset:512
    v_exp_f32 v54, v54
    v_exp_f32 v55, v55
    v_cvt_pk_bf16_f32 v80, v48, v49
    v_cvt_pk_bf16_f32 v81, v50, v51
    v_cvt_pk_bf16_f32 v82, v52, v53
    v_cvt_pk_bf16_f32 v83, v54, v55
    v_exp_f32 v56, v56
    v_exp_f32 v57, v57
    v_exp_f32 v58, v58
    v_exp_f32 v59, v59
    v_exp_f32 v60, v60
    v_exp_f32 v61, v61
    v_exp_f32 v62, v62
    v_exp_f32 v63, v63
    v_cvt_pk_bf16_f32 v84, v56, v57
    v_cvt_pk_bf16_f32 v85, v58, v59
    v_cvt_pk_bf16_f32 v86, v60, v61
    v_cvt_pk_bf16_f32 v87, v62, v63
    v_mfma_f32_32x32x16_bf16 v[48:63], v[120:123], v[8:11], v[16:31]
    v_exp_f32 v64, v64
    v_exp_f32 v65, v65
    v_exp_f32 v66, v66
    v_mfma_f32_32x32x16_bf16 v[88:103], v[136:139], v[80:83], v[88:103]
    v_exp_f32 v67, v67
    v_exp_f32 v68, v68
    v_exp_f32 v69, v69
    v_mfma_f32_32x32x16_bf16 v[88:103], v[140:143], v[84:87], v[88:103]
    s_waitcnt lgkmcnt(0)
    v_exp_f32 v70, v70
    v_exp_f32 v71, v71
    v_cvt_pk_bf16_f32 v156, v64, v65
    v_cvt_pk_bf16_f32 v157, v66, v67
    v_cvt_pk_bf16_f32 v158, v68, v69
    v_cvt_pk_bf16_f32 v159, v70, v71
    v_exp_f32 v72, v72
    v_exp_f32 v73, v73
    v_exp_f32 v74, v74
    v_exp_f32 v75, v75
    v_exp_f32 v76, v76
    v_exp_f32 v77, v77
    v_exp_f32 v78, v78
    v_exp_f32 v79, v79
    v_cvt_pk_bf16_f32 v160, v72, v73
    v_cvt_pk_bf16_f32 v161, v74, v75
    v_cvt_pk_bf16_f32 v162, v76, v77
    v_cvt_pk_bf16_f32 v163, v78, v79
    v_mfma_f32_32x32x16_bf16 v[64:79], v[120:123], v[12:15], v[32:47]
    ds_read_b128 v[120:123], v169 offset:18432
    v_exp_f32 v48, v48
    v_exp_f32 v49, v49
    v_exp_f32 v50, v50
    v_mfma_f32_32x32x16_bf16 v[104:119], v[136:139], v[156:159], v[104:119]
    ds_read_b128 v[136:139], v179 offset:1024
    v_exp_f32 v51, v51
    v_exp_f32 v52, v52
    v_exp_f32 v53, v53
    v_mfma_f32_32x32x16_bf16 v[104:119], v[140:143], v[160:163], v[104:119]
    ds_read_b128 v[140:143], v179 offset:1536
    v_exp_f32 v54, v54
    v_exp_f32 v55, v55
    v_cvt_pk_bf16_f32 v80, v48, v49
    v_cvt_pk_bf16_f32 v81, v50, v51
    v_cvt_pk_bf16_f32 v82, v52, v53
    v_cvt_pk_bf16_f32 v83, v54, v55
    v_exp_f32 v56, v56
    v_exp_f32 v57, v57
    v_exp_f32 v58, v58
    v_exp_f32 v59, v59
    v_exp_f32 v60, v60
    v_exp_f32 v61, v61
    v_exp_f32 v62, v62
    v_exp_f32 v63, v63
    v_cvt_pk_bf16_f32 v84, v56, v57
    v_cvt_pk_bf16_f32 v85, v58, v59
    v_cvt_pk_bf16_f32 v86, v60, v61
    v_cvt_pk_bf16_f32 v87, v62, v63
    v_mfma_f32_32x32x16_bf16 v[48:63], v[124:127], v[8:11], v[16:31]
    v_exp_f32 v64, v64
    v_exp_f32 v65, v65
    v_exp_f32 v66, v66
    v_mfma_f32_32x32x16_bf16 v[88:103], v[128:131], v[80:83], v[88:103]
    v_exp_f32 v67, v67
    v_exp_f32 v68, v68
    v_exp_f32 v69, v69
    v_mfma_f32_32x32x16_bf16 v[88:103], v[132:135], v[84:87], v[88:103]
    s_waitcnt lgkmcnt(0)
    v_exp_f32 v70, v70
    v_exp_f32 v71, v71
    v_cvt_pk_bf16_f32 v156, v64, v65
    v_cvt_pk_bf16_f32 v157, v66, v67
    v_cvt_pk_bf16_f32 v158, v68, v69
    v_cvt_pk_bf16_f32 v159, v70, v71
    v_exp_f32 v72, v72
    v_exp_f32 v73, v73
    v_exp_f32 v74, v74
    v_exp_f32 v75, v75
    v_exp_f32 v76, v76
    v_exp_f32 v77, v77
    v_exp_f32 v78, v78
    v_exp_f32 v79, v79
    v_cvt_pk_bf16_f32 v160, v72, v73
    v_cvt_pk_bf16_f32 v161, v74, v75
    v_cvt_pk_bf16_f32 v162, v76, v77
    v_cvt_pk_bf16_f32 v163, v78, v79
    v_mfma_f32_32x32x16_bf16 v[64:79], v[124:127], v[12:15], v[32:47]
    ds_read_b128 v[124:127], v169 offset:19456
    v_exp_f32 v48, v48
    v_exp_f32 v49, v49
    v_exp_f32 v50, v50
    v_mfma_f32_32x32x16_bf16 v[104:119], v[128:131], v[156:159], v[104:119]
    ds_read_b128 v[128:131], v179 offset:2048
    v_exp_f32 v51, v51
    v_exp_f32 v52, v52
    v_exp_f32 v53, v53
    v_mfma_f32_32x32x16_bf16 v[104:119], v[132:135], v[160:163], v[104:119]
    ds_read_b128 v[132:135], v179 offset:2560
    v_exp_f32 v54, v54
    v_exp_f32 v55, v55
    v_cvt_pk_bf16_f32 v80, v48, v49
    v_cvt_pk_bf16_f32 v81, v50, v51
    v_cvt_pk_bf16_f32 v82, v52, v53
    v_cvt_pk_bf16_f32 v83, v54, v55
    v_exp_f32 v56, v56
    v_exp_f32 v57, v57
    v_exp_f32 v58, v58
    v_exp_f32 v59, v59
    v_exp_f32 v60, v60
    v_exp_f32 v61, v61
    v_exp_f32 v62, v62
    v_exp_f32 v63, v63
    v_cvt_pk_bf16_f32 v84, v56, v57
    v_cvt_pk_bf16_f32 v85, v58, v59
    v_cvt_pk_bf16_f32 v86, v60, v61
    v_cvt_pk_bf16_f32 v87, v62, v63
    v_mfma_f32_32x32x16_bf16 v[48:63], v[120:123], v[8:11], v[16:31]
    s_waitcnt lgkmcnt(0)
    v_exp_f32 v64, v64
    v_readlane_b32 s9, v128, 59
    v_exp_f32 v65, v65
    v_exp_f32 v66, v66
    v_mfma_f32_32x32x16_bf16 v[88:103], v[136:139], v[80:83], v[88:103]
    s_cmp_lt_u32 s9, 4
    v_exp_f32 v67, v67
    v_exp_f32 v68, v68
    v_exp_f32 v69, v69
    v_mfma_f32_32x32x16_bf16 v[88:103], v[140:143], v[84:87], v[88:103]
    s_cbranch_scc1 a_ck29
a_cb29:
    v_exp_f32 v70, v70
    v_exp_f32 v71, v71
    v_cvt_pk_bf16_f32 v156, v64, v65
    v_cvt_pk_bf16_f32 v157, v66, v67
    v_cvt_pk_bf16_f32 v158, v68, v69
    v_cvt_pk_bf16_f32 v159, v70, v71
    v_exp_f32 v72, v72
    v_exp_f32 v73, v73
    v_exp_f32 v74, v74
    v_exp_f32 v75, v75
    v_exp_f32 v76, v76
    v_exp_f32 v77, v77
    v_exp_f32 v78, v78
    v_exp_f32 v79, v79
    v_cvt_pk_bf16_f32 v160, v72, v73
    v_cvt_pk_bf16_f32 v161, v74, v75
    v_cvt_pk_bf16_f32 v162, v76, v77
    v_cvt_pk_bf16_f32 v163, v78, v79
    v_mfma_f32_32x32x16_bf16 v[64:79], v[120:123], v[12:15], v[32:47]
    ds_read_b128 v[120:123], v168 offset:32768
    v_exp_f32 v48, v48
    v_exp_f32 v49, v49
    v_exp_f32 v50, v50
    v_mfma_f32_32x32x16_bf16 v[104:119], v[136:139], v[156:159], v[104:119]
    ds_read_b128 v[136:139], v179 offset:3072
    v_exp_f32 v51, v51
    v_exp_f32 v52, v52
    v_exp_f32 v53, v53
    v_mfma_f32_32x32x16_bf16 v[104:119], v[140:143], v[160:163], v[104:119]
    ds_read_b128 v[140:143], v179 offset:3584
    v_exp_f32 v54, v54
    v_exp_f32 v55, v55
    v_cvt_pk_bf16_f32 v80, v48, v49
    v_cvt_pk_bf16_f32 v81, v50, v51
    v_cvt_pk_bf16_f32 v82, v52, v53
    v_cvt_pk_bf16_f32 v83, v54, v55
    v_exp_f32 v56, v56
    v_exp_f32 v57, v57
    v_exp_f32 v58, v58
    v_exp_f32 v59, v59
    v_exp_f32 v60, v60
    v_exp_f32 v61, v61
    v_exp_f32 v62, v62
    v_exp_f32 v63, v63
    v_cvt_pk_bf16_f32 v84, v56, v57
    v_cvt_pk_bf16_f32 v85, v58, v59
    v_cvt_pk_bf16_f32 v86, v60, v61
    v_cvt_pk_bf16_f32 v87, v62, v63
    v_mfma_f32_32x32x16_bf16 v[48:63], v[124:127], v[8:11], v[16:31]
    v_exp_f32 v64, v64
    v_exp_f32 v65, v65
    v_exp_f32 v66, v66
    v_mfma_f32_32x32x16_bf16 v[88:103], v[128:131], v[80:83], v[88:103]
    v_exp_f32 v67, v67
    v_exp_f32 v68, v68
    v_exp_f32 v69, v69
    v_mfma_f32_32x32x16_bf16 v[88:103], v[132:135], v[84:87], v[88:103]
    s_waitcnt lgkmcnt(0)
    v_exp_f32 v70, v70
    v_exp_f32 v71, v71
    v_cvt_pk_bf16_f32 v156, v64, v65
    v_cvt_pk_bf16_f32 v157, v66, v67
    v_cvt_pk_bf16_f32 v158, v68, v69
    v_cvt_pk_bf16_f32 v159, v70, v71
    v_exp_f32 v72, v72
    v_exp_f32 v73, v73
    v_exp_f32 v74, v74
    v_exp_f32 v75, v75
    v_exp_f32 v76, v76
    v_exp_f32 v77, v77
    v_exp_f32 v78, v78
    v_exp_f32 v79, v79
    v_cvt_pk_bf16_f32 v160, v72, v73
    v_cvt_pk_bf16_f32 v161, v74, v75
    v_cvt_pk_bf16_f32 v162, v76, v77
    v_cvt_pk_bf16_f32 v163, v78, v79
    v_mfma_f32_32x32x16_bf16 v[64:79], v[124:127], v[12:15], v[32:47]
    ds_read_b128 v[124:127], v168 offset:33792
    v_exp_f32 v48, v48
    v_exp_f32 v49, v49
    v_exp_f32 v50, v50
    v_mfma_f32_32x32x16_bf16 v[104:119], v[128:131], v[156:159], v[104:119]
    ds_read_b128 v[128:131], v180 offset:0
    v_exp_f32 v51, v51
    v_exp_f32 v52, v52
    v_exp_f32 v53, v53
    v_mfma_f32_32x32x16_bf16 v[104:119], v[132:135], v[160:163], v[104:119]
    ds_read_b128 v[132:135], v180 offset:512
    v_exp_f32 v54, v54
    v_exp_f32 v55, v55
    v_cvt_pk_bf16_f32 v80, v48, v49
    v_cvt_pk_bf16_f32 v81, v50, v51
    v_cvt_pk_bf16_f32 v82, v52, v53
    v_cvt_pk_bf16_f32 v83, v54, v55
    v_exp_f32 v56, v56
    v_exp_f32 v57, v57
    v_exp_f32 v58, v58
    v_exp_f32 v59, v59
    v_exp_f32 v60, v60
    v_exp_f32 v61, v61
    v_exp_f32 v62, v62
    v_exp_f32 v63, v63
    v_cvt_pk_bf16_f32 v84, v56, v57
    v_cvt_pk_bf16_f32 v85, v58, v59
    v_cvt_pk_bf16_f32 v86, v60, v61
    v_cvt_pk_bf16_f32 v87, v62, v63
    v_mfma_f32_32x32x16_bf16 v[48:63], v[120:123], v[8:11], v[16:31]
    v_exp_f32 v64, v64
    v_exp_f32 v65, v65
    v_exp_f32 v66, v66
    v_mfma_f32_32x32x16_bf16 v[88:103], v[136:139], v[80:83], v[88:103]
    v_exp_f32 v67, v67
    v_exp_f32 v68, v68
    v_exp_f32 v69, v69
    v_mfma_f32_32x32x16_bf16 v[88:103], v[140:143], v[84:87], v[88:103]
    s_waitcnt lgkmcnt(0)
    v_exp_f32 v70, v70
    v_exp_f32 v71, v71
    v_cvt_pk_bf16_f32 v156, v64, v65
    v_cvt_pk_bf16_f32 v157, v66, v67
    v_cvt_pk_bf16_f32 v158, v68, v69
    v_cvt_pk_bf16_f32 v159, v70, v71
    v_exp_f32 v72, v72
    v_exp_f32 v73, v73
    v_exp_f32 v74, v74
    v_exp_f32 v75, v75
    v_exp_f32 v76, v76
    v_exp_f32 v77, v77
    v_exp_f32 v78, v78
    v_exp_f32 v79, v79
    v_cvt_pk_bf16_f32 v160, v72, v73
    v_cvt_pk_bf16_f32 v161, v74, v75
    v_cvt_pk_bf16_f32 v162, v76, v77
    v_cvt_pk_bf16_f32 v163, v78, v79
    v_mfma_f32_32x32x16_bf16 v[64:79], v[120:123], v[12:15], v[32:47]
    ds_read_b128 v[120:123], v168 offset:34816
    v_exp_f32 v48, v48
    v_exp_f32 v49, v49
    v_exp_f32 v50, v50
    v_mfma_f32_32x32x16_bf16 v[104:119], v[136:139], v[156:159], v[104:119]
    ds_read_b128 v[136:139], v180 offset:1024
    v_exp_f32 v51, v51
    v_exp_f32 v52, v52
    v_exp_f32 v53, v53
    v_mfma_f32_32x32x16_bf16 v[104:119], v[140:143], v[160:163], v[104:119]
    ds_read_b128 v[140:143], v180 offset:1536
    v_exp_f32 v54, v54
    v_exp_f32 v55, v55
    v_cvt_pk_bf16_f32 v80, v48, v49
    v_cvt_pk_bf16_f32 v81, v50, v51
    v_cvt_pk_bf16_f32 v82, v52, v53
    v_cvt_pk_bf16_f32 v83, v54, v55
    v_exp_f32 v56, v56
    v_exp_f32 v57, v57
    v_exp_f32 v58, v58
    v_exp_f32 v59, v59
    v_exp_f32 v60, v60
    v_exp_f32 v61, v61
    v_exp_f32 v62, v62
    v_exp_f32 v63, v63
    v_cvt_pk_bf16_f32 v84, v56, v57
    v_cvt_pk_bf16_f32 v85, v58, v59
    v_cvt_pk_bf16_f32 v86, v60, v61
    v_cvt_pk_bf16_f32 v87, v62, v63
    v_mfma_f32_32x32x16_bf16 v[48:63], v[124:127], v[8:11], v[16:31]
    v_exp_f32 v64, v64
    v_exp_f32 v65, v65
    v_exp_f32 v66, v66
    v_mfma_f32_32x32x16_bf16 v[88:103], v[128:131], v[80:83], v[88:103]
    v_exp_f32 v67, v67
    v_exp_f32 v68, v68
    v_exp_f32 v69, v69
    v_mfma_f32_32x32x16_bf16 v[88:103], v[132:135], v[84:87], v[88:103]
    s_waitcnt lgkmcnt(0)
    v_exp_f32 v70, v70
    v_exp_f32 v71, v71
    v_cvt_pk_bf16_f32 v156, v64, v65
    v_cvt_pk_bf16_f32 v157, v66, v67
    v_cvt_pk_bf16_f32 v158, v68, v69
    v_cvt_pk_bf16_f32 v159, v70, v71
    v_exp_f32 v72, v72
    v_exp_f32 v73, v73
    v_exp_f32 v74, v74
    v_exp_f32 v75, v75
    v_exp_f32 v76, v76
    v_exp_f32 v77, v77
    v_exp_f32 v78, v78
    v_exp_f32 v79, v79
    v_cvt_pk_bf16_f32 v160, v72, v73
    v_cvt_pk_bf16_f32 v161, v74, v75
    v_cvt_pk_bf16_f32 v162, v76, v77
    v_cvt_pk_bf16_f32 v163, v78, v79
    v_mfma_f32_32x32x16_bf16 v[64:79], v[124:127], v[12:15], v[32:47]
    ds_read_b128 v[124:127], v168 offset:35840
    v_exp_f32 v48, v48
    v_exp_f32 v49, v49
    v_exp_f32 v50, v50
    v_mfma_f32_32x32x16_bf16 v[104:119], v[128:131], v[156:159], v[104:119]
    ds_read_b128 v[128:131], v180 offset:2048
    v_exp_f32 v51, v51
    v_exp_f32 v52, v52
    v_exp_f32 v53, v53
    v_mfma_f32_32x32x16_bf16 v[104:119], v[132:135], v[160:163], v[104:119]
    ds_read_b128 v[132:135], v180 offset:2560
    v_exp_f32 v54, v54
    v_exp_f32 v55, v55
    v_cvt_pk_bf16_f32 v80, v48, v49
    v_cvt_pk_bf16_f32 v81, v50, v51
    v_cvt_pk_bf16_f32 v82, v52, v53
    v_cvt_pk_bf16_f32 v83, v54, v55
    v_exp_f32 v56, v56
    v_exp_f32 v57, v57
    v_exp_f32 v58, v58
    v_exp_f32 v59, v59
    v_exp_f32 v60, v60
    v_exp_f32 v61, v61
    v_exp_f32 v62, v62
    v_exp_f32 v63, v63
    v_cvt_pk_bf16_f32 v84, v56, v57
    v_cvt_pk_bf16_f32 v85, v58, v59
    v_cvt_pk_bf16_f32 v86, v60, v61
    v_cvt_pk_bf16_f32 v87, v62, v63
    v_mfma_f32_32x32x16_bf16 v[48:63], v[120:123], v[8:11], v[16:31]
    v_exp_f32 v64, v64
    v_exp_f32 v65, v65
    v_exp_f32 v66, v66
    v_mfma_f32_32x32x16_bf16 v[88:103], v[136:139], v[80:83], v[88:103]
    v_exp_f32 v67, v67
    v_exp_f32 v68, v68
    v_exp_f32 v69, v69
    v_mfma_f32_32x32x16_bf16 v[88:103], v[140:143], v[84:87], v[88:103]
    s_waitcnt lgkmcnt(0)
    v_exp_f32 v70, v70
    v_exp_f32 v71, v71
    v_cvt_pk_bf16_f32 v156, v64, v65
    v_cvt_pk_bf16_f32 v157, v66, v67
    v_cvt_pk_bf16_f32 v158, v68, v69
    v_cvt_pk_bf16_f32 v159, v70, v71
    v_exp_f32 v72, v72
    v_exp_f32 v73, v73
    v_exp_f32 v74, v74
    v_exp_f32 v75, v75
    v_exp_f32 v76, v76
    v_exp_f32 v77, v77
    v_exp_f32 v78, v78
    v_exp_f32 v79, v79
    v_cvt_pk_bf16_f32 v160, v72, v73
    v_cvt_pk_bf16_f32 v161, v74, v75
    v_cvt_pk_bf16_f32 v162, v76, v77
    v_cvt_pk_bf16_f32 v163, v78, v79
    v_mfma_f32_32x32x16_bf16 v[64:79], v[120:123], v[12:15], v[32:47]
    ds_read_b128 v[120:123], v169 offset:32768
    v_exp_f32 v48, v48
    v_exp_f32 v49, v49
    v_exp_f32 v50, v50
    v_mfma_f32_32x32x16_bf16 v[104:119], v[136:139], v[156:159], v[104:119]
    ds_read_b128 v[136:139], v180 offset:3072
    v_exp_f32 v51, v51
    v_exp_f32 v52, v52
    v_exp_f32 v53, v53
    v_mfma_f32_32x32x16_bf16 v[104:119], v[140:143], v[160:163], v[104:119]
    ds_read_b128 v[140:143], v180 offset:3584
    v_exp_f32 v54, v54
    v_exp_f32 v55, v55
    v_cvt_pk_bf16_f32 v80, v48, v49
    v_cvt_pk_bf16_f32 v81, v50, v51
    v_cvt_pk_bf16_f32 v82, v52, v53
    v_cvt_pk_bf16_f32 v83, v54, v55
    v_exp_f32 v56, v56
    v_exp_f32 v57, v57
    v_exp_f32 v58, v58
    v_exp_f32 v59, v59
    v_exp_f32 v60, v60
    v_exp_f32 v61, v61
    v_exp_f32 v62, v62
    v_exp_f32 v63, v63
    v_cvt_pk_bf16_f32 v84, v56, v57
    v_cvt_pk_bf16_f32 v85, v58, v59
    v_cvt_pk_bf16_f32 v86, v60, v61
    v_cvt_pk_bf16_f32 v87, v62, v63
    v_mfma_f32_32x32x16_bf16 v[48:63], v[124:127], v[8:11], v[16:31]
    v_exp_f32 v64, v64
    v_exp_f32 v65, v65
    v_exp_f32 v66, v66
    v_mfma_f32_32x32x16_bf16 v[88:103], v[128:131], v[80:83], v[88:103]
    v_exp_f32 v67, v67
    v_exp_f32 v68, v68
    v_exp_f32 v69, v69
    v_mfma_f32_32x32x16_bf16 v[88:103], v[132:135], v[84:87], v[88:103]
    s_waitcnt lgkmcnt(0)
    v_exp_f32 v70, v70
    v_exp_f32 v71, v71
    v_cvt_pk_bf16_f32 v156, v64, v65
    v_cvt_pk_bf16_f32 v157, v66, v67
    v_cvt_pk_bf16_f32 v158, v68, v69
    v_cvt_pk_bf16_f32 v159, v70, v71
    v_exp_f32 v72, v72
    v_exp_f32 v73, v73
    v_exp_f32 v74, v74
    v_exp_f32 v75, v75
    v_exp_f32 v76, v76
    v_exp_f32 v77, v77
    v_exp_f32 v78, v78
    v_exp_f32 v79, v79
    v_cvt_pk_bf16_f32 v160, v72, v73
    v_cvt_pk_bf16_f32 v161, v74, v75
    v_cvt_pk_bf16_f32 v162, v76, v77
    v_cvt_pk_bf16_f32 v163, v78, v79
    v_mfma_f32_32x32x16_bf16 v[64:79], v[124:127], v[12:15], v[32:47]
    ds_read_b128 v[124:127], v169 offset:33792
    v_exp_f32 v48, v48
    v_exp_f32 v49, v49
    v_exp_f32 v50, v50
    v_mfma_f32_32x32x16_bf16 v[104:119], v[128:131], v[156:159], v[104:119]
    ds_read_b128 v[128:131], v181 offset:0
    v_exp_f32 v51, v51
    v_exp_f32 v52, v52
    v_exp_f32 v53, v53
    v_mfma_f32_32x32x16_bf16 v[104:119], v[132:135], v[160:163], v[104:119]
    ds_read_b128 v[132:135], v181 offset:512
    v_exp_f32 v54, v54
    v_exp_f32 v55, v55
    v_cvt_pk_bf16_f32 v80, v48, v49
    v_cvt_pk_bf16_f32 v81, v50, v51
    v_cvt_pk_bf16_f32 v82, v52, v53
    v_cvt_pk_bf16_f32 v83, v54, v55
    v_exp_f32 v56, v56
    v_exp_f32 v57, v57
    v_exp_f32 v58, v58
    v_exp_f32 v59, v59
    v_exp_f32 v60, v60
    v_exp_f32 v61, v61
    v_exp_f32 v62, v62
    v_exp_f32 v63, v63
    v_cvt_pk_bf16_f32 v84, v56, v57
    v_cvt_pk_bf16_f32 v85, v58, v59
    v_cvt_pk_bf16_f32 v86, v60, v61
    v_cvt_pk_bf16_f32 v87, v62, v63
    v_mfma_f32_32x32x16_bf16 v[48:63], v[120:123], v[8:11], v[16:31]
    v_exp_f32 v64, v64
    v_exp_f32 v65, v65
    v_exp_f32 v66, v66
    v_mfma_f32_32x32x16_bf16 v[88:103], v[136:139], v[80:83], v[88:103]
    v_exp_f32 v67, v67
    v_exp_f32 v68, v68
    v_exp_f32 v69, v69
    v_mfma_f32_32x32x16_bf16 v[88:103], v[140:143], v[84:87], v[88:103]
    s_waitcnt lgkmcnt(0)
    v_exp_f32 v70, v70
    v_exp_f32 v71, v71
    v_cvt_pk_bf16_f32 v156, v64, v65
    v_cvt_pk_bf16_f32 v157, v66, v67
    v_cvt_pk_bf16_f32 v158, v68, v69
    v_cvt_pk_bf16_f32 v159, v70, v71
    v_exp_f32 v72, v72
    v_exp_f32 v73, v73
    v_exp_f32 v74, v74
    v_exp_f32 v75, v75
    v_exp_f32 v76, v76
    v_exp_f32 v77, v77
    v_exp_f32 v78, v78
    v_exp_f32 v79, v79
    v_cvt_pk_bf16_f32 v160, v72, v73
    v_cvt_pk_bf16_f32 v161, v74, v75
    v_cvt_pk_bf16_f32 v162, v76, v77
    v_cvt_pk_bf16_f32 v163, v78, v79
    v_mfma_f32_32x32x16_bf16 v[64:79], v[120:123], v[12:15], v[32:47]
    ds_read_b128 v[120:123], v169 offset:34816
    v_exp_f32 v48, v48
    v_exp_f32 v49, v49
    v_exp_f32 v50, v50
    v_mfma_f32_32x32x16_bf16 v[104:119], v[136:139], v[156:159], v[104:119]
    ds_read_b128 v[136:139], v181 offset:1024
    v_exp_f32 v51, v51
    v_exp_f32 v52, v52
    v_exp_f32 v53, v53
    v_mfma_f32_32x32x16_bf16 v[104:119], v[140:143], v[160:163], v[104:119]
    ds_read_b128 v[140:143], v181 offset:1536
    v_exp_f32 v54, v54
    v_exp_f32 v55, v55
    v_cvt_pk_bf16_f32 v80, v48, v49
    v_cvt_pk_bf16_f32 v81, v50, v51
    v_cvt_pk_bf16_f32 v82, v52, v53
    v_cvt_pk_bf16_f32 v83, v54, v55
    v_exp_f32 v56, v56
    v_exp_f32 v57, v57
    v_exp_f32 v58, v58
    v_exp_f32 v59, v59
    v_exp_f32 v60, v60
    v_exp_f32 v61, v61
    v_exp_f32 v62, v62
    v_exp_f32 v63, v63
    v_cvt_pk_bf16_f32 v84, v56, v57
    v_cvt_pk_bf16_f32 v85, v58, v59
    v_cvt_pk_bf16_f32 v86, v60, v61
    v_cvt_pk_bf16_f32 v87, v62, v63
    v_mfma_f32_32x32x16_bf16 v[48:63], v[124:127], v[8:11], v[16:31]
    v_exp_f32 v64, v64
    v_exp_f32 v65, v65
    v_exp_f32 v66, v66
    v_mfma_f32_32x32x16_bf16 v[88:103], v[128:131], v[80:83], v[88:103]
    v_exp_f32 v67, v67
    v_exp_f32 v68, v68
    v_exp_f32 v69, v69
    v_mfma_f32_32x32x16_bf16 v[88:103], v[132:135], v[84:87], v[88:103]
    s_waitcnt lgkmcnt(0)
    v_exp_f32 v70, v70
    v_exp_f32 v71, v71
    v_cvt_pk_bf16_f32 v156, v64, v65
    v_cvt_pk_bf16_f32 v157, v66, v67
    v_cvt_pk_bf16_f32 v158, v68, v69
    v_cvt_pk_bf16_f32 v159, v70, v71
    v_exp_f32 v72, v72
    v_exp_f32 v73, v73
    v_exp_f32 v74, v74
    v_exp_f32 v75, v75
    v_exp_f32 v76, v76
    v_exp_f32 v77, v77
    v_exp_f32 v78, v78
    v_exp_f32 v79, v79
    v_cvt_pk_bf16_f32 v160, v72, v73
    v_cvt_pk_bf16_f32 v161, v74, v75
    v_cvt_pk_bf16_f32 v162, v76, v77
    v_cvt_pk_bf16_f32 v163, v78, v79
    v_mfma_f32_32x32x16_bf16 v[64:79], v[124:127], v[12:15], v[32:47]
    ds_read_b128 v[124:127], v169 offset:35840
    v_exp_f32 v48, v48
    v_exp_f32 v49, v49
    v_exp_f32 v50, v50
    v_mfma_f32_32x32x16_bf16 v[104:119], v[128:131], v[156:159], v[104:119]
    ds_read_b128 v[128:131], v181 offset:2048
    v_exp_f32 v51, v51
    v_exp_f32 v52, v52
    v_exp_f32 v53, v53
    v_mfma_f32_32x32x16_bf16 v[104:119], v[132:135], v[160:163], v[104:119]
    ds_read_b128 v[132:135], v181 offset:2560
    v_exp_f32 v54, v54
    v_exp_f32 v55, v55
    v_cvt_pk_bf16_f32 v80, v48, v49
    v_cvt_pk_bf16_f32 v81, v50, v51
    v_cvt_pk_bf16_f32 v82, v52, v53
    v_cvt_pk_bf16_f32 v83, v54, v55
    v_exp_f32 v56, v56
    v_exp_f32 v57, v57
    v_exp_f32 v58, v58
    v_exp_f32 v59, v59
    v_exp_f32 v60, v60
    v_exp_f32 v61, v61
    v_exp_f32 v62, v62
    v_exp_f32 v63, v63
    v_cvt_pk_bf16_f32 v84, v56, v57
    v_cvt_pk_bf16_f32 v85, v58, v59
    v_cvt_pk_bf16_f32 v86, v60, v61
    v_cvt_pk_bf16_f32 v87, v62, v63
    v_mfma_f32_32x32x16_bf16 v[48:63], v[120:123], v[8:11], v[16:31]
    v_exp_f32 v64, v64
    v_exp_f32 v65, v65
    v_exp_f32 v66, v66
    v_mfma_f32_32x32x16_bf16 v[88:103], v[136:139], v[80:83], v[88:103]
    v_exp_f32 v67, v67
    v_exp_f32 v68, v68
    v_exp_f32 v69, v69
    v_mfma_f32_32x32x16_bf16 v[88:103], v[140:143], v[84:87], v[88:103]
    s_waitcnt lgkmcnt(0)
    v_exp_f32 v70, v70
    v_exp_f32 v71, v71
    v_cvt_pk_bf16_f32 v156, v64, v65
    v_cvt_pk_bf16_f32 v157, v66, v67
    v_cvt_pk_bf16_f32 v158, v68, v69
    v_cvt_pk_bf16_f32 v159, v70, v71
    v_exp_f32 v72, v72
    v_exp_f32 v73, v73
    v_exp_f32 v74, v74
    v_exp_f32 v75, v75
    v_exp_f32 v76, v76
    v_exp_f32 v77, v77
    v_exp_f32 v78, v78
    v_exp_f32 v79, v79
    v_cvt_pk_bf16_f32 v160, v72, v73
    v_cvt_pk_bf16_f32 v161, v74, v75
    v_cvt_pk_bf16_f32 v162, v76, v77
    v_cvt_pk_bf16_f32 v163, v78, v79
    v_mfma_f32_32x32x16_bf16 v[64:79], v[120:123], v[12:15], v[32:47]
    ds_read_b128 v[120:123], v170 offset:0
    v_exp_f32 v48, v48
    v_exp_f32 v49, v49
    v_exp_f32 v50, v50
    v_mfma_f32_32x32x16_bf16 v[104:119], v[136:139], v[156:159], v[104:119]
    ds_read_b128 v[136:139], v181 offset:3072
    v_exp_f32 v51, v51
    v_exp_f32 v52, v52
    v_exp_f32 v53, v53
    v_mfma_f32_32x32x16_bf16 v[104:119], v[140:143], v[160:163], v[104:119]
    ds_read_b128 v[140:143], v181 offset:3584
    v_exp_f32 v54, v54
    v_exp_f32 v55, v55
    v_cvt_pk_bf16_f32 v80, v48, v49
    v_cvt_pk_bf16_f32 v81, v50, v51
    v_cvt_pk_bf16_f32 v82, v52, v53
    v_cvt_pk_bf16_f32 v83, v54, v55
    v_exp_f32 v56, v56
    v_exp_f32 v57, v57
    v_exp_f32 v58, v58
    v_exp_f32 v59, v59
    v_exp_f32 v60, v60
    v_exp_f32 v61, v61
    v_exp_f32 v62, v62
    v_exp_f32 v63, v63
    v_cvt_pk_bf16_f32 v84, v56, v57
    v_cvt_pk_bf16_f32 v85, v58, v59
    v_cvt_pk_bf16_f32 v86, v60, v61
    v_cvt_pk_bf16_f32 v87, v62, v63
    v_mfma_f32_32x32x16_bf16 v[48:63], v[124:127], v[8:11], v[16:31]
    v_exp_f32 v64, v64
    v_exp_f32 v65, v65
    v_exp_f32 v66, v66
    v_mfma_f32_32x32x16_bf16 v[88:103], v[128:131], v[80:83], v[88:103]
    v_exp_f32 v67, v67
    v_exp_f32 v68, v68
    v_exp_f32 v69, v69
    v_mfma_f32_32x32x16_bf16 v[88:103], v[132:135], v[84:87], v[88:103]
    s_waitcnt lgkmcnt(0)
    v_exp_f32 v70, v70
    v_exp_f32 v71, v71
    v_cvt_pk_bf16_f32 v156, v64, v65
    v_cvt_pk_bf16_f32 v157, v66, v67
    v_cvt_pk_bf16_f32 v158, v68, v69
    v_cvt_pk_bf16_f32 v159, v70, v71
    v_exp_f32 v72, v72
    v_exp_f32 v73, v73
    v_exp_f32 v74, v74
    v_exp_f32 v75, v75
    v_exp_f32 v76, v76
    v_exp_f32 v77, v77
    v_exp_f32 v78, v78
    v_exp_f32 v79, v79
    v_cvt_pk_bf16_f32 v160, v72, v73
    v_cvt_pk_bf16_f32 v161, v74, v75
    v_cvt_pk_bf16_f32 v162, v76, v77
    v_cvt_pk_bf16_f32 v163, v78, v79
    v_mfma_f32_32x32x16_bf16 v[64:79], v[124:127], v[12:15], v[32:47]
    ds_read_b128 v[124:127], v170 offset:1024
    v_exp_f32 v48, v48
    v_exp_f32 v49, v49
    v_exp_f32 v50, v50
    v_mfma_f32_32x32x16_bf16 v[104:119], v[128:131], v[156:159], v[104:119]
    ds_read_b128 v[128:131], v182 offset:0
    v_exp_f32 v51, v51
    v_exp_f32 v52, v52
    v_exp_f32 v53, v53
    v_mfma_f32_32x32x16_bf16 v[104:119], v[132:135], v[160:163], v[104:119]
a_pad3:
    s_cbranch_execz a_ret0
    ds_read_b128 v[132:135], v182 offset:512
    v_exp_f32 v54, v54
    v_exp_f32 v55, v55
    v_cvt_pk_bf16_f32 v80, v48, v49
    v_cvt_pk_bf16_f32 v81, v50, v51
    v_cvt_pk_bf16_f32 v82, v52, v53
    v_cvt_pk_bf16_f32 v83, v54, v55
    v_exp_f32 v56, v56
    v_exp_f32 v57, v57
    v_exp_f32 v58, v58
    v_exp_f32 v59, v59
    v_exp_f32 v60, v60
    v_exp_f32 v61, v61
    v_exp_f32 v62, v62
    v_exp_f32 v63, v63
    v_cvt_pk_bf16_f32 v84, v56, v57
    v_cvt_pk_bf16_f32 v85, v58, v59
    v_cvt_pk_bf16_f32 v86, v60, v61
    v_cvt_pk_bf16_f32 v87, v62, v63
    v_mfma_f32_32x32x16_bf16 v[48:63], v[120:123], v[8:11], v[16:31]
    v_exp_f32 v64, v64
    v_exp_f32 v65, v65
    v_exp_f32 v66, v66
    v_mfma_f32_32x32x16_bf16 v[88:103], v[136:139], v[80:83], v[88:103]
    v_exp_f32 v67, v67
    v_exp_f32 v68, v68
    v_exp_f32 v69, v69
    v_mfma_f32_32x32x16_bf16 v[88:103], v[140:143], v[84:87], v[88:103]
    s_waitcnt lgkmcnt(0)
    v_exp_f32 v70, v70
    v_exp_f32 v71, v71
    v_cvt_pk_bf16_f32 v156, v64, v65
    v_cvt_pk_bf16_f32 v157, v66, v67
    v_cvt_pk_bf16_f32 v158, v68, v69
    v_cvt_pk_bf16_f32 v159, v70, v71
    v_exp_f32 v72, v72
    v_exp_f32 v73, v73
    v_exp_f32 v74, v74
    v_exp_f32 v75, v75
    v_exp_f32 v76, v76
    v_exp_f32 v77, v77
    v_exp_f32 v78, v78
    v_exp_f32 v79, v79
    v_cvt_pk_bf16_f32 v160, v72, v73
    v_cvt_pk_bf16_f32 v161, v74, v75
    v_cvt_pk_bf16_f32 v162, v76, v77
    v_cvt_pk_bf16_f32 v163, v78, v79
    v_mfma_f32_32x32x16_bf16 v[64:79], v[120:123], v[12:15], v[32:47]
    ds_read_b128 v[120:123], v170 offset:2048
    v_exp_f32 v48, v48
    v_exp_f32 v49, v49
    v_exp_f32 v50, v50
    v_mfma_f32_32x32x16_bf16 v[104:119], v[136:139], v[156:159], v[104:119]
    ds_read_b128 v[136:139], v182 offset:1024
    v_exp_f32 v51, v51
    v_exp_f32 v52, v52
    v_exp_f32 v53, v53
    v_mfma_f32_32x32x16_bf16 v[104:119], v[140:143], v[160:163], v[104:119]
    ds_read_b128 v[140:143], v182 offset:1536
    v_exp_f32 v54, v54
    v_exp_f32 v55, v55
    v_cvt_pk_bf16_f32 v80, v48, v49
    v_cvt_pk_bf16_f32 v81, v50, v51
    v_cvt_pk_bf16_f32 v82, v52, v53
    v_cvt_pk_bf16_f32 v83, v54, v55
    v_exp_f32 v56, v56
    v_exp_f32 v57, v57
    v_exp_f32 v58, v58
    v_exp_f32 v59, v59
    v_exp_f32 v60, v60
    v_exp_f32 v61, v61
    v_exp_f32 v62, v62
    v_exp_f32 v63, v63
    v_cvt_pk_bf16_f32 v84, v56, v57
    v_cvt_pk_bf16_f32 v85, v58, v59
    v_cvt_pk_bf16_f32 v86, v60, v61
    v_cvt_pk_bf16_f32 v87, v62, v63
    v_mfma_f32_32x32x16_bf16 v[48:63], v[124:127], v[8:11], v[16:31]
    v_exp_f32 v64, v64
    v_exp_f32 v65, v65
    v_exp_f32 v66, v66
    v_mfma_f32_32x32x16_bf16 v[88:103], v[128:131], v[80:83], v[88:103]
    v_exp_f32 v67, v67
    v_exp_f32 v68, v68
    v_exp_f32 v69, v69
    v_mfma_f32_32x32x16_bf16 v[88:103], v[132:135], v[84:87], v[88:103]
    s_waitcnt lgkmcnt(0)
    v_exp_f32 v70, v70
    v_exp_f32 v71, v71
    v_cvt_pk_bf16_f32 v156, v64, v65
    v_cvt_pk_bf16_f32 v157, v66, v67
    v_cvt_pk_bf16_f32 v158, v68, v69
    v_cvt_pk_bf16_f32 v159, v70, v71
    v_exp_f32 v72, v72
    v_exp_f32 v73, v73
    v_exp_f32 v74, v74
    v_exp_f32 v75, v75
    v_exp_f32 v76, v76
    v_exp_f32 v77, v77
    v_exp_f32 v78, v78
    v_exp_f32 v79, v79
    v_cvt_pk_bf16_f32 v160, v72, v73
    v_cvt_pk_bf16_f32 v161, v74, v75
    v_cvt_pk_bf16_f32 v162, v76, v77
    v_cvt_pk_bf16_f32 v163, v78, v79
    v_mfma_f32_32x32x16_bf16 v[64:79], v[124:127], v[12:15], v[32:47]
    ds_read_b128 v[124:127], v170 offset:3072
    v_exp_f32 v48, v48
    v_exp_f32 v49, v49
    v_exp_f32 v50, v50
    v_mfma_f32_32x32x16_bf16 v[104:119], v[128:131], v[156:159], v[104:119]
    ds_read_b128 v[128:131], v182 offset:2048
    v_exp_f32 v51, v51
    v_exp_f32 v52, v52
    v_exp_f32 v53, v53
    v_mfma_f32_32x32x16_bf16 v[104:119], v[132:135], v[160:163], v[104:119]
    ds_read_b128 v[132:135], v182 offset:2560
    v_exp_f32 v54, v54
    v_exp_f32 v55, v55
    v_cvt_pk_bf16_f32 v80, v48, v49
    v_cvt_pk_bf16_f32 v81, v50, v51
    v_cvt_pk_bf16_f32 v82, v52, v53
    v_cvt_pk_bf16_f32 v83, v54, v55
    v_exp_f32 v56, v56
    v_exp_f32 v57, v57
    v_exp_f32 v58, v58
    v_exp_f32 v59, v59
    v_exp_f32 v60, v60
    v_exp_f32 v61, v61
    v_exp_f32 v62, v62
    v_exp_f32 v63, v63
    v_cvt_pk_bf16_f32 v84, v56, v57
    v_cvt_pk_bf16_f32 v85, v58, v59
    v_cvt_pk_bf16_f32 v86, v60, v61
    v_cvt_pk_bf16_f32 v87, v62, v63
    v_mfma_f32_32x32x16_bf16 v[48:63], v[120:123], v[8:11], v[16:31]
    v_exp_f32 v64, v64
    v_exp_f32 v65, v65
    v_exp_f32 v66, v66
    v_mfma_f32_32x32x16_bf16 v[88:103], v[136:139], v[80:83], v[88:103]
    v_exp_f32 v67, v67
    v_exp_f32 v68, v68
    v_exp_f32 v69, v69
    v_mfma_f32_32x32x16_bf16 v[88:103], v[140:143], v[84:87], v[88:103]
    s_waitcnt lgkmcnt(0)
    v_exp_f32 v70, v70
    v_exp_f32 v71, v71
    v_cvt_pk_bf16_f32 v156, v64, v65
    v_cvt_pk_bf16_f32 v157, v66, v67
    v_cvt_pk_bf16_f32 v158, v68, v69
    v_cvt_pk_bf16_f32 v159, v70, v71
    v_exp_f32 v72, v72
    v_exp_f32 v73, v73
    v_exp_f32 v74, v74
    v_exp_f32 v75, v75
    v_exp_f32 v76, v76
    v_exp_f32 v77, v77
    v_exp_f32 v78, v78
    v_exp_f32 v79, v79
    v_cvt_pk_bf16_f32 v160, v72, v73
    v_cvt_pk_bf16_f32 v161, v74, v75
    v_cvt_pk_bf16_f32 v162, v76, v77
    v_cvt_pk_bf16_f32 v163, v78, v79
    v_mfma_f32_32x32x16_bf16 v[64:79], v[120:123], v[12:15], v[32:47]
    ds_read_b128 v[120:123], v171 offset:0
    v_exp_f32 v48, v48
    v_exp_f32 v49, v49
    v_exp_f32 v50, v50
    v_mfma_f32_32x32x16_bf16 v[104:119], v[136:139], v[156:159], v[104:119]
    ds_read_b128 v[136:139], v182 offset:3072
    v_exp_f32 v51, v51
    v_exp_f32 v52, v52
    v_exp_f32 v53, v53
    v_mfma_f32_32x32x16_bf16 v[104:119], v[140:143], v[160:163], v[104:119]
    ds_read_b128 v[140:143], v182 offset:3584
    v_exp_f32 v54, v54
    v_exp_f32 v55, v55
    v_cvt_pk_bf16_f32 v80, v48, v49
    v_cvt_pk_bf16_f32 v81, v50, v51
    v_cvt_pk_bf16_f32 v82, v52, v53
    v_cvt_pk_bf16_f32 v83, v54, v55
    v_exp_f32 v56, v56
    v_exp_f32 v57, v57
    v_exp_f32 v58, v58
    v_exp_f32 v59, v59
    v_exp_f32 v60, v60
    v_exp_f32 v61, v61
    v_exp_f32 v62, v62
    v_exp_f32 v63, v63
    v_cvt_pk_bf16_f32 v84, v56, v57
    v_cvt_pk_bf16_f32 v85, v58, v59
    v_cvt_pk_bf16_f32 v86, v60, v61
    v_cvt_pk_bf16_f32 v87, v62, v63
    v_mfma_f32_32x32x16_bf16 v[48:63], v[124:127], v[8:11], v[16:31]
    v_exp_f32 v64, v64
    v_exp_f32 v65, v65
    v_exp_f32 v66, v66
    v_mfma_f32_32x32x16_bf16 v[88:103], v[128:131], v[80:83], v[88:103]
    v_exp_f32 v67, v67
    v_exp_f32 v68, v68
    v_exp_f32 v69, v69
    v_mfma_f32_32x32x16_bf16 v[88:103], v[132:135], v[84:87], v[88:103]
    s_waitcnt lgkmcnt(0)
    v_exp_f32 v70, v70
    v_exp_f32 v71, v71
    v_cvt_pk_bf16_f32 v156, v64, v65
    v_cvt_pk_bf16_f32 v157, v66, v67
    v_cvt_pk_bf16_f32 v158, v68, v69
    v_cvt_pk_bf16_f32 v159, v70, v71
    v_exp_f32 v72, v72
    v_exp_f32 v73, v73
    v_exp_f32 v74, v74
    v_exp_f32 v75, v75
    v_exp_f32 v76, v76
    v_exp_f32 v77, v77
    v_exp_f32 v78, v78
    v_exp_f32 v79, v79
    v_cvt_pk_bf16_f32 v160, v72, v73
    v_cvt_pk_bf16_f32 v161, v74, v75
    v_cvt_pk_bf16_f32 v162, v76, v77
    v_cvt_pk_bf16_f32 v163, v78, v79
    v_mfma_f32_32x32x16_bf16 v[64:79], v[124:127], v[12:15], v[32:47]
    ds_read_b128 v[124:127], v171 offset:1024
    v_exp_f32 v48, v48
    v_exp_f32 v49, v49
    v_exp_f32 v50, v50
    v_mfma_f32_32x32x16_bf16 v[104:119], v[128:131], v[156:159], v[104:119]
    ds_read_b128 v[128:131], v183 offset:0
    v_exp_f32 v51, v51
    v_exp_f32 v52, v52
    v_exp_f32 v53, v53
    v_mfma_f32_32x32x16_bf16 v[104:119], v[132:135], v[160:163], v[104:119]
    ds_read_b128 v[132:135], v183 offset:512
    v_exp_f32 v54, v54
    v_exp_f32 v55, v55
    v_cvt_pk_bf16_f32 v80, v48, v49
    v_cvt_pk_bf16_f32 v81, v50, v51
    v_cvt_pk_bf16_f32 v82, v52, v53
    v_cvt_pk_bf16_f32 v83, v54, v55
    v_exp_f32 v56, v56
    v_exp_f32 v57, v57
    v_exp_f32 v58, v58
    v_exp_f32 v59, v59
    v_exp_f32 v60, v60
    v_exp_f32 v61, v61
    v_exp_f32 v62, v62
    v_exp_f32 v63, v63
    v_cvt_pk_bf16_f32 v84, v56, v57
    v_cvt_pk_bf16_f32 v85, v58, v59
    v_cvt_pk_bf16_f32 v86, v60, v61
    v_cvt_pk_bf16_f32 v87, v62, v63
    v_mfma_f32_32x32x16_bf16 v[48:63], v[120:123], v[8:11], v[16:31]
    v_exp_f32 v64, v64
    v_exp_f32 v65, v65
    v_exp_f32 v66, v66
    v_mfma_f32_32x32x16_bf16 v[88:103], v[136:139], v[80:83], v[88:103]
    v_exp_f32 v67, v67
    v_exp_f32 v68, v68
    v_exp_f32 v69, v69
    v_mfma_f32_32x32x16_bf16 v[88:103], v[140:143], v[84:87], v[88:103]
    s_waitcnt lgkmcnt(0)
    v_exp_f32 v70, v70
    v_exp_f32 v71, v71
    v_cvt_pk_bf16_f32 v156, v64, v65
    v_cvt_pk_bf16_f32 v157, v66, v67
    v_cvt_pk_bf16_f32 v158, v68, v69
    v_cvt_pk_bf16_f32 v159, v70, v71
    v_exp_f32 v72, v72
    v_exp_f32 v73, v73
    v_exp_f32 v74, v74
    v_exp_f32 v75, v75
    v_exp_f32 v76, v76
    v_exp_f32 v77, v77
    v_exp_f32 v78, v78
    v_exp_f32 v79, v79
    v_cvt_pk_bf16_f32 v160, v72, v73
    v_cvt_pk_bf16_f32 v161, v74, v75
    v_cvt_pk_bf16_f32 v162, v76, v77
    v_cvt_pk_bf16_f32 v163, v78, v79
    v_mfma_f32_32x32x16_bf16 v[64:79], v[120:123], v[12:15], v[32:47]
    ds_read_b128 v[120:123], v171 offset:2048
    v_exp_f32 v48, v48
    v_exp_f32 v49, v49
    v_exp_f32 v50, v50
    v_mfma_f32_32x32x16_bf16 v[104:119], v[136:139], v[156:159], v[104:119]
    ds_read_b128 v[136:139], v183 offset:1024
    v_exp_f32 v51, v51
    v_exp_f32 v52, v52
    v_exp_f32 v53, v53
    v_mfma_f32_32x32x16_bf16 v[104:119], v[140:143], v[160:163], v[104:119]
    ds_read_b128 v[140:143], v183 offset:1536
    v_exp_f32 v54, v54
    v_exp_f32 v55, v55
    v_cvt_pk_bf16_f32 v80, v48, v49
    v_cvt_pk_bf16_f32 v81, v50, v51
    v_cvt_pk_bf16_f32 v82, v52, v53
    v_cvt_pk_bf16_f32 v83, v54, v55
    v_exp_f32 v56, v56
    v_exp_f32 v57, v57
    v_exp_f32 v58, v58
    v_exp_f32 v59, v59
    v_exp_f32 v60, v60
    v_exp_f32 v61, v61
    v_exp_f32 v62, v62
    v_exp_f32 v63, v63
    v_cvt_pk_bf16_f32 v84, v56, v57
    v_cvt_pk_bf16_f32 v85, v58, v59
    v_cvt_pk_bf16_f32 v86, v60, v61
    v_cvt_pk_bf16_f32 v87, v62, v63
    v_mfma_f32_32x32x16_bf16 v[48:63], v[124:127], v[8:11], v[16:31]
    v_exp_f32 v64, v64
    v_exp_f32 v65, v65
    v_exp_f32 v66, v66
    v_mfma_f32_32x32x16_bf16 v[88:103], v[128:131], v[80:83], v[88:103]
    v_exp_f32 v67, v67
    v_exp_f32 v68, v68
    v_exp_f32 v69, v69
    v_mfma_f32_32x32x16_bf16 v[88:103], v[132:135], v[84:87], v[88:103]
    s_waitcnt lgkmcnt(0)
    v_exp_f32 v70, v70
    v_exp_f32 v71, v71
    v_cvt_pk_bf16_f32 v156, v64, v65
    v_cvt_pk_bf16_f32 v157, v66, v67
    v_cvt_pk_bf16_f32 v158, v68, v69
    v_cvt_pk_bf16_f32 v159, v70, v71
    v_exp_f32 v72, v72
    v_exp_f32 v73, v73
    v_exp_f32 v74, v74
    v_exp_f32 v75, v75
    v_exp_f32 v76, v76
    v_exp_f32 v77, v77
    v_exp_f32 v78, v78
    v_exp_f32 v79, v79
    v_cvt_pk_bf16_f32 v160, v72, v73
    v_cvt_pk_bf16_f32 v161, v74, v75
    v_cvt_pk_bf16_f32 v162, v76, v77
    v_cvt_pk_bf16_f32 v163, v78, v79
    v_mfma_f32_32x32x16_bf16 v[64:79], v[124:127], v[12:15], v[32:47]
    ds_read_b128 v[124:127], v171 offset:3072
    v_exp_f32 v48, v48
    v_exp_f32 v49, v49
    v_exp_f32 v50, v50
    v_mfma_f32_32x32x16_bf16 v[104:119], v[128:131], v[156:159], v[104:119]
    ds_read_b128 v[128:131], v183 offset:2048
    v_exp_f32 v51, v51
    v_exp_f32 v52, v52
    v_exp_f32 v53, v53
    v_mfma_f32_32x32x16_bf16 v[104:119], v[132:135], v[160:163], v[104:119]
    ds_read_b128 v[132:135], v183 offset:2560
    v_exp_f32 v54, v54
    v_exp_f32 v55, v55
    v_cvt_pk_bf16_f32 v80, v48, v49
    v_cvt_pk_bf16_f32 v81, v50, v51
    v_cvt_pk_bf16_f32 v82, v52, v53
    v_cvt_pk_bf16_f32 v83, v54, v55
    v_exp_f32 v56, v56
    v_exp_f32 v57, v57
    v_exp_f32 v58, v58
    v_exp_f32 v59, v59
    v_exp_f32 v60, v60
    v_exp_f32 v61, v61
    v_exp_f32 v62, v62
    v_exp_f32 v63, v63
    v_cvt_pk_bf16_f32 v84, v56, v57
    v_cvt_pk_bf16_f32 v85, v58, v59
    v_cvt_pk_bf16_f32 v86, v60, v61
    v_cvt_pk_bf16_f32 v87, v62, v63
    v_mfma_f32_32x32x16_bf16 v[48:63], v[120:123], v[8:11], v[16:31]
    v_exp_f32 v64, v64
    v_exp_f32 v65, v65
    v_exp_f32 v66, v66
    v_mfma_f32_32x32x16_bf16 v[88:103], v[136:139], v[80:83], v[88:103]
    v_exp_f32 v67, v67
    v_exp_f32 v68, v68
    v_exp_f32 v69, v69
    v_mfma_f32_32x32x16_bf16 v[88:103], v[140:143], v[84:87], v[88:103]
    s_waitcnt lgkmcnt(0)
    v_exp_f32 v70, v70
    v_exp_f32 v71, v71
    v_cvt_pk_bf16_f32 v156, v64, v65
    v_cvt_pk_bf16_f32 v157, v66, v67
    v_cvt_pk_bf16_f32 v158, v68, v69
    v_cvt_pk_bf16_f32 v159, v70, v71
    v_exp_f32 v72, v72
    v_exp_f32 v73, v73
    v_exp_f32 v74, v74
    v_exp_f32 v75, v75
    v_exp_f32 v76, v76
    v_exp_f32 v77, v77
    v_exp_f32 v78, v78
    v_exp_f32 v79, v79
    v_cvt_pk_bf16_f32 v160, v72, v73
    v_cvt_pk_bf16_f32 v161, v74, v75
    v_cvt_pk_bf16_f32 v162, v76, v77
    v_cvt_pk_bf16_f32 v163, v78, v79
    v_mfma_f32_32x32x16_bf16 v[64:79], v[120:123], v[12:15], v[32:47]
    ds_read_b128 v[120:123], v170 offset:16384
    v_exp_f32 v48, v48
    v_exp_f32 v49, v49
    v_exp_f32 v50, v50
    v_mfma_f32_32x32x16_bf16 v[104:119], v[136:139], v[156:159], v[104:119]
    ds_read_b128 v[136:139], v183 offset:3072
    v_exp_f32 v51, v51
    v_exp_f32 v52, v52
    v_exp_f32 v53, v53
    v_mfma_f32_32x32x16_bf16 v[104:119], v[140:143], v[160:163], v[104:119]
    ds_read_b128 v[140:143], v183 offset:3584
    v_exp_f32 v54, v54
    v_exp_f32 v55, v55
    v_cvt_pk_bf16_f32 v80, v48, v49
    v_cvt_pk_bf16_f32 v81, v50, v51
    v_cvt_pk_bf16_f32 v82, v52, v53
    v_cvt_pk_bf16_f32 v83, v54, v55
    v_exp_f32 v56, v56
    v_exp_f32 v57, v57
    v_exp_f32 v58, v58
    v_exp_f32 v59, v59
    v_exp_f32 v60, v60
    v_exp_f32 v61, v61
    v_exp_f32 v62, v62
    v_exp_f32 v63, v63
    v_cvt_pk_bf16_f32 v84, v56, v57
    v_cvt_pk_bf16_f32 v85, v58, v59
    v_cvt_pk_bf16_f32 v86, v60, v61
    v_cvt_pk_bf16_f32 v87, v62, v63
    v_mfma_f32_32x32x16_bf16 v[48:63], v[124:127], v[8:11], v[16:31]
    v_exp_f32 v64, v64
    v_exp_f32 v65, v65
    v_exp_f32 v66, v66
    v_mfma_f32_32x32x16_bf16 v[88:103], v[128:131], v[80:83], v[88:103]
    v_exp_f32 v67, v67
    v_exp_f32 v68, v68
    v_exp_f32 v69, v69
    v_mfma_f32_32x32x16_bf16 v[88:103], v[132:135], v[84:87], v[88:103]
    s_waitcnt lgkmcnt(0)
    v_exp_f32 v70, v70
    v_exp_f32 v71, v71
    v_cvt_pk_bf16_f32 v156, v64, v65
    v_cvt_pk_bf16_f32 v157, v66, v67
    v_cvt_pk_bf16_f32 v158, v68, v69
    v_cvt_pk_bf16_f32 v159, v70, v71
    v_exp_f32 v72, v72
    v_exp_f32 v73, v73
    v_exp_f32 v74, v74
    v_exp_f32 v75, v75
    v_exp_f32 v76, v76
    v_exp_f32 v77, v77
    v_exp_f32 v78, v78
    v_exp_f32 v79, v79
    v_cvt_pk_bf16_f32 v160, v72, v73
    v_cvt_pk_bf16_f32 v161, v74, v75
    v_cvt_pk_bf16_f32 v162, v76, v77
    v_cvt_pk_bf16_f32 v163, v78, v79
    v_mfma_f32_32x32x16_bf16 v[64:79], v[124:127], v[12:15], v[32:47]
    ds_read_b128 v[124:127], v170 offset:17408
    v_exp_f32 v48, v48
    v_exp_f32 v49, v49
    v_exp_f32 v50, v50
    v_mfma_f32_32x32x16_bf16 v[104:119], v[128:131], v[156:159], v[104:119]
    ds_read_b128 v[128:131], v184 offset:0
    v_exp_f32 v51, v51
    v_exp_f32 v52, v52
    v_exp_f32 v53, v53
    v_mfma_f32_32x32x16_bf16 v[104:119], v[132:135], v[160:163], v[104:119]
    ds_read_b128 v[132:135], v184 offset:512
    v_exp_f32 v54, v54
    v_exp_f32 v55, v55
    v_cvt_pk_bf16_f32 v80, v48, v49
    v_cvt_pk_bf16_f32 v81, v50, v51
    v_cvt_pk_bf16_f32 v82, v52, v53
    v_cvt_pk_bf16_f32 v83, v54, v55
    v_exp_f32 v56, v56
    v_exp_f32 v57, v57
    v_exp_f32 v58, v58
    v_exp_f32 v59, v59
    v_exp_f32 v60, v60
    v_exp_f32 v61, v61
    v_exp_f32 v62, v62
    v_exp_f32 v63, v63
    v_cvt_pk_bf16_f32 v84, v56, v57
    v_cvt_pk_bf16_f32 v85, v58, v59
    v_cvt_pk_bf16_f32 v86, v60, v61
    v_cvt_pk_bf16_f32 v87, v62, v63
    v_mfma_f32_32x32x16_bf16 v[48:63], v[120:123], v[8:11], v[16:31]
    v_exp_f32 v64, v64
    v_exp_f32 v65, v65
    v_exp_f32 v66, v66
    v_mfma_f32_32x32x16_bf16 v[88:103], v[136:139], v[80:83], v[88:103]
    v_exp_f32 v67, v67
    v_exp_f32 v68, v68
    v_exp_f32 v69, v69
    v_mfma_f32_32x32x16_bf16 v[88:103], v[140:143], v[84:87], v[88:103]
    s_waitcnt lgkmcnt(0)
    v_exp_f32 v70, v70
    v_exp_f32 v71, v71
    v_cvt_pk_bf16_f32 v156, v64, v65
    v_cvt_pk_bf16_f32 v157, v66, v67
    v_cvt_pk_bf16_f32 v158, v68, v69
    v_cvt_pk_bf16_f32 v159, v70, v71
    v_exp_f32 v72, v72
    v_exp_f32 v73, v73
    v_exp_f32 v74, v74
    v_exp_f32 v75, v75
    v_exp_f32 v76, v76
    v_exp_f32 v77, v77
    v_exp_f32 v78, v78
    v_exp_f32 v79, v79
    v_cvt_pk_bf16_f32 v160, v72, v73
    v_cvt_pk_bf16_f32 v161, v74, v75
    v_cvt_pk_bf16_f32 v162, v76, v77
    v_cvt_pk_bf16_f32 v163, v78, v79
    v_mfma_f32_32x32x16_bf16 v[64:79], v[120:123], v[12:15], v[32:47]
    ds_read_b128 v[120:123], v170 offset:18432
    v_exp_f32 v48, v48
    v_exp_f32 v49, v49
    v_exp_f32 v50, v50
    v_mfma_f32_32x32x16_bf16 v[104:119], v[136:139], v[156:159], v[104:119]
    ds_read_b128 v[136:139], v184 offset:1024
    v_exp_f32 v51, v51
    v_exp_f32 v52, v52
    v_exp_f32 v53, v53
    v_mfma_f32_32x32x16_bf16 v[104:119], v[140:143], v[160:163], v[104:119]
    ds_read_b128 v[140:143], v184 offset:1536
    v_exp_f32 v54, v54
    v_exp_f32 v55, v55
    v_cvt_pk_bf16_f32 v80, v48, v49
    v_cvt_pk_bf16_f32 v81, v50, v51
    v_cvt_pk_bf16_f32 v82, v52, v53
    v_cvt_pk_bf16_f32 v83, v54, v55
    v_exp_f32 v56, v56
    v_exp_f32 v57, v57
    v_exp_f32 v58, v58
    v_exp_f32 v59, v59
    v_exp_f32 v60, v60
    v_exp_f32 v61, v61
    v_exp_f32 v62, v62
    v_exp_f32 v63, v63
    v_cvt_pk_bf16_f32 v84, v56, v57
    v_cvt_pk_bf16_f32 v85, v58, v59
    v_cvt_pk_bf16_f32 v86, v60, v61
    v_cvt_pk_bf16_f32 v87, v62, v63
    v_mfma_f32_32x32x16_bf16 v[48:63], v[124:127], v[8:11], v[16:31]
    v_exp_f32 v64, v64
    v_exp_f32 v65, v65
    v_exp_f32 v66, v66
    v_mfma_f32_32x32x16_bf16 v[88:103], v[128:131], v[80:83], v[88:103]
    v_exp_f32 v67, v67
    v_exp_f32 v68, v68
    v_exp_f32 v69, v69
    v_mfma_f32_32x32x16_bf16 v[88:103], v[132:135], v[84:87], v[88:103]
    s_waitcnt lgkmcnt(0)
    v_exp_f32 v70, v70
    v_exp_f32 v71, v71
    v_cvt_pk_bf16_f32 v156, v64, v65
    v_cvt_pk_bf16_f32 v157, v66, v67
    v_cvt_pk_bf16_f32 v158, v68, v69
    v_cvt_pk_bf16_f32 v159, v70, v71
    v_exp_f32 v72, v72
    v_exp_f32 v73, v73
    v_exp_f32 v74, v74
    v_exp_f32 v75, v75
    v_exp_f32 v76, v76
    v_exp_f32 v77, v77
    v_exp_f32 v78, v78
    v_exp_f32 v79, v79
    v_cvt_pk_bf16_f32 v160, v72, v73
    v_cvt_pk_bf16_f32 v161, v74, v75
    v_cvt_pk_bf16_f32 v162, v76, v77
    v_cvt_pk_bf16_f32 v163, v78, v79
    v_mfma_f32_32x32x16_bf16 v[64:79], v[124:127], v[12:15], v[32:47]
    ds_read_b128 v[124:127], v170 offset:19456
    v_exp_f32 v48, v48
    v_exp_f32 v49, v49
    v_exp_f32 v50, v50
    v_mfma_f32_32x32x16_bf16 v[104:119], v[128:131], v[156:159], v[104:119]
    ds_read_b128 v[128:131], v184 offset:2048
    v_exp_f32 v51, v51
    v_exp_f32 v52, v52
    v_exp_f32 v53, v53
    v_mfma_f32_32x32x16_bf16 v[104:119], v[132:135], v[160:163], v[104:119]
    ds_read_b128 v[132:135], v184 offset:2560
    v_exp_f32 v54, v54
    v_exp_f32 v55, v55
    v_cvt_pk_bf16_f32 v80, v48, v49
    v_cvt_pk_bf16_f32 v81, v50, v51
    v_cvt_pk_bf16_f32 v82, v52, v53
    v_cvt_pk_bf16_f32 v83, v54, v55
    v_exp_f32 v56, v56
    v_exp_f32 v57, v57
    v_exp_f32 v58, v58
    v_exp_f32 v59, v59
    v_exp_f32 v60, v60
    v_exp_f32 v61, v61
    v_exp_f32 v62, v62
    v_exp_f32 v63, v63
    v_cvt_pk_bf16_f32 v84, v56, v57
    v_cvt_pk_bf16_f32 v85, v58, v59
    v_cvt_pk_bf16_f32 v86, v60, v61
    v_cvt_pk_bf16_f32 v87, v62, v63
    v_mfma_f32_32x32x16_bf16 v[48:63], v[120:123], v[8:11], v[16:31]
    v_exp_f32 v64, v64
    v_exp_f32 v65, v65
    v_exp_f32 v66, v66
    v_mfma_f32_32x32x16_bf16 v[88:103], v[136:139], v[80:83], v[88:103]
    v_exp_f32 v67, v67
    v_exp_f32 v68, v68
    v_exp_f32 v69, v69
    v_mfma_f32_32x32x16_bf16 v[88:103], v[140:143], v[84:87], v[88:103]
    s_waitcnt lgkmcnt(0)
    v_exp_f32 v70, v70
    v_exp_f32 v71, v71
    v_cvt_pk_bf16_f32 v156, v64, v65
    v_cvt_pk_bf16_f32 v157, v66, v67
    v_cvt_pk_bf16_f32 v158, v68, v69
    v_cvt_pk_bf16_f32 v159, v70, v71
    v_exp_f32 v72, v72
    v_exp_f32 v73, v73
    v_exp_f32 v74, v74
    v_exp_f32 v75, v75
    v_exp_f32 v76, v76
    v_exp_f32 v77, v77
    v_exp_f32 v78, v78
    v_exp_f32 v79, v79
    v_cvt_pk_bf16_f32 v160, v72, v73
    v_cvt_pk_bf16_f32 v161, v74, v75
    v_cvt_pk_bf16_f32 v162, v76, v77
    v_cvt_pk_bf16_f32 v163, v78, v79
    v_mfma_f32_32x32x16_bf16 v[64:79], v[120:123], v[12:15], v[32:47]
    ds_read_b128 v[120:123], v171 offset:16384
    v_exp_f32 v48, v48
    v_exp_f32 v49, v49
    v_exp_f32 v50, v50
    v_mfma_f32_32x32x16_bf16 v[104:119], v[136:139], v[156:159], v[104:119]
    ds_read_b128 v[136:139], v184 offset:3072
    v_exp_f32 v51, v51
    v_exp_f32 v52, v52
    v_exp_f32 v53, v53
    v_mfma_f32_32x32x16_bf16 v[104:119], v[140:143], v[160:163], v[104:119]
    ds_read_b128 v[140:143], v184 offset:3584
    v_exp_f32 v54, v54
    v_exp_f32 v55, v55
    v_cvt_pk_bf16_f32 v80, v48, v49
    v_cvt_pk_bf16_f32 v81, v50, v51
    v_cvt_pk_bf16_f32 v82, v52, v53
    v_cvt_pk_bf16_f32 v83, v54, v55
    v_exp_f32 v56, v56
    v_exp_f32 v57, v57
    v_exp_f32 v58, v58
    v_exp_f32 v59, v59
    v_exp_f32 v60, v60
    v_exp_f32 v61, v61
    v_exp_f32 v62, v62
    v_exp_f32 v63, v63
    v_cvt_pk_bf16_f32 v84, v56, v57
    v_cvt_pk_bf16_f32 v85, v58, v59
    v_cvt_pk_bf16_f32 v86, v60, v61
    v_cvt_pk_bf16_f32 v87, v62, v63
    v_mfma_f32_32x32x16_bf16 v[48:63], v[124:127], v[8:11], v[16:31]
    v_exp_f32 v64, v64
    v_exp_f32 v65, v65
    v_exp_f32 v66, v66
    v_mfma_f32_32x32x16_bf16 v[88:103], v[128:131], v[80:83], v[88:103]
    v_exp_f32 v67, v67
    v_exp_f32 v68, v68
    v_exp_f32 v69, v69
    v_mfma_f32_32x32x16_bf16 v[88:103], v[132:135], v[84:87], v[88:103]
    s_waitcnt lgkmcnt(0)
    v_exp_f32 v70, v70
    v_exp_f32 v71, v71
    v_cvt_pk_bf16_f32 v156, v64, v65
    v_cvt_pk_bf16_f32 v157, v66, v67
    v_cvt_pk_bf16_f32 v158, v68, v69
    v_cvt_pk_bf16_f32 v159, v70, v71
    v_exp_f32 v72, v72
    v_exp_f32 v73, v73
    v_exp_f32 v74, v74
    v_exp_f32 v75, v75
    v_exp_f32 v76, v76
    v_exp_f32 v77, v77
    v_exp_f32 v78, v78
    v_exp_f32 v79, v79
    v_cvt_pk_bf16_f32 v160, v72, v73
    v_cvt_pk_bf16_f32 v161, v74, v75
    v_cvt_pk_bf16_f32 v162, v76, v77
    v_cvt_pk_bf16_f32 v163, v78, v79
    v_mfma_f32_32x32x16_bf16 v[64:79], v[124:127], v[12:15], v[32:47]
    ds_read_b128 v[124:127], v171 offset:17408
    v_exp_f32 v48, v48
    v_exp_f32 v49, v49
    v_exp_f32 v50, v50
    v_mfma_f32_32x32x16_bf16 v[104:119], v[128:131], v[156:159], v[104:119]
    ds_read_b128 v[128:131], v185 offset:0
    v_exp_f32 v51, v51
    v_exp_f32 v52, v52
    v_exp_f32 v53, v53
    v_mfma_f32_32x32x16_bf16 v[104:119], v[132:135], v[160:163], v[104:119]
    ds_read_b128 v[132:135], v185 offset:512
    v_exp_f32 v54, v54
    v_exp_f32 v55, v55
    v_cvt_pk_bf16_f32 v80, v48, v49
    v_cvt_pk_bf16_f32 v81, v50, v51
    v_cvt_pk_bf16_f32 v82, v52, v53
    v_cvt_pk_bf16_f32 v83, v54, v55
a_pad4:
    s_cbranch_execz a_ret1
    v_exp_f32 v56, v56
    v_exp_f32 v57, v57
    v_exp_f32 v58, v58
    v_exp_f32 v59, v59
    v_exp_f32 v60, v60
    v_exp_f32 v61, v61
    v_exp_f32 v62, v62
    v_exp_f32 v63, v63
    v_cvt_pk_bf16_f32 v84, v56, v57
    v_cvt_pk_bf16_f32 v85, v58, v59
    v_cvt_pk_bf16_f32 v86, v60, v61
    v_cvt_pk_bf16_f32 v87, v62, v63
    v_mfma_f32_32x32x16_bf16 v[48:63], v[120:123], v[8:11], v[16:31]
    v_exp_f32 v64, v64
    v_exp_f32 v65, v65
    v_exp_f32 v66, v66
    v_mfma_f32_32x32x16_bf16 v[88:103], v[136:139], v[80:83], v[88:103]
    v_exp_f32 v67, v67
    v_exp_f32 v68, v68
    v_exp_f32 v69, v69
    v_mfma_f32_32x32x16_bf16 v[88:103], v[140:143], v[84:87], v[88:103]
    s_waitcnt lgkmcnt(0)
    v_exp_f32 v70, v70
    v_exp_f32 v71, v71
    v_cvt_pk_bf16_f32 v156, v64, v65
    v_cvt_pk_bf16_f32 v157, v66, v67
    v_cvt_pk_bf16_f32 v158, v68, v69
    v_cvt_pk_bf16_f32 v159, v70, v71
    v_exp_f32 v72, v72
    v_exp_f32 v73, v73
    v_exp_f32 v74, v74
    v_exp_f32 v75, v75
    v_exp_f32 v76, v76
    v_exp_f32 v77, v77
    v_exp_f32 v78, v78
    v_exp_f32 v79, v79
    v_cvt_pk_bf16_f32 v160, v72, v73
    v_cvt_pk_bf16_f32 v161, v74, v75
    v_cvt_pk_bf16_f32 v162, v76, v77
    v_cvt_pk_bf16_f32 v163, v78, v79
    v_mfma_f32_32x32x16_bf16 v[64:79], v[120:123], v[12:15], v[32:47]
    ds_read_b128 v[120:123], v171 offset:18432
    v_exp_f32 v48, v48
    v_exp_f32 v49, v49
    v_exp_f32 v50, v50
    v_mfma_f32_32x32x16_bf16 v[104:119], v[136:139], v[156:159], v[104:119]
    ds_read_b128 v[136:139], v185 offset:1024
    v_exp_f32 v51, v51
    v_exp_f32 v52, v52
    v_exp_f32 v53, v53
    v_mfma_f32_32x32x16_bf16 v[104:119], v[140:143], v[160:163], v[104:119]
    ds_read_b128 v[140:143], v185 offset:1536
    v_exp_f32 v54, v54
    v_exp_f32 v55, v55
    v_cvt_pk_bf16_f32 v80, v48, v49
    v_cvt_pk_bf16_f32 v81, v50, v51
    v_cvt_pk_bf16_f32 v82, v52, v53
    v_cvt_pk_bf16_f32 v83, v54, v55
    v_exp_f32 v56, v56
    v_exp_f32 v57, v57
    v_exp_f32 v58, v58
    v_exp_f32 v59, v59
    v_exp_f32 v60, v60
    v_exp_f32 v61, v61
    v_exp_f32 v62, v62
    v_exp_f32 v63, v63
    v_cvt_pk_bf16_f32 v84, v56, v57
    v_cvt_pk_bf16_f32 v85, v58, v59
    v_cvt_pk_bf16_f32 v86, v60, v61
    v_cvt_pk_bf16_f32 v87, v62, v63
    v_mfma_f32_32x32x16_bf16 v[48:63], v[124:127], v[8:11], v[16:31]
    v_exp_f32 v64, v64
    v_exp_f32 v65, v65
    v_exp_f32 v66, v66
    v_mfma_f32_32x32x16_bf16 v[88:103], v[128:131], v[80:83], v[88:103]
    v_exp_f32 v67, v67
    v_exp_f32 v68, v68
    v_exp_f32 v69, v69
    v_mfma_f32_32x32x16_bf16 v[88:103], v[132:135], v[84:87], v[88:103]
    s_waitcnt lgkmcnt(0)
    v_exp_f32 v70, v70
    v_exp_f32 v71, v71
    v_cvt_pk_bf16_f32 v156, v64, v65
    v_cvt_pk_bf16_f32 v157, v66, v67
    v_cvt_pk_bf16_f32 v158, v68, v69
    v_cvt_pk_bf16_f32 v159, v70, v71
    v_exp_f32 v72, v72
    v_exp_f32 v73, v73
    v_exp_f32 v74, v74
    v_exp_f32 v75, v75
    v_exp_f32 v76, v76
    v_exp_f32 v77, v77
    v_exp_f32 v78, v78
    v_exp_f32 v79, v79
    v_cvt_pk_bf16_f32 v160, v72, v73
    v_cvt_pk_bf16_f32 v161, v74, v75
    v_cvt_pk_bf16_f32 v162, v76, v77
    v_cvt_pk_bf16_f32 v163, v78, v79
    v_mfma_f32_32x32x16_bf16 v[64:79], v[124:127], v[12:15], v[32:47]
    ds_read_b128 v[124:127], v171 offset:19456
    v_exp_f32 v48, v48
    v_exp_f32 v49, v49
    v_exp_f32 v50, v50
    v_mfma_f32_32x32x16_bf16 v[104:119], v[128:131], v[156:159], v[104:119]
    ds_read_b128 v[128:131], v185 offset:2048
    v_exp_f32 v51, v51
    v_exp_f32 v52, v52
    v_exp_f32 v53, v53
    v_mfma_f32_32x32x16_bf16 v[104:119], v[132:135], v[160:163], v[104:119]
    ds_read_b128 v[132:135], v185 offset:2560
    v_exp_f32 v54, v54
    v_exp_f32 v55, v55
    v_cvt_pk_bf16_f32 v80, v48, v49
    v_cvt_pk_bf16_f32 v81, v50, v51
    v_cvt_pk_bf16_f32 v82, v52, v53
    v_cvt_pk_bf16_f32 v83, v54, v55
    v_exp_f32 v56, v56
    v_exp_f32 v57, v57
    v_exp_f32 v58, v58
    v_exp_f32 v59, v59
    v_exp_f32 v60, v60
    v_exp_f32 v61, v61
    v_exp_f32 v62, v62
    v_exp_f32 v63, v63
    v_cvt_pk_bf16_f32 v84, v56, v57
    v_cvt_pk_bf16_f32 v85, v58, v59
    v_cvt_pk_bf16_f32 v86, v60, v61
    v_cvt_pk_bf16_f32 v87, v62, v63
    v_mfma_f32_32x32x16_bf16 v[48:63], v[120:123], v[8:11], v[16:31]
    v_exp_f32 v64, v64
    v_exp_f32 v65, v65
    v_exp_f32 v66, v66
    v_mfma_f32_32x32x16_bf16 v[88:103], v[136:139], v[80:83], v[88:103]
    v_exp_f32 v67, v67
    v_exp_f32 v68, v68
    v_exp_f32 v69, v69
    v_mfma_f32_32x32x16_bf16 v[88:103], v[140:143], v[84:87], v[88:103]
    s_waitcnt lgkmcnt(0)
    v_exp_f32 v70, v70
    v_exp_f32 v71, v71
    v_cvt_pk_bf16_f32 v156, v64, v65
    v_cvt_pk_bf16_f32 v157, v66, v67
    v_cvt_pk_bf16_f32 v158, v68, v69
    v_cvt_pk_bf16_f32 v159, v70, v71
    v_exp_f32 v72, v72
    v_exp_f32 v73, v73
    v_exp_f32 v74, v74
    v_exp_f32 v75, v75
    v_exp_f32 v76, v76
    v_exp_f32 v77, v77
    v_exp_f32 v78, v78
    v_exp_f32 v79, v79
    v_cvt_pk_bf16_f32 v160, v72, v73
    v_cvt_pk_bf16_f32 v161, v74, v75
    v_cvt_pk_bf16_f32 v162, v76, v77
    v_cvt_pk_bf16_f32 v163, v78, v79
    v_mfma_f32_32x32x16_bf16 v[64:79], v[120:123], v[12:15], v[32:47]
    ds_read_b128 v[120:123], v170 offset:32768
    v_exp_f32 v48, v48
    v_exp_f32 v49, v49
    v_exp_f32 v50, v50
    v_mfma_f32_32x32x16_bf16 v[104:119], v[136:139], v[156:159], v[104:119]
    ds_read_b128 v[136:139], v185 offset:3072
    v_exp_f32 v51, v51
    v_exp_f32 v52, v52
    v_exp_f32 v53, v53
    v_mfma_f32_32x32x16_bf16 v[104:119], v[140:143], v[160:163], v[104:119]
    ds_read_b128 v[140:143], v185 offset:3584
    v_exp_f32 v54, v54
    v_exp_f32 v55, v55
    v_cvt_pk_bf16_f32 v80, v48, v49
    v_cvt_pk_bf16_f32 v81, v50, v51
    v_cvt_pk_bf16_f32 v82, v52, v53
    v_cvt_pk_bf16_f32 v83, v54, v55
    v_exp_f32 v56, v56
    v_exp_f32 v57, v57
    v_exp_f32 v58, v58
    v_exp_f32 v59, v59
    v_exp_f32 v60, v60
    v_exp_f32 v61, v61
    v_exp_f32 v62, v62
    v_exp_f32 v63, v63
    v_cvt_pk_bf16_f32 v84, v56, v57
    v_cvt_pk_bf16_f32 v85, v58, v59
    v_cvt_pk_bf16_f32 v86, v60, v61
    v_cvt_pk_bf16_f32 v87, v62, v63
    v_mfma_f32_32x32x16_bf16 v[48:63], v[124:127], v[8:11], v[16:31]
    v_exp_f32 v64, v64
    v_exp_f32 v65, v65
    v_exp_f32 v66, v66
    v_mfma_f32_32x32x16_bf16 v[88:103], v[128:131], v[80:83], v[88:103]
    v_exp_f32 v67, v67
    v_exp_f32 v68, v68
    v_exp_f32 v69, v69
    v_mfma_f32_32x32x16_bf16 v[88:103], v[132:135], v[84:87], v[88:103]
    s_waitcnt lgkmcnt(0)
    v_exp_f32 v70, v70
    v_exp_f32 v71, v71
    v_cvt_pk_bf16_f32 v156, v64, v65
    v_cvt_pk_bf16_f32 v157, v66, v67
    v_cvt_pk_bf16_f32 v158, v68, v69
    v_cvt_pk_bf16_f32 v159, v70, v71
    v_exp_f32 v72, v72
    v_exp_f32 v73, v73
    v_exp_f32 v74, v74
    v_exp_f32 v75, v75
    v_exp_f32 v76, v76
    v_exp_f32 v77, v77
    v_exp_f32 v78, v78
    v_exp_f32 v79, v79
    v_cvt_pk_bf16_f32 v160, v72, v73
    v_cvt_pk_bf16_f32 v161, v74, v75
    v_cvt_pk_bf16_f32 v162, v76, v77
    v_cvt_pk_bf16_f32 v163, v78, v79
    v_mfma_f32_32x32x16_bf16 v[64:79], v[124:127], v[12:15], v[32:47]
    ds_read_b128 v[124:127], v170 offset:33792
    v_exp_f32 v48, v48
    v_exp_f32 v49, v49
    v_exp_f32 v50, v50
    v_mfma_f32_32x32x16_bf16 v[104:119], v[128:131], v[156:159], v[104:119]
    ds_read_b128 v[128:131], v186 offset:0
    v_exp_f32 v51, v51
    v_exp_f32 v52, v52
    v_exp_f32 v53, v53
    v_mfma_f32_32x32x16_bf16 v[104:119], v[132:135], v[160:163], v[104:119]
    ds_read_b128 v[132:135], v186 offset:512
    v_exp_f32 v54, v54
    v_exp_f32 v55, v55
    v_cvt_pk_bf16_f32 v80, v48, v49
    v_cvt_pk_bf16_f32 v81, v50, v51
    v_cvt_pk_bf16_f32 v82, v52, v53
    v_cvt_pk_bf16_f32 v83, v54, v55
    v_exp_f32 v56, v56
    v_exp_f32 v57, v57
    v_exp_f32 v58, v58
    v_exp_f32 v59, v59
    v_exp_f32 v60, v60
    v_exp_f32 v61, v61
    v_exp_f32 v62, v62
    v_exp_f32 v63, v63
    v_cvt_pk_bf16_f32 v84, v56, v57
    v_cvt_pk_bf16_f32 v85, v58, v59
    v_cvt_pk_bf16_f32 v86, v60, v61
    v_cvt_pk_bf16_f32 v87, v62, v63
    v_mfma_f32_32x32x16_bf16 v[48:63], v[120:123], v[8:11], v[16:31]
    v_exp_f32 v64, v64
    v_exp_f32 v65, v65
    v_exp_f32 v66, v66
    v_mfma_f32_32x32x16_bf16 v[88:103], v[136:139], v[80:83], v[88:103]
    v_exp_f32 v67, v67
    v_exp_f32 v68, v68
    v_exp_f32 v69, v69
    v_mfma_f32_32x32x16_bf16 v[88:103], v[140:143], v[84:87], v[88:103]
    s_waitcnt lgkmcnt(0)
    v_exp_f32 v70, v70
    v_exp_f32 v71, v71
    v_cvt_pk_bf16_f32 v156, v64, v65
    v_cvt_pk_bf16_f32 v157, v66, v67
    v_cvt_pk_bf16_f32 v158, v68, v69
    v_cvt_pk_bf16_f32 v159, v70, v71
    v_exp_f32 v72, v72
    v_exp_f32 v73, v73
    v_exp_f32 v74, v74
    v_exp_f32 v75, v75
    v_exp_f32 v76, v76
    v_exp_f32 v77, v77
    v_exp_f32 v78, v78
    v_exp_f32 v79, v79
    v_cvt_pk_bf16_f32 v160, v72, v73
    v_cvt_pk_bf16_f32 v161, v74, v75
    v_cvt_pk_bf16_f32 v162, v76, v77
    v_cvt_pk_bf16_f32 v163, v78, v79
    v_mfma_f32_32x32x16_bf16 v[64:79], v[120:123], v[12:15], v[32:47]
    ds_read_b128 v[120:123], v170 offset:34816
    v_exp_f32 v48, v48
    v_exp_f32 v49, v49
    v_exp_f32 v50, v50
    v_mfma_f32_32x32x16_bf16 v[104:119], v[136:139], v[156:159], v[104:119]
    ds_read_b128 v[136:139], v186 offset:1024
    v_exp_f32 v51, v51
    v_exp_f32 v52, v52
    v_exp_f32 v53, v53
    v_mfma_f32_32x32x16_bf16 v[104:119], v[140:143], v[160:163], v[104:119]
    ds_read_b128 v[140:143], v186 offset:1536
    v_exp_f32 v54, v54
    v_exp_f32 v55, v55
    v_cvt_pk_bf16_f32 v80, v48, v49
    v_cvt_pk_bf16_f32 v81, v50, v51
    v_cvt_pk_bf16_f32 v82, v52, v53
    v_cvt_pk_bf16_f32 v83, v54, v55
    v_exp_f32 v56, v56
    v_exp_f32 v57, v57
    v_exp_f32 v58, v58
    v_exp_f32 v59, v59
    v_exp_f32 v60, v60
    v_exp_f32 v61, v61
    v_exp_f32 v62, v62
    v_exp_f32 v63, v63
    v_cvt_pk_bf16_f32 v84, v56, v57
    v_cvt_pk_bf16_f32 v85, v58, v59
    v_cvt_pk_bf16_f32 v86, v60, v61
    v_cvt_pk_bf16_f32 v87, v62, v63
    v_mfma_f32_32x32x16_bf16 v[48:63], v[124:127], v[8:11], v[16:31]
    v_exp_f32 v64, v64
    v_exp_f32 v65, v65
    v_exp_f32 v66, v66
    v_mfma_f32_32x32x16_bf16 v[88:103], v[128:131], v[80:83], v[88:103]
    v_exp_f32 v67, v67
    v_exp_f32 v68, v68
    v_exp_f32 v69, v69
    v_mfma_f32_32x32x16_bf16 v[88:103], v[132:135], v[84:87], v[88:103]
    s_waitcnt lgkmcnt(0)
    v_exp_f32 v70, v70
    v_exp_f32 v71, v71
    v_cvt_pk_bf16_f32 v156, v64, v65
    v_cvt_pk_bf16_f32 v157, v66, v67
    v_cvt_pk_bf16_f32 v158, v68, v69
    v_cvt_pk_bf16_f32 v159, v70, v71
    v_exp_f32 v72, v72
    v_exp_f32 v73, v73
    v_exp_f32 v74, v74
    v_exp_f32 v75, v75
    v_exp_f32 v76, v76
    v_exp_f32 v77, v77
    v_exp_f32 v78, v78
    v_exp_f32 v79, v79
    v_cvt_pk_bf16_f32 v160, v72, v73
    v_cvt_pk_bf16_f32 v161, v74, v75
    v_cvt_pk_bf16_f32 v162, v76, v77
    v_cvt_pk_bf16_f32 v163, v78, v79
    v_mfma_f32_32x32x16_bf16 v[64:79], v[124:127], v[12:15], v[32:47]
    ds_read_b128 v[124:127], v170 offset:35840
    v_exp_f32 v48, v48
    v_exp_f32 v49, v49
    v_exp_f32 v50, v50
    v_mfma_f32_32x32x16_bf16 v[104:119], v[128:131], v[156:159], v[104:119]
    ds_read_b128 v[128:131], v186 offset:2048
    v_exp_f32 v51, v51
    v_exp_f32 v52, v52
    v_exp_f32 v53, v53
    v_mfma_f32_32x32x16_bf16 v[104:119], v[132:135], v[160:163], v[104:119]
    ds_read_b128 v[132:135], v186 offset:2560
    v_exp_f32 v54, v54
    v_exp_f32 v55, v55
    v_cvt_pk_bf16_f32 v80, v48, v49
    v_cvt_pk_bf16_f32 v81, v50, v51
    v_cvt_pk_bf16_f32 v82, v52, v53
    v_cvt_pk_bf16_f32 v83, v54, v55
    v_exp_f32 v56, v56
    v_exp_f32 v57, v57
    v_exp_f32 v58, v58
    v_exp_f32 v59, v59
    v_exp_f32 v60, v60
    v_exp_f32 v61, v61
    v_exp_f32 v62, v62
    v_exp_f32 v63, v63
    v_cvt_pk_bf16_f32 v84, v56, v57
    v_cvt_pk_bf16_f32 v85, v58, v59
    v_cvt_pk_bf16_f32 v86, v60, v61
    v_cvt_pk_bf16_f32 v87, v62, v63
    v_mfma_f32_32x32x16_bf16 v[48:63], v[120:123], v[8:11], v[16:31]
    v_exp_f32 v64, v64
    v_exp_f32 v65, v65
    v_exp_f32 v66, v66
    v_mfma_f32_32x32x16_bf16 v[88:103], v[136:139], v[80:83], v[88:103]
    v_exp_f32 v67, v67
    v_exp_f32 v68, v68
    v_exp_f32 v69, v69
    v_mfma_f32_32x32x16_bf16 v[88:103], v[140:143], v[84:87], v[88:103]
    s_waitcnt lgkmcnt(0)
    v_exp_f32 v70, v70
    v_exp_f32 v71, v71
    v_cvt_pk_bf16_f32 v156, v64, v65
    v_cvt_pk_bf16_f32 v157, v66, v67
    v_cvt_pk_bf16_f32 v158, v68, v69
    v_cvt_pk_bf16_f32 v159, v70, v71
    v_exp_f32 v72, v72
    v_exp_f32 v73, v73
    v_exp_f32 v74, v74
    v_exp_f32 v75, v75
    v_exp_f32 v76, v76
    v_exp_f32 v77, v77
    v_exp_f32 v78, v78
    v_exp_f32 v79, v79
    v_cvt_pk_bf16_f32 v160, v72, v73
    v_cvt_pk_bf16_f32 v161, v74, v75
    v_cvt_pk_bf16_f32 v162, v76, v77
    v_cvt_pk_bf16_f32 v163, v78, v79
    v_mfma_f32_32x32x16_bf16 v[64:79], v[120:123], v[12:15], v[32:47]
    ds_read_b128 v[120:123], v171 offset:32768
    v_exp_f32 v48, v48
    v_exp_f32 v49, v49
    v_exp_f32 v50, v50
    v_mfma_f32_32x32x16_bf16 v[104:119], v[136:139], v[156:159], v[104:119]
    ds_read_b128 v[136:139], v186 offset:3072
    v_exp_f32 v51, v51
    v_exp_f32 v52, v52
    v_exp_f32 v53, v53
    v_mfma_f32_32x32x16_bf16 v[104:119], v[140:143], v[160:163], v[104:119]
    ds_read_b128 v[140:143], v186 offset:3584
    v_exp_f32 v54, v54
    v_exp_f32 v55, v55
    v_cvt_pk_bf16_f32 v80, v48, v49
    v_cvt_pk_bf16_f32 v81, v50, v51
    v_cvt_pk_bf16_f32 v82, v52, v53
    v_cvt_pk_bf16_f32 v83, v54, v55
    v_exp_f32 v56, v56
    v_exp_f32 v57, v57
    v_exp_f32 v58, v58
    v_exp_f32 v59, v59
    v_exp_f32 v60, v60
    v_exp_f32 v61, v61
    v_exp_f32 v62, v62
    v_exp_f32 v63, v63
    v_cvt_pk_bf16_f32 v84, v56, v57
    v_cvt_pk_bf16_f32 v85, v58, v59
    v_cvt_pk_bf16_f32 v86, v60, v61
    v_cvt_pk_bf16_f32 v87, v62, v63
    v_mfma_f32_32x32x16_bf16 v[48:63], v[124:127], v[8:11], v[16:31]
    v_exp_f32 v64, v64
    v_exp_f32 v65, v65
    v_exp_f32 v66, v66
    v_mfma_f32_32x32x16_bf16 v[88:103], v[128:131], v[80:83], v[88:103]
    v_exp_f32 v67, v67
    v_exp_f32 v68, v68
    v_exp_f32 v69, v69
    v_mfma_f32_32x32x16_bf16 v[88:103], v[132:135], v[84:87], v[88:103]
    s_waitcnt lgkmcnt(0)
    v_exp_f32 v70, v70
    v_exp_f32 v71, v71
    v_cvt_pk_bf16_f32 v156, v64, v65
    v_cvt_pk_bf16_f32 v157, v66, v67
    v_cvt_pk_bf16_f32 v158, v68, v69
    v_cvt_pk_bf16_f32 v159, v70, v71
    v_exp_f32 v72, v72
    v_exp_f32 v73, v73
    v_exp_f32 v74, v74
    v_exp_f32 v75, v75
    v_exp_f32 v76, v76
    v_exp_f32 v77, v77
    v_exp_f32 v78, v78
    v_exp_f32 v79, v79
    v_cvt_pk_bf16_f32 v160, v72, v73
    v_cvt_pk_bf16_f32 v161, v74, v75
    v_cvt_pk_bf16_f32 v162, v76, v77
    v_cvt_pk_bf16_f32 v163, v78, v79
    v_mfma_f32_32x32x16_bf16 v[64:79], v[124:127], v[12:15], v[32:47]
    ds_read_b128 v[124:127], v171 offset:33792
    v_exp_f32 v48, v48
    v_exp_f32 v49, v49
    v_exp_f32 v50, v50
    v_mfma_f32_32x32x16_bf16 v[104:119], v[128:131], v[156:159], v[104:119]
    ds_read_b128 v[128:131], v187 offset:0
    v_exp_f32 v51, v51
    v_exp_f32 v52, v52
    v_exp_f32 v53, v53
    v_mfma_f32_32x32x16_bf16 v[104:119], v[132:135], v[160:163], v[104:119]
    ds_read_b128 v[132:135], v187 offset:512
    v_exp_f32 v54, v54
    v_exp_f32 v55, v55
    v_cvt_pk_bf16_f32 v80, v48, v49
    v_cvt_pk_bf16_f32 v81, v50, v51
    v_cvt_pk_bf16_f32 v82, v52, v53
    v_cvt_pk_bf16_f32 v83, v54, v55
    v_exp_f32 v56, v56
    v_exp_f32 v57, v57
    v_exp_f32 v58, v58
    v_exp_f32 v59, v59
    v_exp_f32 v60, v60
    v_exp_f32 v61, v61
    v_exp_f32 v62, v62
    v_exp_f32 v63, v63
    v_cvt_pk_bf16_f32 v84, v56, v57
    v_cvt_pk_bf16_f32 v85, v58, v59
    v_cvt_pk_bf16_f32 v86, v60, v61
    v_cvt_pk_bf16_f32 v87, v62, v63
    v_mfma_f32_32x32x16_bf16 v[48:63], v[120:123], v[8:11], v[16:31]
    v_exp_f32 v64, v64
    v_exp_f32 v65, v65
    v_exp_f32 v66, v66
    v_mfma_f32_32x32x16_bf16 v[88:103], v[136:139], v[80:83], v[88:103]
    v_exp_f32 v67, v67
    v_exp_f32 v68, v68
    v_exp_f32 v69, v69
    v_mfma_f32_32x32x16_bf16 v[88:103], v[140:143], v[84:87], v[88:103]
    s_waitcnt lgkmcnt(0)
    v_exp_f32 v70, v70
    v_exp_f32 v71, v71
    v_cvt_pk_bf16_f32 v156, v64, v65
    v_cvt_pk_bf16_f32 v157, v66, v67
    v_cvt_pk_bf16_f32 v158, v68, v69
    v_cvt_pk_bf16_f32 v159, v70, v71
    v_exp_f32 v72, v72
    v_exp_f32 v73, v73
    v_exp_f32 v74, v74
    v_exp_f32 v75, v75
    v_exp_f32 v76, v76
    v_exp_f32 v77, v77
    v_exp_f32 v78, v78
    v_exp_f32 v79, v79
    v_cvt_pk_bf16_f32 v160, v72, v73
    v_cvt_pk_bf16_f32 v161, v74, v75
    v_cvt_pk_bf16_f32 v162, v76, v77
    v_cvt_pk_bf16_f32 v163, v78, v79
    v_mfma_f32_32x32x16_bf16 v[64:79], v[120:123], v[12:15], v[32:47]
    ds_read_b128 v[120:123], v171 offset:34816
    v_exp_f32 v48, v48
    v_exp_f32 v49, v49
    v_exp_f32 v50, v50
    v_mfma_f32_32x32x16_bf16 v[104:119], v[136:139], v[156:159], v[104:119]
    ds_read_b128 v[136:139], v187 offset:1024
    v_exp_f32 v51, v51
    v_exp_f32 v52, v52
    v_exp_f32 v53, v53
    v_mfma_f32_32x32x16_bf16 v[104:119], v[140:143], v[160:163], v[104:119]
    ds_read_b128 v[140:143], v187 offset:1536
    v_exp_f32 v54, v54
    v_exp_f32 v55, v55
    v_cvt_pk_bf16_f32 v80, v48, v49
    v_cvt_pk_bf16_f32 v81, v50, v51
    v_cvt_pk_bf16_f32 v82, v52, v53
    v_cvt_pk_bf16_f32 v83, v54, v55
    v_exp_f32 v56, v56
    v_exp_f32 v57, v57
    v_exp_f32 v58, v58
    v_exp_f32 v59, v59
    v_exp_f32 v60, v60
    v_exp_f32 v61, v61
    v_exp_f32 v62, v62
    v_exp_f32 v63, v63
    v_cvt_pk_bf16_f32 v84, v56, v57
    v_cvt_pk_bf16_f32 v85, v58, v59
    v_cvt_pk_bf16_f32 v86, v60, v61
    v_cvt_pk_bf16_f32 v87, v62, v63
    v_mfma_f32_32x32x16_bf16 v[48:63], v[124:127], v[8:11], v[16:31]
    v_exp_f32 v64, v64
    v_exp_f32 v65, v65
    v_exp_f32 v66, v66
    v_mfma_f32_32x32x16_bf16 v[88:103], v[128:131], v[80:83], v[88:103]
    v_exp_f32 v67, v67
    v_exp_f32 v68, v68
    v_exp_f32 v69, v69
    v_mfma_f32_32x32x16_bf16 v[88:103], v[132:135], v[84:87], v[88:103]
    s_waitcnt lgkmcnt(0)
    v_exp_f32 v70, v70
    v_exp_f32 v71, v71
    v_cvt_pk_bf16_f32 v156, v64, v65
    v_cvt_pk_bf16_f32 v157, v66, v67
    v_cvt_pk_bf16_f32 v158, v68, v69
    v_cvt_pk_bf16_f32 v159, v70, v71
    v_exp_f32 v72, v72
    v_exp_f32 v73, v73
    v_exp_f32 v74, v74
    v_exp_f32 v75, v75
    v_exp_f32 v76, v76
    v_exp_f32 v77, v77
    v_exp_f32 v78, v78
    v_exp_f32 v79, v79
    v_cvt_pk_bf16_f32 v160, v72, v73
    v_cvt_pk_bf16_f32 v161, v74, v75
    v_cvt_pk_bf16_f32 v162, v76, v77
    v_cvt_pk_bf16_f32 v163, v78, v79
    v_mfma_f32_32x32x16_bf16 v[64:79], v[124:127], v[12:15], v[32:47]
    ds_read_b128 v[124:127], v171 offset:35840
    v_exp_f32 v48, v48
    v_exp_f32 v49, v49
    v_exp_f32 v50, v50
    v_mfma_f32_32x32x16_bf16 v[104:119], v[128:131], v[156:159], v[104:119]
    ds_read_b128 v[128:131], v187 offset:2048
    v_exp_f32 v51, v51
    v_exp_f32 v52, v52
    v_exp_f32 v53, v53
    v_mfma_f32_32x32x16_bf16 v[104:119], v[132:135], v[160:163], v[104:119]
    ds_read_b128 v[132:135], v187 offset:2560
    v_exp_f32 v54, v54
    v_exp_f32 v55, v55
    v_cvt_pk_bf16_f32 v80, v48, v49
    v_cvt_pk_bf16_f32 v81, v50, v51
    v_cvt_pk_bf16_f32 v82, v52, v53
    v_cvt_pk_bf16_f32 v83, v54, v55
    v_exp_f32 v56, v56
    v_exp_f32 v57, v57
    v_exp_f32 v58, v58
    v_exp_f32 v59, v59
    v_exp_f32 v60, v60
    v_exp_f32 v61, v61
    v_exp_f32 v62, v62
    v_exp_f32 v63, v63
    v_cvt_pk_bf16_f32 v84, v56, v57
    v_cvt_pk_bf16_f32 v85, v58, v59
    v_cvt_pk_bf16_f32 v86, v60, v61
    v_cvt_pk_bf16_f32 v87, v62, v63
    v_mfma_f32_32x32x16_bf16 v[48:63], v[120:123], v[8:11], v[16:31]
    v_exp_f32 v64, v64
    v_exp_f32 v65, v65
    v_exp_f32 v66, v66
    v_mfma_f32_32x32x16_bf16 v[88:103], v[136:139], v[80:83], v[88:103]
    v_exp_f32 v67, v67
    v_exp_f32 v68, v68
    v_exp_f32 v69, v69
    v_mfma_f32_32x32x16_bf16 v[88:103], v[140:143], v[84:87], v[88:103]
    s_waitcnt lgkmcnt(0)
    v_exp_f32 v70, v70
    v_exp_f32 v71, v71
    v_cvt_pk_bf16_f32 v156, v64, v65
    v_cvt_pk_bf16_f32 v157, v66, v67
    v_cvt_pk_bf16_f32 v158, v68, v69
    v_cvt_pk_bf16_f32 v159, v70, v71
    v_exp_f32 v72, v72
    v_exp_f32 v73, v73
    v_exp_f32 v74, v74
    v_exp_f32 v75, v75
    v_exp_f32 v76, v76
    v_exp_f32 v77, v77
    v_exp_f32 v78, v78
    v_exp_f32 v79, v79
    v_cvt_pk_bf16_f32 v160, v72, v73
    v_cvt_pk_bf16_f32 v161, v74, v75
    v_cvt_pk_bf16_f32 v162, v76, v77
    v_cvt_pk_bf16_f32 v163, v78, v79
    v_mfma_f32_32x32x16_bf16 v[64:79], v[120:123], v[12:15], v[32:47]
    v_exp_f32 v48, v48
    v_exp_f32 v49, v49
    v_exp_f32 v50, v50
    v_mfma_f32_32x32x16_bf16 v[104:119], v[136:139], v[156:159], v[104:119]
    ds_read_b128 v[136:139], v187 offset:3072
    v_exp_f32 v51, v51
    v_exp_f32 v52, v52
    v_exp_f32 v53, v53
    v_mfma_f32_32x32x16_bf16 v[104:119], v[140:143], v[160:163], v[104:119]
    ds_read_b128 v[140:143], v187 offset:3584
    v_exp_f32 v54, v54
    v_exp_f32 v55, v55
    v_cvt_pk_bf16_f32 v80, v48, v49
    v_cvt_pk_bf16_f32 v81, v50, v51
    v_cvt_pk_bf16_f32 v82, v52, v53
    v_cvt_pk_bf16_f32 v83, v54, v55
    v_exp_f32 v56, v56
    v_exp_f32 v57, v57
    v_exp_f32 v58, v58
    v_exp_f32 v59, v59
    v_exp_f32 v60, v60
    v_exp_f32 v61, v61
    v_exp_f32 v62, v62
    v_exp_f32 v63, v63
    v_cvt_pk_bf16_f32 v84, v56, v57
    v_cvt_pk_bf16_f32 v85, v58, v59
    v_cvt_pk_bf16_f32 v86, v60, v61
    v_cvt_pk_bf16_f32 v87, v62, v63
    v_mfma_f32_32x32x16_bf16 v[48:63], v[124:127], v[8:11], v[16:31]
    v_exp_f32 v64, v64
    v_exp_f32 v65, v65
    v_exp_f32 v66, v66
    v_mfma_f32_32x32x16_bf16 v[88:103], v[128:131], v[80:83], v[88:103]
    v_exp_f32 v67, v67
    v_exp_f32 v68, v68
    v_exp_f32 v69, v69
    v_mfma_f32_32x32x16_bf16 v[88:103], v[132:135], v[84:87], v[88:103]
    s_waitcnt lgkmcnt(0)
    v_exp_f32 v70, v70
    v_exp_f32 v71, v71
    v_cvt_pk_bf16_f32 v156, v64, v65
    v_cvt_pk_bf16_f32 v157, v66, v67
    v_cvt_pk_bf16_f32 v158, v68, v69
    v_cvt_pk_bf16_f32 v159, v70, v71
    v_exp_f32 v72, v72
    v_exp_f32 v73, v73
    v_exp_f32 v74, v74
    v_exp_f32 v75, v75
    v_exp_f32 v76, v76
    v_exp_f32 v77, v77
    v_exp_f32 v78, v78
    v_exp_f32 v79, v79
    v_cvt_pk_bf16_f32 v160, v72, v73
    v_cvt_pk_bf16_f32 v161, v74, v75
    v_cvt_pk_bf16_f32 v162, v76, v77
    v_cvt_pk_bf16_f32 v163, v78, v79
    v_mfma_f32_32x32x16_bf16 v[64:79], v[124:127], v[12:15], v[32:47]
    v_exp_f32 v48, v48
    v_exp_f32 v49, v49
    v_exp_f32 v50, v50
    v_mfma_f32_32x32x16_bf16 v[104:119], v[128:131], v[156:159], v[104:119]
    v_exp_f32 v51, v51
    v_exp_f32 v52, v52
    v_exp_f32 v53, v53
    v_mfma_f32_32x32x16_bf16 v[104:119], v[132:135], v[160:163], v[104:119]
    v_exp_f32 v54, v54
    v_exp_f32 v55, v55
    v_cvt_pk_bf16_f32 v80, v48, v49
    v_cvt_pk_bf16_f32 v81, v50, v51
    v_cvt_pk_bf16_f32 v82, v52, v53
    v_cvt_pk_bf16_f32 v83, v54, v55
    v_exp_f32 v56, v56
    v_exp_f32 v57, v57
    v_exp_f32 v58, v58
    v_exp_f32 v59, v59
    v_exp_f32 v60, v60
    v_exp_f32 v61, v61
    v_exp_f32 v62, v62
    v_exp_f32 v63, v63
    v_cvt_pk_bf16_f32 v84, v56, v57
    v_cvt_pk_bf16_f32 v85, v58, v59
    v_cvt_pk_bf16_f32 v86, v60, v61
    v_cvt_pk_bf16_f32 v87, v62, v63
    v_mfma_f32_32x32x16_bf16 v[88:103], v[136:139], v[80:83], v[88:103]
    v_exp_f32 v64, v64
    v_exp_f32 v65, v65
    v_exp_f32 v66, v66
    v_mfma_f32_32x32x16_bf16 v[88:103], v[140:143], v[84:87], v[88:103]
    v_exp_f32 v67, v67
    v_exp_f32 v68, v68
    v_exp_f32 v69, v69
    v_exp_f32 v70, v70
    v_exp_f32 v71, v71
    v_cvt_pk_bf16_f32 v156, v64, v65
    v_cvt_pk_bf16_f32 v157, v66, v67
    v_cvt_pk_bf16_f32 v158, v68, v69
    v_cvt_pk_bf16_f32 v159, v70, v71
    v_exp_f32 v72, v72
    v_exp_f32 v73, v73
    v_mfma_f32_32x32x16_bf16 v[104:119], v[136:139], v[156:159], v[104:119]
a_pad5:
    s_cbranch_execz a_ret1
    v_exp_f32 v74, v74
    v_exp_f32 v75, v75
    v_exp_f32 v76, v76
    v_exp_f32 v77, v77
    v_exp_f32 v78, v78
    v_exp_f32 v79, v79
    v_cvt_pk_bf16_f32 v160, v72, v73
    v_cvt_pk_bf16_f32 v161, v74, v75
    v_cvt_pk_bf16_f32 v162, v76, v77
    v_cvt_pk_bf16_f32 v163, v78, v79
    v_rcp_f32 v6, v96
    s_nop 0
    v_mfma_f32_32x32x16_bf16 v[104:119], v[140:143], v[160:163], v[104:119]
    v_mov_b32 v7, v6
    v_pk_mul_f32 v[88:89], v[88:89], v[6:7]
    v_pk_mul_f32 v[90:91], v[90:91], v[6:7]
    v_pk_mul_f32 v[92:93], v[92:93], v[6:7]
    v_pk_mul_f32 v[94:95], v[94:95], v[6:7]
    v_cvt_pk_bf16_f32 v64, v88, v89
    v_cvt_pk_bf16_f32 v65, v90, v91
    v_cvt_pk_bf16_f32 v66, v92, v93
    v_cvt_pk_bf16_f32 v67, v94, v95
    v_min_u32 v64, 0xfffeffff, v64
    v_min_u32 v65, 0xfffeffff, v65
    v_min_u32 v66, 0xfffeffff, v66
    v_min_u32 v67, 0xfffeffff, v67
    v_add_f32 v5, v96, v112
    v_cmp_nge_f32 vcc, 0x5d800000, v5
    v_rcp_f32 v6, v112
    s_nop 0
    v_mov_b32 v7, v6
    v_pk_mul_f32 v[104:105], v[104:105], v[6:7]
    v_pk_mul_f32 v[106:107], v[106:107], v[6:7]
    v_pk_mul_f32 v[108:109], v[108:109], v[6:7]
    v_pk_mul_f32 v[110:111], v[110:111], v[6:7]
    v_cvt_pk_bf16_f32 v68, v104, v105
    v_cvt_pk_bf16_f32 v69, v106, v107
    v_cvt_pk_bf16_f32 v70, v108, v109
    v_cvt_pk_bf16_f32 v71, v110, v111
    v_min_u32 v68, 0xfffeffff, v68
    v_min_u32 v69, 0xfffeffff, v69
    v_min_u32 v70, 0xfffeffff, v70
    v_min_u32 v71, 0xfffeffff, v71
    s_cbranch_vccnz a_fb
a_fin:
    buffer_store_dwordx4 v[64:67], v3, s[12:15], s34 offen sc1
    buffer_store_dwordx4 v[68:71], v3, s[12:15], s35 offen sc1
    s_mov_b64 exec, 1
    ds_add_u32 v153, v152 offset:48
    s_mov_b64 exec, -1
    s_waitcnt lgkmcnt(0)
    s_endpgm
a_ck1:
    v_readlane_b32 s21, v172, 56
    s_nop 3
    v_mov_b32 v4, s21
    s_mov_b32 s97, 0
a_all1_ld:
    ds_read_b32 v5, v4 offset:2048
    s_waitcnt lgkmcnt(0)
    v_readfirstlane_b32 s20, v5
    s_nop 3
    s_cmp_ge_u32 s20, 4
    s_cbranch_scc1 a_all1_ok
    s_add_u32 s97, s97, 1
    s_cmp_gt_u32 s97, 262144
    s_cbranch_scc1 a_all1_ok
    s_sleep 1
    s_branch a_all1_ld
a_all1_ok:
    s_branch a_cb1
a_ck5:
    v_readlane_b32 s21, v172, 57
    s_nop 3
    v_mov_b32 v4, s21
    s_mov_b32 s97, 0
a_all5_ld:
    ds_read_b32 v5, v4 offset:2048
    s_waitcnt lgkmcnt(0)
    v_readfirstlane_b32 s20, v5
    s_nop 3
    s_cmp_ge_u32 s20, 4
    s_cbranch_scc1 a_all5_ok
    s_add_u32 s97, s97, 1
    s_cmp_gt_u32 s97, 262144
    s_cbranch_scc1 a_all5_ok
    s_sleep 1
    s_branch a_all5_ld
a_all5_ok:
    s_branch a_cb5
a_ck13:
    v_readlane_b32 s21, v172, 58
    s_nop 3
    v_mov_b32 v4, s21
    s_mov_b32 s97, 0
a_all13_ld:
    ds_read_b32 v5, v4 offset:2048
    s_waitcnt lgkmcnt(0)
    v_readfirstlane_b32 s20, v5
    s_nop 3
    s_cmp_ge_u32 s20, 4
    s_cbranch_scc1 a_all13_ok
    s_add_u32 s97, s97, 1
    s_cmp_gt_u32 s97, 262144
    s_cbranch_scc1 a_all13_ok
    s_sleep 1
    s_branch a_all13_ld
a_all13_ok:
    s_branch a_cb13
a_ck29:
    v_readlane_b32 s21, v172, 59
    s_nop 3
    v_mov_b32 v4, s21
    s_mov_b32 s97, 0
a_all29_ld:
    ds_read_b32 v5, v4 offset:2048
    s_waitcnt lgkmcnt(0)
    v_readfirstlane_b32 s20, v5
    s_nop 3
    s_cmp_ge_u32 s20, 4
    s_cbranch_scc1 a_all29_ok
    s_add_u32 s97, s97, 1
    s_cmp_gt_u32 s97, 262144
    s_cbranch_scc1 a_all29_ok
    s_sleep 1
    s_branch a_all29_ld
a_all29_ok:
    s_branch a_cb29
a_fb:
    s_cmp_lg_u32 s36, 0
    s_cbranch_scc1 a_fin
    s_waitcnt lgkmcnt(0)
    s_mov_b32 s36, 1
    v_mov_b32 v4, 0xff61b1e6
    v_mov_b32 v6, 0xff61b1e6
    s_mov_b32 s37, 0
a_mx:
    s_lshr_b32 s20, s37, 2
    s_lshl_b32 s20, s20, 13
    s_and_b32 s21, s37, 3
    s_lshl_b32 s21, s21, 10
    s_add_u32 s20, s20, s21
    v_add_u32 v5, s20, v3
    ds_read_b128 v[120:123], v5
    s_waitcnt lgkmcnt(0)
    v_mfma_f32_32x32x16_bf16 v[48:63], v[120:123], v[8:11], 0
    v_mfma_f32_32x32x16_bf16 v[64:79], v[120:123], v[12:15], 0
    s_nop 15
    v_max3_f32 v4, v4, v48, v49
    v_max3_f32 v4, v4, v50, v51
    v_max3_f32 v4, v4, v52, v53
    v_max3_f32 v4, v4, v54, v55
    v_max3_f32 v4, v4, v56, v57
    v_max3_f32 v4, v4, v58, v59
    v_max3_f32 v4, v4, v60, v61
    v_max3_f32 v4, v4, v62, v63
    v_max3_f32 v6, v6, v64, v65
    v_max3_f32 v6, v6, v66, v67
    v_max3_f32 v6, v6, v68, v69
    v_max3_f32 v6, v6, v70, v71
    v_max3_f32 v6, v6, v72, v73
    v_max3_f32 v6, v6, v74, v75
    v_max3_f32 v6, v6, v76, v77
    v_max3_f32 v6, v6, v78, v79
    s_add_u32 s37, s37, 1
    s_cmp_lt_u32 s37, 64
    s_cbranch_scc1 a_mx
    v_mov_b32 v5, v4
    s_nop 1
    v_permlane32_swap_b32 v4, v5
    s_nop 1
    v_min_f32 v4, -v4, -v5
    v_mov_b32 v5, v4
    v_mov_b64 v[16:17], v[4:5]
    v_mov_b64 v[18:19], v[4:5]
    v_mov_b64 v[20:21], v[4:5]
    v_mov_b64 v[22:23], v[4:5]
    v_mov_b64 v[24:25], v[4:5]
    v_mov_b64 v[26:27], v[4:5]
    v_mov_b64 v[28:29], v[4:5]
    v_mov_b64 v[30:31], v[4:5]
    v_mov_b32 v7, v6
    s_nop 1
    v_permlane32_swap_b32 v6, v7
    s_nop 1
    v_min_f32 v6, -v6, -v7
    v_mov_b32 v7, v6
    v_mov_b64 v[32:33], v[6:7]
    v_mov_b64 v[34:35], v[6:7]
    v_mov_b64 v[36:37], v[6:7]
    v_mov_b64 v[38:39], v[6:7]
    v_mov_b64 v[40:41], v[6:7]
    v_mov_b64 v[42:43], v[6:7]
    v_mov_b64 v[44:45], v[6:7]
    v_mov_b64 v[46:47], v[6:7]
    ds_read_b128 v[120:123], v164
    s_waitcnt lgkmcnt(0)
    v_mfma_f32_32x32x16_bf16 v[48:63], v[120:123], v[8:11], v[16:31]
    s_nop 15
    s_branch a_start
k_g:
    s_waitcnt lgkmcnt(0)
    s_mov_b32 s12, s62
    s_and_b32 s13, s63, 0xffff
    s_mov_b32 s14, 59768832
    s_mov_b32 s15, 0x00020000
    s_mov_b32 s24, s60
    s_and_b32 s25, s61, 0xffff
    s_mov_b32 s26, 256
    s_mov_b32 s27, 0x00020000
    s_sub_u32 s30, s30, 4
    s_lshl_b32 s34, s31, 2
    s_add_u32 s34, s34, s30
    v_lshlrev_b32 v4, 2, v1
    v_add_u32 v4, 143360, v4
    v_mov_b32 v5, 0
    ds_write_b32 v4, v5
    s_and_b32 s20, s29, 7
    s_lshl_b32 s20, s20, 2
    s_add_u32 s20, s20, s30
    s_lshl_b32 s20, s20, 4
    s_add_u32 s20, s20, s28
    s_lshl_b32 s20, s20, 2
    s_lshr_b32 s21, s29, 3
    s_add_u32 s20, s20, s21
    s_lshl_b32 s20, s20, 10
    s_add_u32 s42, s20, 6291456
    s_cmp_ge_u32 s2, 8
    s_cbranch_scc1 g_noreset
    v_mov_b32 v48, 0
    v_mov_b32 v49, 0
    v_mov_b32 v50, 0
    v_mov_b32 v51, 0
    s_lshl_b32 s20, s2, 2
    s_add_u32 s20, s20, s30
    s_lshl_b32 s20, s20, 10
    s_add_u32 s20, s20, 56623104
    buffer_store_dwordx4 v[48:51], v3, s[12:15], s20 offen sc1
g_noreset:
    v_and_b32 v5, 31, v1
    v_lshrrev_b32 v6, 5, v1
    v_bfe_u32 v7, v1, 1, 3
    s_lshl_b32 s20, s30, 12
    v_lshl_add_u32 v12, v5, 7, s20
    v_add_u32 v13, 0, v6
    v_xor_b32 v13, v13, v7
    v_lshl_add_u32 v8, v13, 4, v12
    v_add_u32 v13, 2, v6
    v_xor_b32 v13, v13, v7
    v_lshl_add_u32 v9, v13, 4, v12
    v_add_u32 v13, 4, v6
    v_xor_b32 v13, v13, v7
    v_lshl_add_u32 v10, v13, 4, v12
    v_add_u32 v13, 6, v6
    v_xor_b32 v13, v13, v7
    v_lshl_add_u32 v11, v13, 4, v12
    v_bfe_u32 v13, v1, 4, 1
    v_lshlrev_b32 v13, 5, v13
    v_and_b32 v14, 3, v1
    v_lshl_add_u32 v13, v14, 3, v13
    v_bfe_u32 v14, v1, 2, 2
    v_lshl_add_u32 v13, v14, 6, v13
    v_lshl_add_u32 v12, v6, 9, v13
    v_lshl_add_u32 v14, v6, 8, v13
    v_mov_b32 v64, 0
    v_mov_b32 v65, 0
    v_mov_b32 v66, 0
    v_mov_b32 v67, 0
    v_mov_b32 v68, 0
    v_mov_b32 v69, 0
    v_mov_b32 v70, 0
    v_mov_b32 v71, 0
    v_mov_b32 v72, 0
    v_mov_b32 v73, 0
    v_mov_b32 v74, 0
    v_mov_b32 v75, 0
    v_mov_b32 v76, 0
    v_mov_b32 v77, 0
    v_mov_b32 v78, 0
    v_mov_b32 v79, 0
    v_mov_b32 v80, 0
    v_mov_b32 v81, 0
    v_mov_b32 v82, 0
    v_mov_b32 v83, 0
    v_mov_b32 v84, 0
    v_mov_b32 v85, 0
    v_mov_b32 v86, 0
    v_mov_b32 v87, 0
    v_mov_b32 v88, 0
    v_mov_b32 v89, 0
    v_mov_b32 v90, 0
    v_mov_b32 v91, 0
    v_mov_b32 v92, 0
    v_mov_b32 v93, 0
    v_mov_b32 v94, 0
    v_mov_b32 v95, 0
    v_mov_b32 v96, 0
    v_mov_b32 v97, 0
    v_mov_b32 v98, 0
    v_mov_b32 v99, 0
    v_mov_b32 v100, 0
    v_mov_b32 v101, 0
    v_mov_b32 v102, 0
    v_mov_b32 v103, 0
    v_mov_b32 v104, 0
    v_mov_b32 v105, 0
    v_mov_b32 v106, 0
    v_mov_b32 v107, 0
    v_mov_b32 v108, 0
    v_mov_b32 v109, 0
    v_mov_b32 v110, 0
    v_mov_b32 v111, 0
    v_add_u32 v24, 86016, v8
    v_add_u32 v25, 86016, v9
    v_add_u32 v26, 86016, v10
    v_add_u32 v27, 86016, v11
    v_add_u32 v28, 0x10000, v12
    v_add_u32 v29, 0x20000, v12
    v_lshlrev_b32 v15, 1, v5
    v_add_u32 v15, 143616, v15
    v_mov_b32 v16, 0
    v_mov_b32 v22, 1
    s_lshr_b32 s35, s32, 1
    s_lshl_b32 s35, s35, 2
    s_lshl_b32 s38, s35, 7
    s_add_u32 s38, s38, s34
    s_lshl_b32 s38, s38, 10
    s_add_u32 s38, s38, 2097152
    s_lshl_b32 s22, s28, 2
    s_lshr_b32 s20, s29, 3
    s_add_u32 s22, s22, s20
    s_and_b32 s21, s29, 7
    s_lshl_b32 s21, s21, 1
    s_mul_i32 s40, s30, 3
    s_add_u32 s21, s21, s40
    s_add_u32 s41, s21, 4
    s_lshr_b32 s23, s22, 2
    s_lshl_b32 s23, s23, 11
    s_add_u32 s23, s23, 56639488
    s_lshl_b32 s22, s22, 17
    s_add_u32 s22, s22, 2097152
    s_lshl_b32 s40, s30, 13
    s_lshl_b32 s43, s30, 1
    s_add_u32 s43, s43, 8
    s_cmp_eq_u32 s30, 0
    s_cselect_b32 s43, 4, s43
    s_lshl_b32 s43, s43, 13
    v_min_u32 v31, 5, v1
    v_lshlrev_b32 v31, 6, v31
    s_lshl_b32 s20, s41, 7
    v_add_u32 v31, s20, v31
    v_and_b32 v31, 0x7ff, v31
    s_mov_b32 s4, s52
    s_and_b32 s5, s53, 0xffff
    s_mov_b32 s6, 1835008
    s_mov_b32 s7, 0x00020000
    s_mov_b32 s8, s44
    s_and_b32 s9, s45, 0xffff
    s_mov_b32 s10, 524288
    s_mov_b32 s11, 0x00020000
    s_mov_b32 s16, s54
    s_and_b32 s17, s55, 0xffff
    s_mov_b32 s18, 1024
    s_mov_b32 s19, 0x00020000
    s_mov_b32 s80, s58
    s_and_b32 s81, s59, 0xffff
    s_mov_b32 s82, 2097152
    s_mov_b32 s83, 0x00020000
    s_mov_b32 s84, s48
    s_and_b32 s85, s49, 0xffff
    s_mov_b32 s86, 1835008
    s_mov_b32 s87, 0x00020000
    v_lshrrev_b32 v19, 2, v1
    v_and_b32 v20, 3, v1
    v_lshlrev_b32 v4, 10, v19
    v_lshl_add_u32 v4, v20, 4, v4
    s_lshl_b32 s20, s28, 4
    s_lshr_b32 s21, s29, 3
    s_lshl_b32 s21, s21, 2
    s_add_u32 s20, s20, s21
    s_add_u32 s20, s20, s30
    s_and_b32 s21, s29, 7
    s_mul_i32 s48, s21, 294912
    s_add_u32 s48, s48, 15990784
    s_lshl_b32 s21, s21, 7
    s_cmp_lt_u32 s20, 32
    s_cselect_b32 s8, s8, s4
    s_cselect_b32 s9, s9, s5
    s_cselect_b32 s10, s10, s6
    s_cselect_b32 s46, 0, -32
    s_add_u32 s46, s46, s20
    s_lshl_b32 s46, s46, 14
    s_add_u32 s46, s46, s21
    s_and_b32 s47, s20, 15
    s_lshl_b32 s49, s47, 10
    s_add_u32 s49, s49, s48
    s_add_u32 s49, s49, 131072
    s_lshl_b32 s47, s47, 14
    s_add_u32 s47, s47, s21
    s_add_u32 s47, s47, 1572864
    s_lshl_b32 s20, s20, 10
    s_add_u32 s48, s48, s20
    s_lshl_b32 s20, s30, 12
    s_add_u32 s20, s20, 147456
    v_add_u32 v7, s20, v14
    v_add_u32 v2, s20, v3
    s_lshl_b32 s20, s28, 1
    s_lshr_b32 s21, s29, 4
    s_add_u32 s20, s20, s21
    s_and_b32 s21, s29, 7
    v_mov_b32 v13, s21
    v_mov_b32 v14, s28
    v_cmp_gt_u32 vcc, 2, v1
    v_cndmask_b32 v14, v14, v13, vcc
    v_and_b32 v13, 1, v1
    v_lshl_add_u32 v14, v13, 3, v14
    v_mov_b32 v13, s20
    v_cmp_gt_u32 vcc, 4, v1
    v_cndmask_b32 v14, v13, v14, vcc
    v_lshl_add_u32 v14, s28, 4, v14
    v_lshlrev_b32 v14, 1, v14
    v_lshlrev_b32 v14, 6, v14
    v_mul_u32_u24 v30, 3584, v19
    v_lshl_add_u32 v30, v20, 4, v30
    s_cmp_lt_u32 s32, 8
    s_cselect_b32 s20, s33, s32
    s_cselect_b32 s21, 1, 0
    s_and_b32 s20, s20, 1
    s_lshl_b32 s90, s20, s21
    s_lshl_b32 s20, s20, 1
    s_sub_u32 s91, 2, s20
    s_mul_i32 s20, s32, 3
    s_min_u32 s21, s32, 8
    s_add_u32 s20, s20, s21
    s_add_u32 s90, s90, s20
    s_add_u32 s91, s91, s20
    s_mul_i32 s39, s30, 57344
    s_lshl_b32 s20, s91, 6
    s_add_u32 s39, s39, s20
    s_mul_i32 s20, s34, 56
    s_add_u32 s90, s90, s20
    s_lshl_b32 s90, s90, 11
    s_add_u32 s90, s90, 8388608
    s_add_u32 s91, s91, s20
    s_lshl_b32 s91, s91, 11
    s_add_u32 s91, s91, 8388608
    s_lshl_b32 s88, s30, 10
    v_mov_b32 v17, 143360
    s_waitcnt lgkmcnt(0)
    s_mov_b32 s12, s62
    s_and_b32 s13, s63, 0xffff
    s_mov_b32 s14, 59768832
    s_mov_b32 s15, 0x00020000
    s_mov_b32 s3, 0
    s_sub_u32 s23, s23, s3
    s_bitcmp1_b32 s32, 0
    s_cbranch_scc1 g_vpath
    s_barrier
    ds_read_b128 v[128:131], v8 offset:0
    ds_read_b64_tr_b16 v[32:33], v12 offset:16384
    ds_read_b64_tr_b16 v[34:35], v12 offset:16640
    ds_read_b64_tr_b16 v[36:37], v12 offset:20480
    ds_read_b64_tr_b16 v[38:39], v12 offset:20736
    ds_read_b64_tr_b16 v[40:41], v12 offset:24576
    ds_read_b64_tr_b16 v[42:43], v12 offset:24832
    ds_read_b128 v[132:135], v9 offset:0
    ds_read_b64_tr_b16 v[44:45], v12 offset:17408
    ds_read_b64_tr_b16 v[46:47], v12 offset:17664
    ds_read_b64_tr_b16 v[48:49], v12 offset:21504
    ds_read_b64_tr_b16 v[50:51], v12 offset:21760
    ds_read_b64_tr_b16 v[52:53], v12 offset:25600
    ds_read_b64_tr_b16 v[54:55], v12 offset:25856
    s_waitcnt lgkmcnt(11)
    v_mfma_f32_32x32x16_bf16 v[64:79], v[32:35], v[128:131], v[64:79]
    ds_read_b128 v[136:139], v10 offset:0
    ds_read_b64_tr_b16 v[56:57], v12 offset:18432
    ds_read_b64_tr_b16 v[58:59], v12 offset:18688
    s_waitcnt lgkmcnt(12)
    v_mfma_f32_32x32x16_bf16 v[80:95], v[36:39], v[128:131], v[80:95]
    ds_read_b64_tr_b16 v[60:61], v12 offset:22528
    ds_read_b64_tr_b16 v[62:63], v12 offset:22784
    s_waitcnt lgkmcnt(12)
    v_mfma_f32_32x32x16_bf16 v[96:111], v[40:43], v[128:131], v[96:111]
    ds_read_b64_tr_b16 v[32:33], v12 offset:26624
    ds_read_b64_tr_b16 v[34:35], v12 offset:26880
    s_waitcnt lgkmcnt(11)
    v_mfma_f32_32x32x16_bf16 v[64:79], v[44:47], v[132:135], v[64:79]
    ds_read_b128 v[140:143], v11 offset:0
    ds_read_b64_tr_b16 v[36:37], v12 offset:19456
    ds_read_b64_tr_b16 v[38:39], v12 offset:19712
    s_cmp_ge_u32 s2, 8
    s_cbranch_scc1 g_nocntk
    s_waitcnt vmcnt(0)
    s_mov_b64 exec, 1
    buffer_atomic_add v22, v16, s[24:27], 0 offen sc1
    s_mov_b64 exec, -1
g_nocntk:
    s_waitcnt lgkmcnt(12)
    v_mfma_f32_32x32x16_bf16 v[80:95], v[48:51], v[132:135], v[80:95]
    ds_read_b64_tr_b16 v[40:41], v12 offset:23552
    ds_read_b64_tr_b16 v[42:43], v12 offset:23808
    s_waitcnt lgkmcnt(12)
    v_mfma_f32_32x32x16_bf16 v[96:111], v[52:55], v[132:135], v[96:111]
    ds_read_b64_tr_b16 v[44:45], v12 offset:27648
    ds_read_b64_tr_b16 v[46:47], v12 offset:27904
    s_waitcnt lgkmcnt(11)
    v_mfma_f32_32x32x16_bf16 v[64:79], v[56:59], v[136:139], v[64:79]
    s_barrier
    ds_read_b128 v[144:147], v8 offset:28672
    ds_read_b64_tr_b16 v[48:49], v12 offset:45056
    ds_read_b64_tr_b16 v[50:51], v12 offset:45312
    s_waitcnt lgkmcnt(12)
    v_mfma_f32_32x32x16_bf16 v[80:95], v[60:63], v[136:139], v[80:95]
    ds_read_b64_tr_b16 v[52:53], v12 offset:49152
    ds_read_b64_tr_b16 v[54:55], v12 offset:49408
    s_waitcnt lgkmcnt(12)
    v_mfma_f32_32x32x16_bf16 v[96:111], v[32:35], v[136:139], v[96:111]
    ds_read_b64_tr_b16 v[56:57], v12 offset:53248
    ds_read_b64_tr_b16 v[58:59], v12 offset:53504
    s_waitcnt lgkmcnt(11)
    v_mfma_f32_32x32x16_bf16 v[64:79], v[36:39], v[140:143], v[64:79]
    ds_read_b128 v[148:151], v9 offset:28672
    ds_read_b64_tr_b16 v[60:61], v12 offset:46080
    ds_read_b64_tr_b16 v[62:63], v12 offset:46336
    s_waitcnt lgkmcnt(12)
    v_mfma_f32_32x32x16_bf16 v[80:95], v[40:43], v[140:143], v[80:95]
    ds_read_b64_tr_b16 v[32:33], v12 offset:50176
    ds_read_b64_tr_b16 v[34:35], v12 offset:50432
    s_waitcnt lgkmcnt(12)
    v_mfma_f32_32x32x16_bf16 v[96:111], v[44:47], v[140:143], v[96:111]
    ds_read_b64_tr_b16 v[36:37], v12 offset:54272
    ds_read_b64_tr_b16 v[38:39], v12 offset:54528
    s_waitcnt lgkmcnt(11)
    v_mfma_f32_32x32x16_bf16 v[64:79], v[48:51], v[144:147], v[64:79]
    ds_read_b128 v[152:155], v10 offset:28672
    ds_read_b64_tr_b16 v[40:41], v12 offset:47104
    ds_read_b64_tr_b16 v[42:43], v12 offset:47360
    s_waitcnt lgkmcnt(12)
    v_mfma_f32_32x32x16_bf16 v[80:95], v[52:55], v[144:147], v[80:95]
    ds_read_b64_tr_b16 v[44:45], v12 offset:51200
    ds_read_b64_tr_b16 v[46:47], v12 offset:51456
    s_waitcnt lgkmcnt(12)
    v_mfma_f32_32x32x16_bf16 v[96:111], v[56:59], v[144:147], v[96:111]
    ds_read_b64_tr_b16 v[48:49], v12 offset:55296
    ds_read_b64_tr_b16 v[50:51], v12 offset:55552
    s_waitcnt lgkmcnt(11)
    v_mfma_f32_32x32x16_bf16 v[64:79], v[60:63], v[148:151], v[64:79]
    ds_read_b128 v[156:159], v11 offset:28672
    ds_read_b64_tr_b16 v[52:53], v12 offset:48128
    ds_read_b64_tr_b16 v[54:55], v12 offset:48384
    s_waitcnt lgkmcnt(12)
    v_mfma_f32_32x32x16_bf16 v[80:95], v[32:35], v[148:151], v[80:95]
    ds_read_b64_tr_b16 v[56:57], v12 offset:52224
    ds_read_b64_tr_b16 v[58:59], v12 offset:52480
    s_waitcnt lgkmcnt(12)
    v_mfma_f32_32x32x16_bf16 v[96:111], v[36:39], v[148:151], v[96:111]
    ds_read_b64_tr_b16 v[60:61], v12 offset:56320
    ds_read_b64_tr_b16 v[62:63], v12 offset:56576
    s_waitcnt lgkmcnt(11)
    v_mfma_f32_32x32x16_bf16 v[64:79], v[40:43], v[152:155], v[64:79]
    s_barrier
    ds_read_b128 v[160:163], v8 offset:57344
    ds_read_b64_tr_b16 v[32:33], v28 offset:8192
    ds_read_b64_tr_b16 v[34:35], v28 offset:8448
    s_waitcnt lgkmcnt(12)
    v_mfma_f32_32x32x16_bf16 v[80:95], v[44:47], v[152:155], v[80:95]
    ds_read_b64_tr_b16 v[36:37], v28 offset:12288
    ds_read_b64_tr_b16 v[38:39], v28 offset:12544
    s_waitcnt lgkmcnt(12)
    v_mfma_f32_32x32x16_bf16 v[96:111], v[48:51], v[152:155], v[96:111]
    ds_read_b64_tr_b16 v[40:41], v28 offset:16384
    ds_read_b64_tr_b16 v[42:43], v28 offset:16640
    s_waitcnt lgkmcnt(11)
    v_mfma_f32_32x32x16_bf16 v[64:79], v[52:55], v[156:159], v[64:79]
    ds_read_b128 v[164:167], v9 offset:57344
    ds_read_b64_tr_b16 v[44:45], v28 offset:9216
    ds_read_b64_tr_b16 v[46:47], v28 offset:9472
    s_waitcnt lgkmcnt(12)
    v_mfma_f32_32x32x16_bf16 v[80:95], v[56:59], v[156:159], v[80:95]
    ds_read_b64_tr_b16 v[48:49], v28 offset:13312
    ds_read_b64_tr_b16 v[50:51], v28 offset:13568
    s_waitcnt lgkmcnt(12)
    v_mfma_f32_32x32x16_bf16 v[96:111], v[60:63], v[156:159], v[96:111]
    ds_read_b64_tr_b16 v[52:53], v28 offset:17408
    ds_read_b64_tr_b16 v[54:55], v28 offset:17664
    s_waitcnt lgkmcnt(11)
    v_mfma_f32_32x32x16_bf16 v[64:79], v[32:35], v[160:163], v[64:79]
    ds_read_b128 v[168:171], v10 offset:57344
    ds_read_b64_tr_b16 v[56:57], v28 offset:10240
    ds_read_b64_tr_b16 v[58:59], v28 offset:10496
    s_waitcnt lgkmcnt(12)
    v_mfma_f32_32x32x16_bf16 v[80:95], v[36:39], v[160:163], v[80:95]
    ds_read_b64_tr_b16 v[60:61], v28 offset:14336
    ds_read_b64_tr_b16 v[62:63], v28 offset:14592
    s_waitcnt lgkmcnt(12)
    v_mfma_f32_32x32x16_bf16 v[96:111], v[40:43], v[160:163], v[96:111]
    ds_read_b64_tr_b16 v[32:33], v28 offset:18432
    ds_read_b64_tr_b16 v[34:35], v28 offset:18688
    s_waitcnt lgkmcnt(11)
    v_mfma_f32_32x32x16_bf16 v[64:79], v[44:47], v[164:167], v[64:79]
    ds_read_b128 v[172:175], v11 offset:57344
    ds_read_b64_tr_b16 v[36:37], v28 offset:11264
    ds_read_b64_tr_b16 v[38:39], v28 offset:11520
    s_waitcnt lgkmcnt(12)
    v_mfma_f32_32x32x16_bf16 v[80:95], v[48:51], v[164:167], v[80:95]
    ds_read_b64_tr_b16 v[40:41], v28 offset:15360
    ds_read_b64_tr_b16 v[42:43], v28 offset:15616
    s_waitcnt lgkmcnt(12)
    v_mfma_f32_32x32x16_bf16 v[96:111], v[52:55], v[164:167], v[96:111]
    ds_read_b64_tr_b16 v[44:45], v28 offset:19456
    ds_read_b64_tr_b16 v[46:47], v28 offset:19712
    s_waitcnt lgkmcnt(11)
    v_mfma_f32_32x32x16_bf16 v[64:79], v[56:59], v[168:171], v[64:79]
    s_barrier
    ds_read_b128 v[176:179], v24 offset:0
    ds_read_b64_tr_b16 v[48:49], v28 offset:36864
    ds_read_b64_tr_b16 v[50:51], v28 offset:37120
    s_waitcnt lgkmcnt(12)
    v_mfma_f32_32x32x16_bf16 v[80:95], v[60:63], v[168:171], v[80:95]
    ds_read_b64_tr_b16 v[52:53], v28 offset:40960
    ds_read_b64_tr_b16 v[54:55], v28 offset:41216
    s_waitcnt lgkmcnt(12)
    v_mfma_f32_32x32x16_bf16 v[96:111], v[32:35], v[168:171], v[96:111]
    ds_read_b64_tr_b16 v[56:57], v28 offset:45056
    ds_read_b64_tr_b16 v[58:59], v28 offset:45312
    s_waitcnt lgkmcnt(11)
    v_mfma_f32_32x32x16_bf16 v[64:79], v[36:39], v[172:175], v[64:79]
    ds_read_b128 v[180:183], v25 offset:0
    ds_read_b64_tr_b16 v[60:61], v28 offset:37888
    ds_read_b64_tr_b16 v[62:63], v28 offset:38144
    s_waitcnt lgkmcnt(12)
    v_mfma_f32_32x32x16_bf16 v[80:95], v[40:43], v[172:175], v[80:95]
    ds_read_b64_tr_b16 v[32:33], v28 offset:41984
    ds_read_b64_tr_b16 v[34:35], v28 offset:42240
    s_waitcnt lgkmcnt(12)
    v_mfma_f32_32x32x16_bf16 v[96:111], v[44:47], v[172:175], v[96:111]
    ds_read_b64_tr_b16 v[36:37], v28 offset:46080
    ds_read_b64_tr_b16 v[38:39], v28 offset:46336
    s_waitcnt lgkmcnt(11)
    v_mfma_f32_32x32x16_bf16 v[64:79], v[48:51], v[176:179], v[64:79]
    ds_read_b128 v[184:187], v26 offset:0
    ds_read_b64_tr_b16 v[40:41], v28 offset:38912
    ds_read_b64_tr_b16 v[42:43], v28 offset:39168
    s_waitcnt lgkmcnt(12)
    v_mfma_f32_32x32x16_bf16 v[80:95], v[52:55], v[176:179], v[80:95]
    ds_read_b64_tr_b16 v[44:45], v28 offset:43008
    ds_read_b64_tr_b16 v[46:47], v28 offset:43264
    s_waitcnt lgkmcnt(12)
    v_mfma_f32_32x32x16_bf16 v[96:111], v[56:59], v[176:179], v[96:111]
    ds_read_b64_tr_b16 v[48:49], v28 offset:47104
    ds_read_b64_tr_b16 v[50:51], v28 offset:47360
    s_waitcnt lgkmcnt(11)
    v_mfma_f32_32x32x16_bf16 v[64:79], v[60:63], v[180:183], v[64:79]
    ds_read_b128 v[188:191], v27 offset:0
    ds_read_b64_tr_b16 v[52:53], v28 offset:39936
    ds_read_b64_tr_b16 v[54:55], v28 offset:40192
    s_waitcnt lgkmcnt(12)
    v_mfma_f32_32x32x16_bf16 v[80:95], v[32:35], v[180:183], v[80:95]
    ds_read_b64_tr_b16 v[56:57], v28 offset:44032
    ds_read_b64_tr_b16 v[58:59], v28 offset:44288
    s_waitcnt lgkmcnt(12)
    v_mfma_f32_32x32x16_bf16 v[96:111], v[36:39], v[180:183], v[96:111]
    ds_read_b64_tr_b16 v[60:61], v28 offset:48128
    ds_read_b64_tr_b16 v[62:63], v28 offset:48384
    s_waitcnt lgkmcnt(11)
    v_mfma_f32_32x32x16_bf16 v[64:79], v[40:43], v[184:187], v[64:79]
    s_barrier
    ds_read_b128 v[192:195], v24 offset:28672
    ds_read_b64_tr_b16 v[32:33], v29 offset:0
    ds_read_b64_tr_b16 v[34:35], v29 offset:256
    s_waitcnt lgkmcnt(12)
    v_mfma_f32_32x32x16_bf16 v[80:95], v[44:47], v[184:187], v[80:95]
    ds_read_b64_tr_b16 v[36:37], v29 offset:4096
    ds_read_b64_tr_b16 v[38:39], v29 offset:4352
    s_waitcnt lgkmcnt(12)
    v_mfma_f32_32x32x16_bf16 v[96:111], v[48:51], v[184:187], v[96:111]
    ds_read_b64_tr_b16 v[40:41], v29 offset:8192
    ds_read_b64_tr_b16 v[42:43], v29 offset:8448
    s_waitcnt lgkmcnt(11)
    v_mfma_f32_32x32x16_bf16 v[64:79], v[52:55], v[188:191], v[64:79]
    ds_read_b128 v[196:199], v25 offset:28672
    ds_read_b64_tr_b16 v[44:45], v29 offset:1024
    ds_read_b64_tr_b16 v[46:47], v29 offset:1280
    s_waitcnt lgkmcnt(12)
    v_mfma_f32_32x32x16_bf16 v[80:95], v[56:59], v[188:191], v[80:95]
    ds_read_b64_tr_b16 v[48:49], v29 offset:5120
    ds_read_b64_tr_b16 v[50:51], v29 offset:5376
    s_waitcnt lgkmcnt(12)
    v_mfma_f32_32x32x16_bf16 v[96:111], v[60:63], v[188:191], v[96:111]
    ds_read_b64_tr_b16 v[52:53], v29 offset:9216
    ds_read_b64_tr_b16 v[54:55], v29 offset:9472
    s_waitcnt lgkmcnt(11)
    v_mfma_f32_32x32x16_bf16 v[64:79], v[32:35], v[192:195], v[64:79]
    ds_read_b128 v[200:203], v26 offset:28672
    ds_read_b64_tr_b16 v[56:57], v29 offset:2048
    ds_read_b64_tr_b16 v[58:59], v29 offset:2304
    s_waitcnt lgkmcnt(12)
    v_mfma_f32_32x32x16_bf16 v[80:95], v[36:39], v[192:195], v[80:95]
    ds_read_b64_tr_b16 v[60:61], v29 offset:6144
    ds_read_b64_tr_b16 v[62:63], v29 offset:6400
    s_waitcnt lgkmcnt(12)
    v_mfma_f32_32x32x16_bf16 v[96:111], v[40:43], v[192:195], v[96:111]
    ds_read_b64_tr_b16 v[32:33], v29 offset:10240
    ds_read_b64_tr_b16 v[34:35], v29 offset:10496
    s_waitcnt lgkmcnt(11)
    v_mfma_f32_32x32x16_bf16 v[64:79], v[44:47], v[196:199], v[64:79]
    ds_read_b128 v[204:207], v27 offset:28672
    ds_read_b64_tr_b16 v[36:37], v29 offset:3072
    ds_read_b64_tr_b16 v[38:39], v29 offset:3328
    s_waitcnt lgkmcnt(12)
    v_mfma_f32_32x32x16_bf16 v[80:95], v[48:51], v[196:199], v[80:95]
    ds_read_b64_tr_b16 v[40:41], v29 offset:7168
    ds_read_b64_tr_b16 v[42:43], v29 offset:7424
    s_waitcnt lgkmcnt(12)
    v_mfma_f32_32x32x16_bf16 v[96:111], v[52:55], v[196:199], v[96:111]
    ds_read_b64_tr_b16 v[44:45], v29 offset:11264
    ds_read_b64_tr_b16 v[46:47], v29 offset:11520
    s_waitcnt lgkmcnt(11)
    v_mfma_f32_32x32x16_bf16 v[64:79], v[56:59], v[200:203], v[64:79]
    s_barrier
    ds_read_b128 v[208:211], v8 offset:0
    ds_read_b64_tr_b16 v[48:49], v12 offset:16384
    ds_read_b64_tr_b16 v[50:51], v12 offset:16640
    s_waitcnt lgkmcnt(12)
    v_mfma_f32_32x32x16_bf16 v[80:95], v[60:63], v[200:203], v[80:95]
    ds_read_b64_tr_b16 v[52:53], v12 offset:20480
    ds_read_b64_tr_b16 v[54:55], v12 offset:20736
    s_waitcnt lgkmcnt(12)
    v_mfma_f32_32x32x16_bf16 v[96:111], v[32:35], v[200:203], v[96:111]
    ds_read_b64_tr_b16 v[56:57], v12 offset:24576
    ds_read_b64_tr_b16 v[58:59], v12 offset:24832
    s_waitcnt lgkmcnt(11)
    v_mfma_f32_32x32x16_bf16 v[64:79], v[36:39], v[204:207], v[64:79]
    ds_read_b128 v[212:215], v9 offset:0
    ds_read_b64_tr_b16 v[60:61], v12 offset:17408
    ds_read_b64_tr_b16 v[62:63], v12 offset:17664
    s_waitcnt lgkmcnt(12)
    v_mfma_f32_32x32x16_bf16 v[80:95], v[40:43], v[204:207], v[80:95]
    ds_read_b64_tr_b16 v[32:33], v12 offset:21504
    ds_read_b64_tr_b16 v[34:35], v12 offset:21760
    s_waitcnt lgkmcnt(12)
    v_mfma_f32_32x32x16_bf16 v[96:111], v[44:47], v[204:207], v[96:111]
    ds_read_b64_tr_b16 v[36:37], v12 offset:25600
    ds_read_b64_tr_b16 v[38:39], v12 offset:25856
    s_waitcnt lgkmcnt(11)
    v_mfma_f32_32x32x16_bf16 v[64:79], v[48:51], v[208:211], v[64:79]
    ds_read_b128 v[216:219], v10 offset:0
    ds_read_b64_tr_b16 v[40:41], v12 offset:18432
    ds_read_b64_tr_b16 v[42:43], v12 offset:18688
    s_waitcnt lgkmcnt(12)
    v_mfma_f32_32x32x16_bf16 v[80:95], v[52:55], v[208:211], v[80:95]
    ds_read_b64_tr_b16 v[44:45], v12 offset:22528
    ds_read_b64_tr_b16 v[46:47], v12 offset:22784
    s_waitcnt lgkmcnt(12)
    v_mfma_f32_32x32x16_bf16 v[96:111], v[56:59], v[208:211], v[96:111]
    ds_read_b64_tr_b16 v[48:49], v12 offset:26624
    ds_read_b64_tr_b16 v[50:51], v12 offset:26880
    s_waitcnt lgkmcnt(11)
    v_mfma_f32_32x32x16_bf16 v[64:79], v[60:63], v[212:215], v[64:79]
    ds_read_b128 v[220:223], v11 offset:0
    ds_read_b64_tr_b16 v[52:53], v12 offset:19456
    ds_read_b64_tr_b16 v[54:55], v12 offset:19712
    s_waitcnt lgkmcnt(12)
    v_mfma_f32_32x32x16_bf16 v[80:95], v[32:35], v[212:215], v[80:95]
    ds_read_b64_tr_b16 v[56:57], v12 offset:23552
    ds_read_b64_tr_b16 v[58:59], v12 offset:23808
    s_waitcnt lgkmcnt(12)
    v_mfma_f32_32x32x16_bf16 v[96:111], v[36:39], v[212:215], v[96:111]
    ds_read_b64_tr_b16 v[60:61], v12 offset:27648
    ds_read_b64_tr_b16 v[62:63], v12 offset:27904
    s_waitcnt lgkmcnt(11)
    v_mfma_f32_32x32x16_bf16 v[64:79], v[40:43], v[216:219], v[64:79]
    s_barrier
    ds_read_b128 v[224:227], v8 offset:28672
    ds_read_b64_tr_b16 v[32:33], v12 offset:45056
    ds_read_b64_tr_b16 v[34:35], v12 offset:45312
    s_waitcnt lgkmcnt(12)
    v_mfma_f32_32x32x16_bf16 v[80:95], v[44:47], v[216:219], v[80:95]
    ds_read_b64_tr_b16 v[36:37], v12 offset:49152
    ds_read_b64_tr_b16 v[38:39], v12 offset:49408
    s_waitcnt lgkmcnt(12)
    v_mfma_f32_32x32x16_bf16 v[96:111], v[48:51], v[216:219], v[96:111]
    ds_read_b64_tr_b16 v[40:41], v12 offset:53248
    ds_read_b64_tr_b16 v[42:43], v12 offset:53504
    s_waitcnt lgkmcnt(11)
    v_mfma_f32_32x32x16_bf16 v[64:79], v[52:55], v[220:223], v[64:79]
    ds_read_b128 v[228:231], v9 offset:28672
    ds_read_b64_tr_b16 v[44:45], v12 offset:46080
    ds_read_b64_tr_b16 v[46:47], v12 offset:46336
    s_waitcnt lgkmcnt(12)
    v_mfma_f32_32x32x16_bf16 v[80:95], v[56:59], v[220:223], v[80:95]
    ds_read_b64_tr_b16 v[48:49], v12 offset:50176
    ds_read_b64_tr_b16 v[50:51], v12 offset:50432
    s_waitcnt lgkmcnt(12)
    v_mfma_f32_32x32x16_bf16 v[96:111], v[60:63], v[220:223], v[96:111]
    ds_read_b64_tr_b16 v[52:53], v12 offset:54272
    ds_read_b64_tr_b16 v[54:55], v12 offset:54528
    s_waitcnt lgkmcnt(11)
    v_mfma_f32_32x32x16_bf16 v[64:79], v[32:35], v[224:227], v[64:79]
    ds_read_b128 v[232:235], v10 offset:28672
    ds_read_b64_tr_b16 v[56:57], v12 offset:47104
    ds_read_b64_tr_b16 v[58:59], v12 offset:47360
    s_waitcnt lgkmcnt(12)
    v_mfma_f32_32x32x16_bf16 v[80:95], v[36:39], v[224:227], v[80:95]
    ds_read_b64_tr_b16 v[60:61], v12 offset:51200
    ds_read_b64_tr_b16 v[62:63], v12 offset:51456
    s_waitcnt lgkmcnt(12)
    v_mfma_f32_32x32x16_bf16 v[96:111], v[40:43], v[224:227], v[96:111]
    ds_read_b64_tr_b16 v[32:33], v12 offset:55296
    ds_read_b64_tr_b16 v[34:35], v12 offset:55552
    s_waitcnt lgkmcnt(11)
    v_mfma_f32_32x32x16_bf16 v[64:79], v[44:47], v[228:231], v[64:79]
    ds_read_b128 v[236:239], v11 offset:28672
    ds_read_b64_tr_b16 v[36:37], v12 offset:48128
    ds_read_b64_tr_b16 v[38:39], v12 offset:48384
    s_waitcnt lgkmcnt(12)
    v_mfma_f32_32x32x16_bf16 v[80:95], v[48:51], v[228:231], v[80:95]
    ds_read_b64_tr_b16 v[40:41], v12 offset:52224
    ds_read_b64_tr_b16 v[42:43], v12 offset:52480
    s_waitcnt lgkmcnt(12)
    v_mfma_f32_32x32x16_bf16 v[96:111], v[52:55], v[228:231], v[96:111]
    ds_read_b64_tr_b16 v[44:45], v12 offset:56320
    ds_read_b64_tr_b16 v[46:47], v12 offset:56576
    s_waitcnt lgkmcnt(11)
    v_mfma_f32_32x32x16_bf16 v[64:79], v[56:59], v[232:235], v[64:79]
    s_barrier
    ds_read_b128 v[240:243], v8 offset:57344
    ds_read_b64_tr_b16 v[48:49], v28 offset:8192
    ds_read_b64_tr_b16 v[50:51], v28 offset:8448
    s_waitcnt lgkmcnt(12)
    v_mfma_f32_32x32x16_bf16 v[80:95], v[60:63], v[232:235], v[80:95]
    ds_read_b64_tr_b16 v[52:53], v28 offset:12288
    ds_read_b64_tr_b16 v[54:55], v28 offset:12544
    s_waitcnt lgkmcnt(12)
    v_mfma_f32_32x32x16_bf16 v[96:111], v[32:35], v[232:235], v[96:111]
    ds_read_b128 v[244:247], v9 offset:57344
    ds_read_b64_tr_b16 v[56:57], v28 offset:9216
    ds_read_b64_tr_b16 v[58:59], v28 offset:9472
    s_waitcnt lgkmcnt(12)
    v_mfma_f32_32x32x16_bf16 v[64:79], v[36:39], v[236:239], v[64:79]
    ds_read_b64_tr_b16 v[60:61], v28 offset:13312
    ds_read_b64_tr_b16 v[62:63], v28 offset:13568
    s_waitcnt lgkmcnt(12)
    v_mfma_f32_32x32x16_bf16 v[80:95], v[40:43], v[236:239], v[80:95]
    ds_read_b128 v[248:251], v10 offset:57344
    ds_read_b64_tr_b16 v[32:33], v28 offset:10240
    ds_read_b64_tr_b16 v[34:35], v28 offset:10496
    s_waitcnt lgkmcnt(13)
    v_mfma_f32_32x32x16_bf16 v[96:111], v[44:47], v[236:239], v[96:111]
    ds_read_b64_tr_b16 v[36:37], v28 offset:14336
    ds_read_b64_tr_b16 v[38:39], v28 offset:14592
    s_waitcnt lgkmcnt(12)
    v_mfma_f32_32x32x16_bf16 v[64:79], v[48:51], v[240:243], v[64:79]
    ds_read_b128 v[252:255], v11 offset:57344
    ds_read_b64_tr_b16 v[40:41], v28 offset:11264
    ds_read_b64_tr_b16 v[42:43], v28 offset:11520
    s_waitcnt lgkmcnt(13)
    v_mfma_f32_32x32x16_bf16 v[80:95], v[52:55], v[240:243], v[80:95]
    ds_read_b64_tr_b16 v[44:45], v28 offset:15360
    ds_read_b64_tr_b16 v[46:47], v28 offset:15616
    s_waitcnt lgkmcnt(12)
    v_mfma_f32_32x32x16_bf16 v[64:79], v[56:59], v[244:247], v[64:79]
    ds_read_b64_tr_b16 v[48:49], v28 offset:16384
    ds_read_b64_tr_b16 v[50:51], v28 offset:16640
    s_waitcnt lgkmcnt(12)
    v_mfma_f32_32x32x16_bf16 v[80:95], v[60:63], v[244:247], v[80:95]
    ds_read_b64_tr_b16 v[52:53], v28 offset:17408
    ds_read_b64_tr_b16 v[54:55], v28 offset:17664
    s_waitcnt lgkmcnt(11)
    v_mfma_f32_32x32x16_bf16 v[64:79], v[32:35], v[248:251], v[64:79]
    ds_read_b64_tr_b16 v[56:57], v28 offset:18432
    ds_read_b64_tr_b16 v[58:59], v28 offset:18688
    s_waitcnt lgkmcnt(11)
    v_mfma_f32_32x32x16_bf16 v[80:95], v[36:39], v[248:251], v[80:95]
    ds_read_b64_tr_b16 v[60:61], v28 offset:19456
    ds_read_b64_tr_b16 v[62:63], v28 offset:19712
    s_waitcnt lgkmcnt(10)
    v_mfma_f32_32x32x16_bf16 v[64:79], v[40:43], v[252:255], v[64:79]
    s_waitcnt lgkmcnt(8)
    v_mfma_f32_32x32x16_bf16 v[80:95], v[44:47], v[252:255], v[80:95]
    s_waitcnt lgkmcnt(6)
    v_mfma_f32_32x32x16_bf16 v[96:111], v[48:51], v[240:243], v[96:111]
    s_waitcnt lgkmcnt(4)
    v_mfma_f32_32x32x16_bf16 v[96:111], v[52:55], v[244:247], v[96:111]
    s_waitcnt lgkmcnt(2)
    v_mfma_f32_32x32x16_bf16 v[96:111], v[56:59], v[248:251], v[96:111]
    s_waitcnt lgkmcnt(0)
    v_mfma_f32_32x32x16_bf16 v[96:111], v[60:63], v[252:255], v[96:111]
    v_cvt_pk_bf16_f32 v64, v64, v65
    v_cvt_pk_bf16_f32 v65, v66, v67
    v_cvt_pk_bf16_f32 v66, v68, v69
    v_cvt_pk_bf16_f32 v67, v70, v71
    v_cvt_pk_bf16_f32 v68, v72, v73
    v_cvt_pk_bf16_f32 v69, v74, v75
    v_cvt_pk_bf16_f32 v70, v76, v77
    v_cvt_pk_bf16_f32 v71, v78, v79
    s_add_u32 s20, s38, 0
    buffer_store_dwordx4 v[64:67], v3, s[12:15], s20 offen sc1
    s_add_u32 s20, s38, 131072
    buffer_store_dwordx4 v[68:71], v3, s[12:15], s20 offen sc1
    v_cvt_pk_bf16_f32 v80, v80, v81
    v_cvt_pk_bf16_f32 v81, v82, v83
    v_cvt_pk_bf16_f32 v82, v84, v85
    v_cvt_pk_bf16_f32 v83, v86, v87
    v_cvt_pk_bf16_f32 v84, v88, v89
    v_cvt_pk_bf16_f32 v85, v90, v91
    v_cvt_pk_bf16_f32 v86, v92, v93
    v_cvt_pk_bf16_f32 v87, v94, v95
    s_add_u32 s20, s38, 262144
    buffer_store_dwordx4 v[80:83], v3, s[12:15], s20 offen sc1
    s_add_u32 s20, s38, 393216
    buffer_store_dwordx4 v[84:87], v3, s[12:15], s20 offen sc1
    s_branch g_qpath
g_vpath:
    s_barrier
    ds_read_b128 v[128:131], v8 offset:0
    ds_read_b64_tr_b16 v[32:33], v12 offset:16384
    ds_read_b64_tr_b16 v[34:35], v12 offset:16640
    ds_read_b64_tr_b16 v[36:37], v12 offset:20480
    ds_read_b64_tr_b16 v[38:39], v12 offset:20736
    ds_read_b64_tr_b16 v[40:41], v12 offset:24576
    ds_read_b64_tr_b16 v[42:43], v12 offset:24832
    ds_read_b128 v[132:135], v9 offset:0
    ds_read_b64_tr_b16 v[44:45], v12 offset:17408
    ds_read_b64_tr_b16 v[46:47], v12 offset:17664
    ds_read_b64_tr_b16 v[48:49], v12 offset:21504
    ds_read_b64_tr_b16 v[50:51], v12 offset:21760
    ds_read_b64_tr_b16 v[52:53], v12 offset:25600
    ds_read_b64_tr_b16 v[54:55], v12 offset:25856
    s_waitcnt lgkmcnt(11)
    v_mfma_f32_32x32x16_bf16 v[64:79], v[128:131], v[32:35], v[64:79]
    ds_read_b128 v[136:139], v10 offset:0
    ds_read_b64_tr_b16 v[56:57], v12 offset:18432
    ds_read_b64_tr_b16 v[58:59], v12 offset:18688
    s_waitcnt lgkmcnt(12)
    v_mfma_f32_32x32x16_bf16 v[80:95], v[128:131], v[36:39], v[80:95]
    ds_read_b64_tr_b16 v[60:61], v12 offset:22528
    ds_read_b64_tr_b16 v[62:63], v12 offset:22784
    s_waitcnt lgkmcnt(12)
    v_mfma_f32_32x32x16_bf16 v[96:111], v[40:43], v[128:131], v[96:111]
    ds_read_b64_tr_b16 v[32:33], v12 offset:26624
    ds_read_b64_tr_b16 v[34:35], v12 offset:26880
    s_waitcnt lgkmcnt(11)
    v_mfma_f32_32x32x16_bf16 v[64:79], v[132:135], v[44:47], v[64:79]
    ds_read_b128 v[140:143], v11 offset:0
    ds_read_b64_tr_b16 v[36:37], v12 offset:19456
    ds_read_b64_tr_b16 v[38:39], v12 offset:19712
    s_cmp_ge_u32 s2, 8
    s_cbranch_scc1 g_nocntv
    s_waitcnt vmcnt(0)
    s_mov_b64 exec, 1
    buffer_atomic_add v22, v16, s[24:27], 0 offen sc1
    s_mov_b64 exec, -1
g_nocntv:
    s_waitcnt lgkmcnt(12)
    v_mfma_f32_32x32x16_bf16 v[80:95], v[132:135], v[48:51], v[80:95]
    ds_read_b64_tr_b16 v[40:41], v12 offset:23552
    ds_read_b64_tr_b16 v[42:43], v12 offset:23808
    s_waitcnt lgkmcnt(12)
    v_mfma_f32_32x32x16_bf16 v[96:111], v[52:55], v[132:135], v[96:111]
    ds_read_b64_tr_b16 v[44:45], v12 offset:27648
    ds_read_b64_tr_b16 v[46:47], v12 offset:27904
    s_waitcnt lgkmcnt(11)
    v_mfma_f32_32x32x16_bf16 v[64:79], v[136:139], v[56:59], v[64:79]
    s_barrier
    ds_read_b128 v[144:147], v8 offset:28672
    ds_read_b64_tr_b16 v[48:49], v12 offset:45056
    ds_read_b64_tr_b16 v[50:51], v12 offset:45312
    s_waitcnt lgkmcnt(12)
    v_mfma_f32_32x32x16_bf16 v[80:95], v[136:139], v[60:63], v[80:95]
    ds_read_b64_tr_b16 v[52:53], v12 offset:49152
    ds_read_b64_tr_b16 v[54:55], v12 offset:49408
    s_waitcnt lgkmcnt(12)
    v_mfma_f32_32x32x16_bf16 v[96:111], v[32:35], v[136:139], v[96:111]
    ds_read_b64_tr_b16 v[56:57], v12 offset:53248
    ds_read_b64_tr_b16 v[58:59], v12 offset:53504
    s_waitcnt lgkmcnt(11)
    v_mfma_f32_32x32x16_bf16 v[64:79], v[140:143], v[36:39], v[64:79]
    ds_read_b128 v[148:151], v9 offset:28672
    ds_read_b64_tr_b16 v[60:61], v12 offset:46080
    ds_read_b64_tr_b16 v[62:63], v12 offset:46336
    s_waitcnt lgkmcnt(12)
    v_mfma_f32_32x32x16_bf16 v[80:95], v[140:143], v[40:43], v[80:95]
    ds_read_b64_tr_b16 v[32:33], v12 offset:50176
    ds_read_b64_tr_b16 v[34:35], v12 offset:50432
    s_waitcnt lgkmcnt(12)
    v_mfma_f32_32x32x16_bf16 v[96:111], v[44:47], v[140:143], v[96:111]
    ds_read_b64_tr_b16 v[36:37], v12 offset:54272
    ds_read_b64_tr_b16 v[38:39], v12 offset:54528
    s_waitcnt lgkmcnt(11)
    v_mfma_f32_32x32x16_bf16 v[64:79], v[144:147], v[48:51], v[64:79]
    ds_read_b128 v[152:155], v10 offset:28672
    ds_read_b64_tr_b16 v[40:41], v12 offset:47104
    ds_read_b64_tr_b16 v[42:43], v12 offset:47360
    s_waitcnt lgkmcnt(12)
    v_mfma_f32_32x32x16_bf16 v[80:95], v[144:147], v[52:55], v[80:95]
    ds_read_b64_tr_b16 v[44:45], v12 offset:51200
    ds_read_b64_tr_b16 v[46:47], v12 offset:51456
    s_waitcnt lgkmcnt(12)
    v_mfma_f32_32x32x16_bf16 v[96:111], v[56:59], v[144:147], v[96:111]
    ds_read_b64_tr_b16 v[48:49], v12 offset:55296
    ds_read_b64_tr_b16 v[50:51], v12 offset:55552
    s_waitcnt lgkmcnt(11)
    v_mfma_f32_32x32x16_bf16 v[64:79], v[148:151], v[60:63], v[64:79]
    ds_read_b128 v[156:159], v11 offset:28672
    ds_read_b64_tr_b16 v[52:53], v12 offset:48128
    ds_read_b64_tr_b16 v[54:55], v12 offset:48384
    s_waitcnt lgkmcnt(12)
    v_mfma_f32_32x32x16_bf16 v[80:95], v[148:151], v[32:35], v[80:95]
    ds_read_b64_tr_b16 v[56:57], v12 offset:52224
    ds_read_b64_tr_b16 v[58:59], v12 offset:52480
    s_waitcnt lgkmcnt(12)
    v_mfma_f32_32x32x16_bf16 v[96:111], v[36:39], v[148:151], v[96:111]
    ds_read_b64_tr_b16 v[60:61], v12 offset:56320
    ds_read_b64_tr_b16 v[62:63], v12 offset:56576
    s_waitcnt lgkmcnt(11)
    v_mfma_f32_32x32x16_bf16 v[64:79], v[152:155], v[40:43], v[64:79]
    s_barrier
    ds_read_b128 v[160:163], v8 offset:57344
    ds_read_b64_tr_b16 v[32:33], v28 offset:8192
    ds_read_b64_tr_b16 v[34:35], v28 offset:8448
    s_waitcnt lgkmcnt(12)
    v_mfma_f32_32x32x16_bf16 v[80:95], v[152:155], v[44:47], v[80:95]
    ds_read_b64_tr_b16 v[36:37], v28 offset:12288
    ds_read_b64_tr_b16 v[38:39], v28 offset:12544
    s_waitcnt lgkmcnt(12)
    v_mfma_f32_32x32x16_bf16 v[96:111], v[48:51], v[152:155], v[96:111]
    ds_read_b64_tr_b16 v[40:41], v28 offset:16384
    ds_read_b64_tr_b16 v[42:43], v28 offset:16640
    s_waitcnt lgkmcnt(11)
    v_mfma_f32_32x32x16_bf16 v[64:79], v[156:159], v[52:55], v[64:79]
    ds_read_b128 v[164:167], v9 offset:57344
    ds_read_b64_tr_b16 v[44:45], v28 offset:9216
    ds_read_b64_tr_b16 v[46:47], v28 offset:9472
    s_waitcnt lgkmcnt(12)
    v_mfma_f32_32x32x16_bf16 v[80:95], v[156:159], v[56:59], v[80:95]
    ds_read_b64_tr_b16 v[48:49], v28 offset:13312
    ds_read_b64_tr_b16 v[50:51], v28 offset:13568
    s_waitcnt lgkmcnt(12)
    v_mfma_f32_32x32x16_bf16 v[96:111], v[60:63], v[156:159], v[96:111]
    ds_read_b64_tr_b16 v[52:53], v28 offset:17408
    ds_read_b64_tr_b16 v[54:55], v28 offset:17664
    s_waitcnt lgkmcnt(11)
    v_mfma_f32_32x32x16_bf16 v[64:79], v[160:163], v[32:35], v[64:79]
    ds_read_b128 v[168:171], v10 offset:57344
    ds_read_b64_tr_b16 v[56:57], v28 offset:10240
    ds_read_b64_tr_b16 v[58:59], v28 offset:10496
    s_waitcnt lgkmcnt(12)
    v_mfma_f32_32x32x16_bf16 v[80:95], v[160:163], v[36:39], v[80:95]
    ds_read_b64_tr_b16 v[60:61], v28 offset:14336
    ds_read_b64_tr_b16 v[62:63], v28 offset:14592
    s_waitcnt lgkmcnt(12)
    v_mfma_f32_32x32x16_bf16 v[96:111], v[40:43], v[160:163], v[96:111]
    ds_read_b64_tr_b16 v[32:33], v28 offset:18432
    ds_read_b64_tr_b16 v[34:35], v28 offset:18688
    s_waitcnt lgkmcnt(11)
    v_mfma_f32_32x32x16_bf16 v[64:79], v[164:167], v[44:47], v[64:79]
    ds_read_b128 v[172:175], v11 offset:57344
    ds_read_b64_tr_b16 v[36:37], v28 offset:11264
    ds_read_b64_tr_b16 v[38:39], v28 offset:11520
    s_waitcnt lgkmcnt(12)
    v_mfma_f32_32x32x16_bf16 v[80:95], v[164:167], v[48:51], v[80:95]
    ds_read_b64_tr_b16 v[40:41], v28 offset:15360
    ds_read_b64_tr_b16 v[42:43], v28 offset:15616
    s_waitcnt lgkmcnt(12)
    v_mfma_f32_32x32x16_bf16 v[96:111], v[52:55], v[164:167], v[96:111]
    ds_read_b64_tr_b16 v[44:45], v28 offset:19456
    ds_read_b64_tr_b16 v[46:47], v28 offset:19712
    s_waitcnt lgkmcnt(11)
    v_mfma_f32_32x32x16_bf16 v[64:79], v[168:171], v[56:59], v[64:79]
    s_barrier
    ds_read_b128 v[176:179], v24 offset:0
    ds_read_b64_tr_b16 v[48:49], v28 offset:36864
    ds_read_b64_tr_b16 v[50:51], v28 offset:37120
    s_waitcnt lgkmcnt(12)
    v_mfma_f32_32x32x16_bf16 v[80:95], v[168:171], v[60:63], v[80:95]
    ds_read_b64_tr_b16 v[52:53], v28 offset:40960
    ds_read_b64_tr_b16 v[54:55], v28 offset:41216
    s_waitcnt lgkmcnt(12)
    v_mfma_f32_32x32x16_bf16 v[96:111], v[32:35], v[168:171], v[96:111]
    ds_read_b64_tr_b16 v[56:57], v28 offset:45056
    ds_read_b64_tr_b16 v[58:59], v28 offset:45312
    s_waitcnt lgkmcnt(11)
    v_mfma_f32_32x32x16_bf16 v[64:79], v[172:175], v[36:39], v[64:79]
    ds_read_b128 v[180:183], v25 offset:0
    ds_read_b64_tr_b16 v[60:61], v28 offset:37888
    ds_read_b64_tr_b16 v[62:63], v28 offset:38144
    s_waitcnt lgkmcnt(12)
    v_mfma_f32_32x32x16_bf16 v[80:95], v[172:175], v[40:43], v[80:95]
    ds_read_b64_tr_b16 v[32:33], v28 offset:41984
    ds_read_b64_tr_b16 v[34:35], v28 offset:42240
    s_waitcnt lgkmcnt(12)
    v_mfma_f32_32x32x16_bf16 v[96:111], v[44:47], v[172:175], v[96:111]
    ds_read_b64_tr_b16 v[36:37], v28 offset:46080
    ds_read_b64_tr_b16 v[38:39], v28 offset:46336
    s_waitcnt lgkmcnt(11)
    v_mfma_f32_32x32x16_bf16 v[64:79], v[176:179], v[48:51], v[64:79]
    ds_read_b128 v[184:187], v26 offset:0
    ds_read_b64_tr_b16 v[40:41], v28 offset:38912
    ds_read_b64_tr_b16 v[42:43], v28 offset:39168
    s_waitcnt lgkmcnt(12)
    v_mfma_f32_32x32x16_bf16 v[80:95], v[176:179], v[52:55], v[80:95]
    ds_read_b64_tr_b16 v[44:45], v28 offset:43008
    ds_read_b64_tr_b16 v[46:47], v28 offset:43264
    s_waitcnt lgkmcnt(12)
    v_mfma_f32_32x32x16_bf16 v[96:111], v[56:59], v[176:179], v[96:111]
    ds_read_b64_tr_b16 v[48:49], v28 offset:47104
    ds_read_b64_tr_b16 v[50:51], v28 offset:47360
    s_waitcnt lgkmcnt(11)
    v_mfma_f32_32x32x16_bf16 v[64:79], v[180:183], v[60:63], v[64:79]
    ds_read_b128 v[188:191], v27 offset:0
    ds_read_b64_tr_b16 v[52:53], v28 offset:39936
    ds_read_b64_tr_b16 v[54:55], v28 offset:40192
    s_waitcnt lgkmcnt(12)
    v_mfma_f32_32x32x16_bf16 v[80:95], v[180:183], v[32:35], v[80:95]
    ds_read_b64_tr_b16 v[56:57], v28 offset:44032
    ds_read_b64_tr_b16 v[58:59], v28 offset:44288
    s_waitcnt lgkmcnt(12)
    v_mfma_f32_32x32x16_bf16 v[96:111], v[36:39], v[180:183], v[96:111]
    ds_read_b64_tr_b16 v[60:61], v28 offset:48128
    ds_read_b64_tr_b16 v[62:63], v28 offset:48384
    s_waitcnt lgkmcnt(11)
    v_mfma_f32_32x32x16_bf16 v[64:79], v[184:187], v[40:43], v[64:79]
    s_barrier
    ds_read_b128 v[192:195], v24 offset:28672
    ds_read_b64_tr_b16 v[32:33], v29 offset:0
    ds_read_b64_tr_b16 v[34:35], v29 offset:256
    s_waitcnt lgkmcnt(12)
    v_mfma_f32_32x32x16_bf16 v[80:95], v[184:187], v[44:47], v[80:95]
    ds_read_b64_tr_b16 v[36:37], v29 offset:4096
    ds_read_b64_tr_b16 v[38:39], v29 offset:4352
    s_waitcnt lgkmcnt(12)
    v_mfma_f32_32x32x16_bf16 v[96:111], v[48:51], v[184:187], v[96:111]
    ds_read_b64_tr_b16 v[40:41], v29 offset:8192
    ds_read_b64_tr_b16 v[42:43], v29 offset:8448
    s_waitcnt lgkmcnt(11)
    v_mfma_f32_32x32x16_bf16 v[64:79], v[188:191], v[52:55], v[64:79]
    ds_read_b128 v[196:199], v25 offset:28672
    ds_read_b64_tr_b16 v[44:45], v29 offset:1024
    ds_read_b64_tr_b16 v[46:47], v29 offset:1280
    s_waitcnt lgkmcnt(12)
    v_mfma_f32_32x32x16_bf16 v[80:95], v[188:191], v[56:59], v[80:95]
    ds_read_b64_tr_b16 v[48:49], v29 offset:5120
    ds_read_b64_tr_b16 v[50:51], v29 offset:5376
    s_waitcnt lgkmcnt(12)
    v_mfma_f32_32x32x16_bf16 v[96:111], v[60:63], v[188:191], v[96:111]
    ds_read_b64_tr_b16 v[52:53], v29 offset:9216
    ds_read_b64_tr_b16 v[54:55], v29 offset:9472
    s_waitcnt lgkmcnt(11)
    v_mfma_f32_32x32x16_bf16 v[64:79], v[192:195], v[32:35], v[64:79]
    ds_read_b128 v[200:203], v26 offset:28672
    ds_read_b64_tr_b16 v[56:57], v29 offset:2048
    ds_read_b64_tr_b16 v[58:59], v29 offset:2304
    s_waitcnt lgkmcnt(12)
    v_mfma_f32_32x32x16_bf16 v[80:95], v[192:195], v[36:39], v[80:95]
    ds_read_b64_tr_b16 v[60:61], v29 offset:6144
    ds_read_b64_tr_b16 v[62:63], v29 offset:6400
    s_waitcnt lgkmcnt(12)
    v_mfma_f32_32x32x16_bf16 v[96:111], v[40:43], v[192:195], v[96:111]
    ds_read_b64_tr_b16 v[32:33], v29 offset:10240
    ds_read_b64_tr_b16 v[34:35], v29 offset:10496
    s_waitcnt lgkmcnt(11)
    v_mfma_f32_32x32x16_bf16 v[64:79], v[196:199], v[44:47], v[64:79]
    ds_read_b128 v[204:207], v27 offset:28672
    ds_read_b64_tr_b16 v[36:37], v29 offset:3072
    ds_read_b64_tr_b16 v[38:39], v29 offset:3328
    s_waitcnt lgkmcnt(12)
    v_mfma_f32_32x32x16_bf16 v[80:95], v[196:199], v[48:51], v[80:95]
    ds_read_b64_tr_b16 v[40:41], v29 offset:7168
    ds_read_b64_tr_b16 v[42:43], v29 offset:7424
    s_waitcnt lgkmcnt(12)
    v_mfma_f32_32x32x16_bf16 v[96:111], v[52:55], v[196:199], v[96:111]
    ds_read_b64_tr_b16 v[44:45], v29 offset:11264
    ds_read_b64_tr_b16 v[46:47], v29 offset:11520
    s_waitcnt lgkmcnt(11)
    v_mfma_f32_32x32x16_bf16 v[64:79], v[200:203], v[56:59], v[64:79]
    s_barrier
    ds_read_b128 v[208:211], v8 offset:0
    ds_read_b64_tr_b16 v[48:49], v12 offset:16384
    ds_read_b64_tr_b16 v[50:51], v12 offset:16640
    s_waitcnt lgkmcnt(12)
    v_mfma_f32_32x32x16_bf16 v[80:95], v[200:203], v[60:63], v[80:95]
    ds_read_b64_tr_b16 v[52:53], v12 offset:20480
    ds_read_b64_tr_b16 v[54:55], v12 offset:20736
    s_waitcnt lgkmcnt(12)
    v_mfma_f32_32x32x16_bf16 v[96:111], v[32:35], v[200:203], v[96:111]
    ds_read_b64_tr_b16 v[56:57], v12 offset:24576
    ds_read_b64_tr_b16 v[58:59], v12 offset:24832
    s_waitcnt lgkmcnt(11)
    v_mfma_f32_32x32x16_bf16 v[64:79], v[204:207], v[36:39], v[64:79]
    ds_read_b128 v[212:215], v9 offset:0
    ds_read_b64_tr_b16 v[60:61], v12 offset:17408
    ds_read_b64_tr_b16 v[62:63], v12 offset:17664
    s_waitcnt lgkmcnt(12)
    v_mfma_f32_32x32x16_bf16 v[80:95], v[204:207], v[40:43], v[80:95]
    ds_read_b64_tr_b16 v[32:33], v12 offset:21504
    ds_read_b64_tr_b16 v[34:35], v12 offset:21760
    s_waitcnt lgkmcnt(12)
    v_mfma_f32_32x32x16_bf16 v[96:111], v[44:47], v[204:207], v[96:111]
    ds_read_b64_tr_b16 v[36:37], v12 offset:25600
    ds_read_b64_tr_b16 v[38:39], v12 offset:25856
    s_waitcnt lgkmcnt(11)
    v_mfma_f32_32x32x16_bf16 v[64:79], v[208:211], v[48:51], v[64:79]
    ds_read_b128 v[216:219], v10 offset:0
    ds_read_b64_tr_b16 v[40:41], v12 offset:18432
    ds_read_b64_tr_b16 v[42:43], v12 offset:18688
    s_waitcnt lgkmcnt(12)
    v_mfma_f32_32x32x16_bf16 v[80:95], v[208:211], v[52:55], v[80:95]
    ds_read_b64_tr_b16 v[44:45], v12 offset:22528
    ds_read_b64_tr_b16 v[46:47], v12 offset:22784
    s_waitcnt lgkmcnt(12)
    v_mfma_f32_32x32x16_bf16 v[96:111], v[56:59], v[208:211], v[96:111]
    ds_read_b64_tr_b16 v[48:49], v12 offset:26624
    ds_read_b64_tr_b16 v[50:51], v12 offset:26880
    s_waitcnt lgkmcnt(11)
    v_mfma_f32_32x32x16_bf16 v[64:79], v[212:215], v[60:63], v[64:79]
    ds_read_b128 v[220:223], v11 offset:0
    ds_read_b64_tr_b16 v[52:53], v12 offset:19456
    ds_read_b64_tr_b16 v[54:55], v12 offset:19712
    s_waitcnt lgkmcnt(12)
    v_mfma_f32_32x32x16_bf16 v[80:95], v[212:215], v[32:35], v[80:95]
    ds_read_b64_tr_b16 v[56:57], v12 offset:23552
    ds_read_b64_tr_b16 v[58:59], v12 offset:23808
    s_waitcnt lgkmcnt(12)
    v_mfma_f32_32x32x16_bf16 v[96:111], v[36:39], v[212:215], v[96:111]
    ds_read_b64_tr_b16 v[60:61], v12 offset:27648
    ds_read_b64_tr_b16 v[62:63], v12 offset:27904
    s_waitcnt lgkmcnt(11)
    v_mfma_f32_32x32x16_bf16 v[64:79], v[216:219], v[40:43], v[64:79]
    s_barrier
    ds_read_b128 v[224:227], v8 offset:28672
    ds_read_b64_tr_b16 v[32:33], v12 offset:45056
    ds_read_b64_tr_b16 v[34:35], v12 offset:45312
    s_waitcnt lgkmcnt(12)
    v_mfma_f32_32x32x16_bf16 v[80:95], v[216:219], v[44:47], v[80:95]
    ds_read_b64_tr_b16 v[36:37], v12 offset:49152
    ds_read_b64_tr_b16 v[38:39], v12 offset:49408
    s_waitcnt lgkmcnt(12)
    v_mfma_f32_32x32x16_bf16 v[96:111], v[48:51], v[216:219], v[96:111]
    ds_read_b64_tr_b16 v[40:41], v12 offset:53248
    ds_read_b64_tr_b16 v[42:43], v12 offset:53504
    s_waitcnt lgkmcnt(11)
    v_mfma_f32_32x32x16_bf16 v[64:79], v[220:223], v[52:55], v[64:79]
    ds_read_b128 v[228:231], v9 offset:28672
    ds_read_b64_tr_b16 v[44:45], v12 offset:46080
    ds_read_b64_tr_b16 v[46:47], v12 offset:46336
    s_waitcnt lgkmcnt(12)
    v_mfma_f32_32x32x16_bf16 v[80:95], v[220:223], v[56:59], v[80:95]
    ds_read_b64_tr_b16 v[48:49], v12 offset:50176
    ds_read_b64_tr_b16 v[50:51], v12 offset:50432
    s_waitcnt lgkmcnt(12)
    v_mfma_f32_32x32x16_bf16 v[96:111], v[60:63], v[220:223], v[96:111]
    ds_read_b64_tr_b16 v[52:53], v12 offset:54272
    ds_read_b64_tr_b16 v[54:55], v12 offset:54528
    s_waitcnt lgkmcnt(11)
    v_mfma_f32_32x32x16_bf16 v[64:79], v[224:227], v[32:35], v[64:79]
    ds_read_b128 v[232:235], v10 offset:28672
    ds_read_b64_tr_b16 v[56:57], v12 offset:47104
    ds_read_b64_tr_b16 v[58:59], v12 offset:47360
    s_waitcnt lgkmcnt(12)
    v_mfma_f32_32x32x16_bf16 v[80:95], v[224:227], v[36:39], v[80:95]
    ds_read_b64_tr_b16 v[60:61], v12 offset:51200
    ds_read_b64_tr_b16 v[62:63], v12 offset:51456
    s_waitcnt lgkmcnt(12)
    v_mfma_f32_32x32x16_bf16 v[96:111], v[40:43], v[224:227], v[96:111]
    ds_read_b64_tr_b16 v[32:33], v12 offset:55296
    ds_read_b64_tr_b16 v[34:35], v12 offset:55552
    s_waitcnt lgkmcnt(11)
    v_mfma_f32_32x32x16_bf16 v[64:79], v[228:231], v[44:47], v[64:79]
    ds_read_b128 v[236:239], v11 offset:28672
    ds_read_b64_tr_b16 v[36:37], v12 offset:48128
    ds_read_b64_tr_b16 v[38:39], v12 offset:48384
    s_waitcnt lgkmcnt(12)
    v_mfma_f32_32x32x16_bf16 v[80:95], v[228:231], v[48:51], v[80:95]
    ds_read_b64_tr_b16 v[40:41], v12 offset:52224
    ds_read_b64_tr_b16 v[42:43], v12 offset:52480
    s_waitcnt lgkmcnt(12)
    v_mfma_f32_32x32x16_bf16 v[96:111], v[52:55], v[228:231], v[96:111]
    ds_read_b64_tr_b16 v[44:45], v12 offset:56320
    ds_read_b64_tr_b16 v[46:47], v12 offset:56576
    s_waitcnt lgkmcnt(11)
    v_mfma_f32_32x32x16_bf16 v[64:79], v[232:235], v[56:59], v[64:79]
    s_barrier
    ds_read_b128 v[240:243], v8 offset:57344
    ds_read_b64_tr_b16 v[48:49], v28 offset:8192
    ds_read_b64_tr_b16 v[50:51], v28 offset:8448
    s_waitcnt lgkmcnt(12)
    v_mfma_f32_32x32x16_bf16 v[80:95], v[232:235], v[60:63], v[80:95]
    ds_read_b64_tr_b16 v[52:53], v28 offset:12288
    ds_read_b64_tr_b16 v[54:55], v28 offset:12544
    s_waitcnt lgkmcnt(12)
    v_mfma_f32_32x32x16_bf16 v[96:111], v[32:35], v[232:235], v[96:111]
    ds_read_b128 v[244:247], v9 offset:57344
    ds_read_b64_tr_b16 v[56:57], v28 offset:9216
    ds_read_b64_tr_b16 v[58:59], v28 offset:9472
    s_waitcnt lgkmcnt(12)
    v_mfma_f32_32x32x16_bf16 v[64:79], v[236:239], v[36:39], v[64:79]
    ds_read_b64_tr_b16 v[60:61], v28 offset:13312
    ds_read_b64_tr_b16 v[62:63], v28 offset:13568
    s_waitcnt lgkmcnt(12)
    v_mfma_f32_32x32x16_bf16 v[80:95], v[236:239], v[40:43], v[80:95]
    ds_read_b128 v[248:251], v10 offset:57344
    ds_read_b64_tr_b16 v[32:33], v28 offset:10240
    ds_read_b64_tr_b16 v[34:35], v28 offset:10496
    s_waitcnt lgkmcnt(13)
    v_mfma_f32_32x32x16_bf16 v[96:111], v[44:47], v[236:239], v[96:111]
    ds_read_b64_tr_b16 v[36:37], v28 offset:14336
    ds_read_b64_tr_b16 v[38:39], v28 offset:14592
    s_waitcnt lgkmcnt(12)
    v_mfma_f32_32x32x16_bf16 v[64:79], v[240:243], v[48:51], v[64:79]
    ds_read_b128 v[252:255], v11 offset:57344
    ds_read_b64_tr_b16 v[40:41], v28 offset:11264
    ds_read_b64_tr_b16 v[42:43], v28 offset:11520
    s_waitcnt lgkmcnt(13)
    v_mfma_f32_32x32x16_bf16 v[80:95], v[240:243], v[52:55], v[80:95]
    ds_read_b64_tr_b16 v[44:45], v28 offset:15360
    ds_read_b64_tr_b16 v[46:47], v28 offset:15616
    s_waitcnt lgkmcnt(12)
    v_mfma_f32_32x32x16_bf16 v[64:79], v[244:247], v[56:59], v[64:79]
    ds_read_b64_tr_b16 v[48:49], v28 offset:16384
    ds_read_b64_tr_b16 v[50:51], v28 offset:16640
    s_waitcnt lgkmcnt(12)
    v_mfma_f32_32x32x16_bf16 v[80:95], v[244:247], v[60:63], v[80:95]
    ds_read_b64_tr_b16 v[52:53], v28 offset:17408
    ds_read_b64_tr_b16 v[54:55], v28 offset:17664
    s_waitcnt lgkmcnt(11)
    v_mfma_f32_32x32x16_bf16 v[64:79], v[248:251], v[32:35], v[64:79]
    ds_read_b64_tr_b16 v[56:57], v28 offset:18432
    ds_read_b64_tr_b16 v[58:59], v28 offset:18688
    s_waitcnt lgkmcnt(11)
    v_mfma_f32_32x32x16_bf16 v[80:95], v[248:251], v[36:39], v[80:95]
    ds_read_b64_tr_b16 v[60:61], v28 offset:19456
    ds_read_b64_tr_b16 v[62:63], v28 offset:19712
    s_waitcnt lgkmcnt(10)
    v_mfma_f32_32x32x16_bf16 v[64:79], v[252:255], v[40:43], v[64:79]
    s_waitcnt lgkmcnt(8)
    v_mfma_f32_32x32x16_bf16 v[80:95], v[252:255], v[44:47], v[80:95]
    s_waitcnt lgkmcnt(6)
    v_mfma_f32_32x32x16_bf16 v[96:111], v[48:51], v[240:243], v[96:111]
    s_waitcnt lgkmcnt(4)
    v_mfma_f32_32x32x16_bf16 v[96:111], v[52:55], v[244:247], v[96:111]
    s_waitcnt lgkmcnt(2)
    v_mfma_f32_32x32x16_bf16 v[96:111], v[56:59], v[248:251], v[96:111]
    s_waitcnt lgkmcnt(0)
    v_mfma_f32_32x32x16_bf16 v[96:111], v[60:63], v[252:255], v[96:111]
    v_bfe_u32 v20, v1, 4, 1
    v_lshlrev_b32 v20, 17, v20
    v_lshl_add_u32 v20, v6, 8, v20
    v_and_b32 v21, 15, v1
    v_lshl_add_u32 v20, v21, 4, v20
    v_cvt_pk_bf16_f32 v64, v64, v65
    v_cvt_pk_bf16_f32 v65, v66, v67
    v_cvt_pk_bf16_f32 v66, v68, v69
    v_cvt_pk_bf16_f32 v67, v70, v71
    v_cvt_pk_bf16_f32 v68, v72, v73
    v_cvt_pk_bf16_f32 v69, v74, v75
    v_cvt_pk_bf16_f32 v70, v76, v77
    v_cvt_pk_bf16_f32 v71, v78, v79
    s_add_u32 s20, s38, 65536
    buffer_store_dwordx4 v[64:67], v20, s[12:15], s20 offen sc1
    buffer_store_dwordx4 v[68:71], v20, s[12:15], s20 offen offset:512 sc1
    v_cvt_pk_bf16_f32 v80, v80, v81
    v_cvt_pk_bf16_f32 v81, v82, v83
    v_cvt_pk_bf16_f32 v82, v84, v85
    v_cvt_pk_bf16_f32 v83, v86, v87
    v_cvt_pk_bf16_f32 v84, v88, v89
    v_cvt_pk_bf16_f32 v85, v90, v91
    v_cvt_pk_bf16_f32 v86, v92, v93
    v_cvt_pk_bf16_f32 v87, v94, v95
    s_add_u32 s20, s38, 327680
    buffer_store_dwordx4 v[80:83], v20, s[12:15], s20 offen sc1
    buffer_store_dwordx4 v[84:87], v20, s[12:15], s20 offen offset:512 sc1
g_qpath:
    s_mov_b32 s36, 0x3eb8aa3b
    v_mul_f32 v96, s36, v96
    v_mul_f32 v97, s36, v97
    v_mul_f32 v98, s36, v98
    v_mul_f32 v99, s36, v99
    v_mul_f32 v100, s36, v100
    v_mul_f32 v101, s36, v101
    v_mul_f32 v102, s36, v102
    v_mul_f32 v103, s36, v103
    v_mul_f32 v104, s36, v104
    v_mul_f32 v105, s36, v105
    v_mul_f32 v106, s36, v106
    v_mul_f32 v107, s36, v107
    v_mul_f32 v108, s36, v108
    v_mul_f32 v109, s36, v109
    v_mul_f32 v110, s36, v110
    v_mul_f32 v111, s36, v111
    v_cvt_pk_bf16_f32 v96, v96, v97
    v_cvt_pk_bf16_f32 v97, v98, v99
    v_cvt_pk_bf16_f32 v98, v100, v101
    v_cvt_pk_bf16_f32 v99, v102, v103
    v_cvt_pk_bf16_f32 v100, v104, v105
    v_cvt_pk_bf16_f32 v101, v106, v107
    v_cvt_pk_bf16_f32 v102, v108, v109
    v_cvt_pk_bf16_f32 v103, v110, v111
    s_xor_b32 s20, s32, 2
    s_lshl_b32 s20, s20, 7
    s_add_u32 s20, s20, s34
    s_lshl_b32 s20, s20, 10
    s_add_u32 s20, s20, 0
    s_add_u32 s21, s20, 65536
    buffer_store_dwordx4 v[96:99], v3, s[12:15], s20 offen sc1
    buffer_store_dwordx4 v[100:103], v3, s[12:15], s21 offen sc1
    s_lshl_b32 s36, s31, 7
    s_add_u32 s36, s36, 56623104
    s_sub_u32 s36, s36, s3
    s_lshl_b32 s35, s35, 2
    s_add_u32 s35, s35, s31
    s_lshl_b32 s35, s35, 1
    s_and_b32 s20, s32, 1
    s_add_u32 s35, s35, s20
    s_lshl_b32 s35, s35, 6
    s_add_u32 s35, s35, 56639488
    s_sub_u32 s35, s35, s3
    s_barrier
    ds_read_u16 v56, v15 offset:0
    ds_read_u16 v58, v15 offset:64
    ds_read_u16 v60, v15 offset:128
    ds_read_u16 v62, v15 offset:192
    v_cmp_eq_u32 vcc, 0, v6
    v_mov_b32 v9, 0x3f80
    v_cndmask_b32 v8, 0, v9, vcc
    v_mov_b32 v9, 0
    v_mov_b32 v10, 0
    v_mov_b32 v11, 0
    s_mov_b32 s37, 0
    s_setprio 0
    ds_read_b64_tr_b16 v[32:33], v29 offset:16384
    ds_read_b64_tr_b16 v[34:35], v29 offset:16640
    ds_read_b64_tr_b16 v[36:37], v29 offset:20480
    ds_read_b64_tr_b16 v[38:39], v29 offset:20736
    ds_read_b64_tr_b16 v[40:41], v29 offset:17408
    ds_read_b64_tr_b16 v[42:43], v29 offset:17664
    ds_read_b64_tr_b16 v[44:45], v29 offset:21504
    ds_read_b64_tr_b16 v[46:47], v29 offset:21760
    ds_read_b64_tr_b16 v[48:49], v29 offset:18432
    ds_read_b64_tr_b16 v[50:51], v29 offset:18688
    ds_read_b64_tr_b16 v[52:53], v29 offset:22528
    ds_read_b64_tr_b16 v[54:55], v29 offset:22784
    s_waitcnt lgkmcnt(12)
    v_mfma_f32_32x32x16_bf16 v[112:127], v[62:65], v[8:11], 0
    v_mfma_f32_32x32x16_bf16 v[64:79], v[56:59], v[8:11], 0
    v_mfma_f32_32x32x16_bf16 v[80:95], v[58:61], v[8:11], 0
    v_mfma_f32_32x32x16_bf16 v[96:111], v[60:63], v[8:11], 0
    s_waitcnt lgkmcnt(10)
    v_mfma_f32_32x32x16_bf16 v[64:79], v[32:35], v[128:131], v[64:79]
    ds_read_b64_tr_b16 v[56:57], v29 offset:19456
    ds_read_b64_tr_b16 v[58:59], v29 offset:19712
    s_waitcnt lgkmcnt(10)
    v_mfma_f32_32x32x16_bf16 v[80:95], v[36:39], v[128:131], v[80:95]
    ds_read_b64_tr_b16 v[60:61], v29 offset:23552
    ds_read_b64_tr_b16 v[62:63], v29 offset:23808
    s_waitcnt lgkmcnt(10)
    v_mfma_f32_32x32x16_bf16 v[64:79], v[40:43], v[132:135], v[64:79]
    ds_read_b64_tr_b16 v[32:33], v29 offset:24576
    ds_read_b64_tr_b16 v[34:35], v29 offset:24832
    s_waitcnt lgkmcnt(10)
    v_mfma_f32_32x32x16_bf16 v[80:95], v[44:47], v[132:135], v[80:95]
    ds_read_b64_tr_b16 v[36:37], v29 offset:28672
    ds_read_b64_tr_b16 v[38:39], v29 offset:28928
    s_waitcnt lgkmcnt(10)
    v_mfma_f32_32x32x16_bf16 v[64:79], v[48:51], v[136:139], v[64:79]
    ds_read_b64_tr_b16 v[40:41], v29 offset:25600
    ds_read_b64_tr_b16 v[42:43], v29 offset:25856
    s_waitcnt lgkmcnt(10)
    v_mfma_f32_32x32x16_bf16 v[80:95], v[52:55], v[136:139], v[80:95]
    ds_read_b64_tr_b16 v[44:45], v29 offset:29696
    ds_read_b64_tr_b16 v[46:47], v29 offset:29952
    s_waitcnt lgkmcnt(10)
    v_mfma_f32_32x32x16_bf16 v[64:79], v[56:59], v[140:143], v[64:79]
    ds_read_b64_tr_b16 v[48:49], v29 offset:26624
    ds_read_b64_tr_b16 v[50:51], v29 offset:26880
    s_waitcnt lgkmcnt(10)
    v_mfma_f32_32x32x16_bf16 v[80:95], v[60:63], v[140:143], v[80:95]
    ds_read_b64_tr_b16 v[52:53], v29 offset:30720
    ds_read_b64_tr_b16 v[54:55], v29 offset:30976
    s_waitcnt lgkmcnt(10)
    v_mfma_f32_32x32x16_bf16 v[64:79], v[32:35], v[144:147], v[64:79]
    ds_read_b64_tr_b16 v[56:57], v29 offset:27648
    ds_read_b64_tr_b16 v[58:59], v29 offset:27904
    s_getreg_b32 s20, hwreg(HW_REG_IB_STS, 0, 4)
    s_or_b32 s20, s20, s37
    s_movk_i32 s21, 8
    s_cbranch_scc0 g_pubkv
g_fl8:
    s_waitcnt lgkmcnt(10)
    v_mfma_f32_32x32x16_bf16 v[80:95], v[36:39], v[144:147], v[80:95]
    ds_read_b64_tr_b16 v[60:61], v29 offset:31744
    ds_read_b64_tr_b16 v[62:63], v29 offset:32000
    s_waitcnt lgkmcnt(10)
    v_mfma_f32_32x32x16_bf16 v[64:79], v[40:43], v[148:151], v[64:79]
    ds_read_b64_tr_b16 v[32:33], v28 offset:20480
    ds_read_b64_tr_b16 v[34:35], v28 offset:20736
    s_waitcnt lgkmcnt(10)
    v_mfma_f32_32x32x16_bf16 v[80:95], v[44:47], v[148:151], v[80:95]
    ds_read_b64_tr_b16 v[36:37], v28 offset:24576
    ds_read_b64_tr_b16 v[38:39], v28 offset:24832
    s_waitcnt lgkmcnt(10)
    v_mfma_f32_32x32x16_bf16 v[64:79], v[48:51], v[152:155], v[64:79]
    ds_read_b64_tr_b16 v[40:41], v28 offset:21504
    ds_read_b64_tr_b16 v[42:43], v28 offset:21760
    s_waitcnt lgkmcnt(10)
    v_mfma_f32_32x32x16_bf16 v[80:95], v[52:55], v[152:155], v[80:95]
    ds_read_b64_tr_b16 v[44:45], v28 offset:25600
    ds_read_b64_tr_b16 v[46:47], v28 offset:25856
    s_getreg_b32 s20, hwreg(HW_REG_IB_STS, 0, 4)
    s_or_b32 s20, s20, s37
    s_movk_i32 s21, 13
    s_cbranch_scc0 g_pubkv
g_fl13:
    s_waitcnt lgkmcnt(10)
    v_mfma_f32_32x32x16_bf16 v[64:79], v[56:59], v[156:159], v[64:79]
    ds_read_b64_tr_b16 v[48:49], v28 offset:22528
    ds_read_b64_tr_b16 v[50:51], v28 offset:22784
    s_waitcnt lgkmcnt(10)
    v_mfma_f32_32x32x16_bf16 v[80:95], v[60:63], v[156:159], v[80:95]
    ds_read_b64_tr_b16 v[52:53], v28 offset:26624
    ds_read_b64_tr_b16 v[54:55], v28 offset:26880
    s_mov_b64 exec, 1
    ds_add_u32 v17, v22 offset:8
    s_mov_b64 exec, -1
    s_waitcnt lgkmcnt(11)
    v_mfma_f32_32x32x16_bf16 v[64:79], v[32:35], v[160:163], v[64:79]
    ds_read_b64_tr_b16 v[56:57], v28 offset:23552
    ds_read_b64_tr_b16 v[58:59], v28 offset:23808
    s_waitcnt lgkmcnt(11)
    v_mfma_f32_32x32x16_bf16 v[80:95], v[36:39], v[160:163], v[80:95]
    ds_read_b64_tr_b16 v[60:61], v28 offset:27648
    ds_read_b64_tr_b16 v[62:63], v28 offset:27904
    ds_read_b32 v20, v17 offset:52
    s_waitcnt lgkmcnt(12)
    v_mfma_f32_32x32x16_bf16 v[64:79], v[40:43], v[164:167], v[64:79]
    ds_read_b64_tr_b16 v[32:33], v28 offset:28672
    ds_read_b64_tr_b16 v[34:35], v28 offset:28928
    s_getreg_b32 s20, hwreg(HW_REG_IB_STS, 0, 4)
    s_or_b32 s20, s20, s37
    s_movk_i32 s21, 18
    s_cbranch_scc0 g_pubkv
g_fl18:
    s_waitcnt lgkmcnt(12)
    v_mfma_f32_32x32x16_bf16 v[80:95], v[44:47], v[164:167], v[80:95]
    ds_read_b64_tr_b16 v[36:37], v28 offset:32768
    ds_read_b64_tr_b16 v[38:39], v28 offset:33024
    s_waitcnt lgkmcnt(12)
    v_mfma_f32_32x32x16_bf16 v[64:79], v[48:51], v[168:171], v[64:79]
    ds_read_b64_tr_b16 v[40:41], v28 offset:29696
    ds_read_b64_tr_b16 v[42:43], v28 offset:29952
    s_waitcnt lgkmcnt(12)
    v_mfma_f32_32x32x16_bf16 v[80:95], v[52:55], v[168:171], v[80:95]
    ds_read_b64_tr_b16 v[44:45], v28 offset:33792
    ds_read_b64_tr_b16 v[46:47], v28 offset:34048
    s_waitcnt lgkmcnt(11)
    v_mfma_f32_32x32x16_bf16 v[64:79], v[56:59], v[172:175], v[64:79]
    ds_read_b64_tr_b16 v[48:49], v28 offset:30720
    ds_read_b64_tr_b16 v[50:51], v28 offset:30976
    s_getreg_b32 s20, hwreg(HW_REG_IB_STS, 0, 4)
    s_or_b32 s20, s20, s37
    s_movk_i32 s21, 22
    s_cbranch_scc0 g_pubkv
g_fl22:
    s_waitcnt lgkmcnt(11)
    v_mfma_f32_32x32x16_bf16 v[80:95], v[60:63], v[172:175], v[80:95]
    ds_read_b64_tr_b16 v[52:53], v28 offset:34816
    ds_read_b64_tr_b16 v[54:55], v28 offset:35072
    s_waitcnt lgkmcnt(10)
    v_mfma_f32_32x32x16_bf16 v[64:79], v[32:35], v[176:179], v[64:79]
    ds_read_b64_tr_b16 v[56:57], v28 offset:31744
    ds_read_b64_tr_b16 v[58:59], v28 offset:32000
    v_cmp_gt_u32 vcc, 4, v20
    s_waitcnt lgkmcnt(10)
    v_mfma_f32_32x32x16_bf16 v[80:95], v[36:39], v[176:179], v[80:95]
    ds_read_b64_tr_b16 v[60:61], v28 offset:35840
    ds_read_b64_tr_b16 v[62:63], v28 offset:36096
    s_cbranch_vccnz g_w1s24
g_w1ok24:
    s_waitcnt lgkmcnt(10)
    v_mfma_f32_32x32x16_bf16 v[64:79], v[40:43], v[180:183], v[64:79]
    ds_read_b64_tr_b16 v[32:33], v28 offset:36864
    ds_read_b64_tr_b16 v[34:35], v28 offset:37120
    s_waitcnt lgkmcnt(10)
    v_mfma_f32_32x32x16_bf16 v[80:95], v[44:47], v[180:183], v[80:95]
    ds_read_b64_tr_b16 v[36:37], v28 offset:40960
    ds_read_b64_tr_b16 v[38:39], v28 offset:41216
    s_getreg_b32 s20, hwreg(HW_REG_IB_STS, 0, 4)
    s_or_b32 s20, s20, s37
    s_movk_i32 s21, 27
    s_cbranch_scc0 g_pubkv
g_fl27:
    s_waitcnt lgkmcnt(10)
    v_mfma_f32_32x32x16_bf16 v[64:79], v[48:51], v[184:187], v[64:79]
    ds_read_b64_tr_b16 v[40:41], v28 offset:37888
    ds_read_b64_tr_b16 v[42:43], v28 offset:38144
    s_waitcnt lgkmcnt(10)
    v_mfma_f32_32x32x16_bf16 v[80:95], v[52:55], v[184:187], v[80:95]
    ds_read_b64_tr_b16 v[44:45], v28 offset:41984
    ds_read_b64_tr_b16 v[46:47], v28 offset:42240
    s_waitcnt lgkmcnt(10)
    v_mfma_f32_32x32x16_bf16 v[64:79], v[56:59], v[188:191], v[64:79]
    ds_read_b64_tr_b16 v[48:49], v28 offset:38912
    ds_read_b64_tr_b16 v[50:51], v28 offset:39168
    s_waitcnt lgkmcnt(10)
    v_mfma_f32_32x32x16_bf16 v[80:95], v[60:63], v[188:191], v[80:95]
    ds_read_b64_tr_b16 v[52:53], v28 offset:43008
    ds_read_b64_tr_b16 v[54:55], v28 offset:43264
    s_getreg_b32 s20, hwreg(HW_REG_IB_STS, 0, 4)
    s_or_b32 s20, s20, s37
    s_movk_i32 s21, 31
    s_cbranch_scc0 g_pubkv
g_fl31:
    s_waitcnt lgkmcnt(10)
    v_mfma_f32_32x32x16_bf16 v[64:79], v[32:35], v[192:195], v[64:79]
    ds_read_b64_tr_b16 v[56:57], v28 offset:39936
    ds_read_b64_tr_b16 v[58:59], v28 offset:40192
    s_waitcnt lgkmcnt(10)
    v_mfma_f32_32x32x16_bf16 v[80:95], v[36:39], v[192:195], v[80:95]
    ds_read_b64_tr_b16 v[60:61], v28 offset:44032
    ds_read_b64_tr_b16 v[62:63], v28 offset:44288
    s_waitcnt lgkmcnt(10)
    v_mfma_f32_32x32x16_bf16 v[64:79], v[40:43], v[196:199], v[64:79]
    ds_read_b64_tr_b16 v[32:33], v28 offset:45056
    ds_read_b64_tr_b16 v[34:35], v28 offset:45312
    s_waitcnt lgkmcnt(10)
    v_mfma_f32_32x32x16_bf16 v[80:95], v[44:47], v[196:199], v[80:95]
    ds_read_b64_tr_b16 v[36:37], v28 offset:49152
    ds_read_b64_tr_b16 v[38:39], v28 offset:49408
    s_getreg_b32 s20, hwreg(HW_REG_IB_STS, 0, 4)
    s_or_b32 s20, s20, s37
    s_movk_i32 s21, 35
    s_cbranch_scc0 g_pubkv
g_fl35:
    s_waitcnt lgkmcnt(10)
    v_mfma_f32_32x32x16_bf16 v[64:79], v[48:51], v[200:203], v[64:79]
    ds_read_b64_tr_b16 v[40:41], v28 offset:46080
    ds_read_b64_tr_b16 v[42:43], v28 offset:46336
    s_waitcnt lgkmcnt(10)
    v_mfma_f32_32x32x16_bf16 v[80:95], v[52:55], v[200:203], v[80:95]
    ds_read_b64_tr_b16 v[44:45], v28 offset:50176
    ds_read_b64_tr_b16 v[46:47], v28 offset:50432
    s_waitcnt lgkmcnt(10)
    v_mfma_f32_32x32x16_bf16 v[64:79], v[56:59], v[204:207], v[64:79]
    ds_read_b64_tr_b16 v[48:49], v28 offset:47104
    ds_read_b64_tr_b16 v[50:51], v28 offset:47360
    s_waitcnt lgkmcnt(10)
    v_mfma_f32_32x32x16_bf16 v[80:95], v[60:63], v[204:207], v[80:95]
    ds_read_b64_tr_b16 v[52:53], v28 offset:51200
    ds_read_b64_tr_b16 v[54:55], v28 offset:51456
    s_getreg_b32 s20, hwreg(HW_REG_IB_STS, 0, 4)
    s_or_b32 s20, s20, s37
    s_movk_i32 s21, 39
    s_cbranch_scc0 g_pubkv
g_fl39:
    s_waitcnt lgkmcnt(10)
    v_mfma_f32_32x32x16_bf16 v[64:79], v[32:35], v[208:211], v[64:79]
    ds_read_b64_tr_b16 v[56:57], v28 offset:48128
    ds_read_b64_tr_b16 v[58:59], v28 offset:48384
    s_waitcnt lgkmcnt(10)
    v_mfma_f32_32x32x16_bf16 v[80:95], v[36:39], v[208:211], v[80:95]
    ds_read_b64_tr_b16 v[60:61], v28 offset:52224
    ds_read_b64_tr_b16 v[62:63], v28 offset:52480
    s_waitcnt lgkmcnt(10)
    v_mfma_f32_32x32x16_bf16 v[64:79], v[40:43], v[212:215], v[64:79]
    ds_read_b64_tr_b16 v[32:33], v28 offset:53248
    ds_read_b64_tr_b16 v[34:35], v28 offset:53504
    s_waitcnt lgkmcnt(10)
    v_mfma_f32_32x32x16_bf16 v[80:95], v[44:47], v[212:215], v[80:95]
    ds_read_b64_tr_b16 v[36:37], v28 offset:57344
    ds_read_b64_tr_b16 v[38:39], v28 offset:57600
    s_getreg_b32 s20, hwreg(HW_REG_IB_STS, 0, 4)
    s_or_b32 s20, s20, s37
    s_movk_i32 s21, 43
    s_cbranch_scc0 g_pubkv
g_fl43:
    s_waitcnt lgkmcnt(10)
    v_mfma_f32_32x32x16_bf16 v[64:79], v[48:51], v[216:219], v[64:79]
    ds_read_b64_tr_b16 v[40:41], v28 offset:54272
    ds_read_b64_tr_b16 v[42:43], v28 offset:54528
    s_waitcnt lgkmcnt(10)
    v_mfma_f32_32x32x16_bf16 v[80:95], v[52:55], v[216:219], v[80:95]
    ds_read_b64_tr_b16 v[44:45], v28 offset:58368
    ds_read_b64_tr_b16 v[46:47], v28 offset:58624
    s_waitcnt lgkmcnt(10)
    v_mfma_f32_32x32x16_bf16 v[64:79], v[56:59], v[220:223], v[64:79]
    ds_read_b64_tr_b16 v[48:49], v28 offset:55296
    ds_read_b64_tr_b16 v[50:51], v28 offset:55552
    s_waitcnt lgkmcnt(10)
    v_mfma_f32_32x32x16_bf16 v[80:95], v[60:63], v[220:223], v[80:95]
    ds_read_b64_tr_b16 v[52:53], v28 offset:59392
    ds_read_b64_tr_b16 v[54:55], v28 offset:59648
    s_waitcnt lgkmcnt(10)
    v_mfma_f32_32x32x16_bf16 v[64:79], v[32:35], v[224:227], v[64:79]
    ds_read_b64_tr_b16 v[56:57], v28 offset:56320
    ds_read_b64_tr_b16 v[58:59], v28 offset:56576
    s_getreg_b32 s20, hwreg(HW_REG_IB_STS, 0, 4)
    s_or_b32 s20, s20, s37
    s_movk_i32 s21, 48
    s_cbranch_scc0 g_pubkv
g_fl48:
    s_waitcnt lgkmcnt(10)
    v_mfma_f32_32x32x16_bf16 v[80:95], v[36:39], v[224:227], v[80:95]
    ds_read_b64_tr_b16 v[60:61], v28 offset:60416
    ds_read_b64_tr_b16 v[62:63], v28 offset:60672
    ds_read_b32 v20, v17 offset:64
    s_waitcnt lgkmcnt(11)
    v_mfma_f32_32x32x16_bf16 v[64:79], v[40:43], v[228:231], v[64:79]
    ds_read_b64_tr_b16 v[32:33], v28 offset:61440
    ds_read_b64_tr_b16 v[34:35], v28 offset:61696
    s_waitcnt lgkmcnt(11)
    v_mfma_f32_32x32x16_bf16 v[80:95], v[44:47], v[228:231], v[80:95]
    ds_read_b64_tr_b16 v[36:37], v29 offset:0
    ds_read_b64_tr_b16 v[38:39], v29 offset:256
    s_waitcnt lgkmcnt(11)
    v_mfma_f32_32x32x16_bf16 v[64:79], v[48:51], v[232:235], v[64:79]
    ds_read_b64_tr_b16 v[40:41], v28 offset:62464
    ds_read_b64_tr_b16 v[42:43], v28 offset:62720
    ds_read_b32 v13, v17 offset:8
    s_waitcnt lgkmcnt(12)
    v_mfma_f32_32x32x16_bf16 v[80:95], v[52:55], v[232:235], v[80:95]
    ds_read_b64_tr_b16 v[44:45], v29 offset:1024
    ds_read_b64_tr_b16 v[46:47], v29 offset:1280
    s_getreg_b32 s20, hwreg(HW_REG_IB_STS, 0, 4)
    s_or_b32 s20, s20, s37
    s_movk_i32 s21, 53
    s_cbranch_scc0 g_pubkv
g_fl53:
    s_waitcnt lgkmcnt(12)
    v_mfma_f32_32x32x16_bf16 v[64:79], v[56:59], v[236:239], v[64:79]
    ds_read_b64_tr_b16 v[48:49], v28 offset:63488
    ds_read_b64_tr_b16 v[50:51], v28 offset:63744
    s_waitcnt lgkmcnt(12)
    v_mfma_f32_32x32x16_bf16 v[80:95], v[60:63], v[236:239], v[80:95]
    ds_read_b64_tr_b16 v[52:53], v29 offset:2048
    ds_read_b64_tr_b16 v[54:55], v29 offset:2304
    s_waitcnt lgkmcnt(11)
    v_mfma_f32_32x32x16_bf16 v[64:79], v[32:35], v[240:243], v[64:79]
    ds_read_b64_tr_b16 v[56:57], v28 offset:64512
    ds_read_b64_tr_b16 v[58:59], v28 offset:64768
    v_cmp_gt_u32 vcc, 4, v20
    s_waitcnt lgkmcnt(11)
    v_mfma_f32_32x32x16_bf16 v[80:95], v[36:39], v[240:243], v[80:95]
    ds_read_b64_tr_b16 v[60:61], v29 offset:3072
    ds_read_b64_tr_b16 v[62:63], v29 offset:3328
    s_cbranch_vccnz g_w1s56
g_w1ok56:
    s_waitcnt lgkmcnt(11)
    v_mfma_f32_32x32x16_bf16 v[64:79], v[40:43], v[244:247], v[64:79]
    ds_read_b64_tr_b16 v[32:33], v29 offset:4096
    ds_read_b64_tr_b16 v[34:35], v29 offset:4352
    s_cmp_lg_u32 s37, 0
    s_movk_i32 s21, 58
    s_cbranch_scc0 g_pubkv
g_fl58:
    s_waitcnt lgkmcnt(10)
    v_mfma_f32_32x32x16_bf16 v[80:95], v[44:47], v[244:247], v[80:95]
    ds_read_b64_tr_b16 v[36:37], v29 offset:5120
    ds_read_b64_tr_b16 v[38:39], v29 offset:5376
    v_cmp_gt_u32 vcc, 4, v13
    s_waitcnt lgkmcnt(10)
    v_mfma_f32_32x32x16_bf16 v[64:79], v[48:51], v[248:251], v[64:79]
    ds_read_b64_tr_b16 v[40:41], v29 offset:6144
    ds_read_b64_tr_b16 v[42:43], v29 offset:6400
    s_cbranch_vccnz g_w1s59
g_w1ok59:
    s_waitcnt lgkmcnt(10)
    v_mfma_f32_32x32x16_bf16 v[80:95], v[52:55], v[248:251], v[80:95]
    ds_read_b64_tr_b16 v[44:45], v29 offset:7168
    ds_read_b64_tr_b16 v[46:47], v29 offset:7424
    s_cmp_ge_u32 s32, 8
    s_cbranch_scc1 g_nolate
    s_add_u32 s21, s33, 7
    s_and_b32 s21, s21, 7
    s_mul_i32 s89, s21, 229376
    s_add_u32 s89, s89, s39
    s_add_u32 m0, s88, 147456
    s_add_u32 s20, s89, 64
    buffer_load_dwordx4 v30, s[84:87], s20 offen lds
g_nolate:
    s_waitcnt lgkmcnt(10)
    v_mfma_f32_32x32x16_bf16 v[64:79], v[56:59], v[252:255], v[64:79]
    ds_read_b64_tr_b16 v[48:49], v12 offset:0
    ds_read_b64_tr_b16 v[50:51], v12 offset:256
    s_waitcnt lgkmcnt(10)
    v_mfma_f32_32x32x16_bf16 v[80:95], v[60:63], v[252:255], v[80:95]
    ds_read_b64_tr_b16 v[52:53], v12 offset:1024
    ds_read_b64_tr_b16 v[54:55], v12 offset:1280
    s_waitcnt lgkmcnt(10)
    v_mfma_f32_32x32x16_bf16 v[96:111], v[32:35], v[128:131], v[96:111]
    ds_read_b64_tr_b16 v[56:57], v12 offset:2048
    ds_read_b64_tr_b16 v[58:59], v12 offset:2304
    s_waitcnt lgkmcnt(10)
    v_mfma_f32_32x32x16_bf16 v[96:111], v[36:39], v[132:135], v[96:111]
    ds_read_b64_tr_b16 v[60:61], v12 offset:3072
    ds_read_b64_tr_b16 v[62:63], v12 offset:3328
    ds_read_b32 v20, v17 offset:68
    s_waitcnt lgkmcnt(11)
    v_mfma_f32_32x32x16_bf16 v[96:111], v[40:43], v[136:139], v[96:111]
    ds_read_b64_tr_b16 v[32:33], v12 offset:8192
    ds_read_b64_tr_b16 v[34:35], v12 offset:8448
    s_waitcnt lgkmcnt(11)
    v_mfma_f32_32x32x16_bf16 v[96:111], v[44:47], v[140:143], v[96:111]
    ds_read_b64_tr_b16 v[36:37], v12 offset:9216
    ds_read_b64_tr_b16 v[38:39], v12 offset:9472
    s_setprio 2
    v_mul_f32 v64, v64, |v64|
    v_mul_f32 v65, v65, |v65|
    v_mul_f32 v66, v66, |v66|
    v_mul_f32 v67, v67, |v67|
    s_setprio 0
    s_waitcnt lgkmcnt(11)
    v_mfma_f32_32x32x16_bf16 v[96:111], v[48:51], v[144:147], v[96:111]
    ds_read_b64_tr_b16 v[40:41], v12 offset:10240
    ds_read_b64_tr_b16 v[42:43], v12 offset:10496
    s_setprio 2
    v_mul_f32 v68, v68, |v68|
    v_mul_f32 v69, v69, |v69|
    v_mul_f32 v70, v70, |v70|
    v_mul_f32 v71, v71, |v71|
    s_setprio 0
    s_waitcnt lgkmcnt(11)
    v_mfma_f32_32x32x16_bf16 v[96:111], v[52:55], v[148:151], v[96:111]
    ds_read_b64_tr_b16 v[44:45], v12 offset:11264
    ds_read_b64_tr_b16 v[46:47], v12 offset:11520
    s_setprio 2
    v_mul_f32 v72, v72, |v72|
    v_mul_f32 v73, v73, |v73|
    v_mul_f32 v74, v74, |v74|
    v_mul_f32 v75, v75, |v75|
    s_setprio 0
    s_waitcnt lgkmcnt(11)
    v_mfma_f32_32x32x16_bf16 v[96:111], v[56:59], v[152:155], v[96:111]
    ds_read_b64_tr_b16 v[48:49], v12 offset:16384
    ds_read_b64_tr_b16 v[50:51], v12 offset:16640
    s_setprio 2
    v_mul_f32 v76, v76, |v76|
    v_mul_f32 v77, v77, |v77|
    v_mul_f32 v78, v78, |v78|
    v_mul_f32 v79, v79, |v79|
    s_setprio 0
    s_waitcnt lgkmcnt(11)
    v_mfma_f32_32x32x16_bf16 v[96:111], v[60:63], v[156:159], v[96:111]
    ds_read_b64_tr_b16 v[52:53], v12 offset:17408
    ds_read_b64_tr_b16 v[54:55], v12 offset:17664
    s_setprio 2
    v_cvt_pk_bf16_f32 v64, v64, v65
    v_cvt_pk_bf16_f32 v65, v66, v67
    v_cvt_pk_bf16_f32 v66, v68, v69
    v_cvt_pk_bf16_f32 v67, v70, v71
    s_setprio 0
    s_waitcnt lgkmcnt(10)
    v_mfma_f32_32x32x16_bf16 v[96:111], v[32:35], v[160:163], v[96:111]
    ds_read_b64_tr_b16 v[56:57], v12 offset:18432
    ds_read_b64_tr_b16 v[58:59], v12 offset:18688
    v_cmp_gt_u32 vcc, 4, v20
    s_waitcnt lgkmcnt(10)
    v_mfma_f32_32x32x16_bf16 v[96:111], v[36:39], v[164:167], v[96:111]
    ds_read_b64_tr_b16 v[60:61], v12 offset:19456
    ds_read_b64_tr_b16 v[62:63], v12 offset:19712
    s_cbranch_vccnz g_w1s72
g_w1ok72:
    s_waitcnt lgkmcnt(10)
    v_mfma_f32_32x32x16_bf16 v[96:111], v[40:43], v[168:171], v[96:111]
    ds_read_b64_tr_b16 v[32:33], v12 offset:24576
    ds_read_b64_tr_b16 v[34:35], v12 offset:24832
    s_setprio 2
    v_cvt_pk_bf16_f32 v68, v72, v73
    v_cvt_pk_bf16_f32 v69, v74, v75
    v_cvt_pk_bf16_f32 v70, v76, v77
    v_cvt_pk_bf16_f32 v71, v78, v79
    s_setprio 0
    s_waitcnt lgkmcnt(10)
    v_mfma_f32_32x32x16_bf16 v[96:111], v[44:47], v[172:175], v[96:111]
    ds_read_b64_tr_b16 v[36:37], v12 offset:25600
    ds_read_b64_tr_b16 v[38:39], v12 offset:25856
    s_setprio 2
    v_pk_max_i16 v64, v64, 0
    v_pk_max_i16 v65, v65, 0
    v_pk_max_i16 v66, v66, 0
    v_pk_max_i16 v67, v67, 0
    s_setprio 0
    s_waitcnt lgkmcnt(10)
    v_mfma_f32_32x32x16_bf16 v[96:111], v[48:51], v[176:179], v[96:111]
    ds_read_b64_tr_b16 v[40:41], v12 offset:26624
    ds_read_b64_tr_b16 v[42:43], v12 offset:26880
    s_setprio 2
    v_pk_max_i16 v68, v68, 0
    v_pk_max_i16 v69, v69, 0
    v_pk_max_i16 v70, v70, 0
    v_pk_max_i16 v71, v71, 0
    s_setprio 0
    s_waitcnt lgkmcnt(10)
    v_mfma_f32_32x32x16_bf16 v[96:111], v[52:55], v[180:183], v[96:111]
    ds_read_b64_tr_b16 v[44:45], v12 offset:27648
    ds_read_b64_tr_b16 v[46:47], v12 offset:27904
    s_setprio 2
    v_mul_f32 v80, v80, |v80|
    v_mul_f32 v81, v81, |v81|
    v_mul_f32 v82, v82, |v82|
    v_mul_f32 v83, v83, |v83|
    s_setprio 0
    s_waitcnt lgkmcnt(10)
    v_mfma_f32_32x32x16_bf16 v[96:111], v[56:59], v[184:187], v[96:111]
    ds_read_b64_tr_b16 v[48:49], v12 offset:32768
    ds_read_b64_tr_b16 v[50:51], v12 offset:33024
    s_setprio 2
    v_mul_f32 v84, v84, |v84|
    v_mul_f32 v85, v85, |v85|
    v_mul_f32 v86, v86, |v86|
    v_mul_f32 v87, v87, |v87|
    s_setprio 0
    s_waitcnt lgkmcnt(10)
    v_mfma_f32_32x32x16_bf16 v[96:111], v[60:63], v[188:191], v[96:111]
    ds_read_b64_tr_b16 v[52:53], v12 offset:33792
    ds_read_b64_tr_b16 v[54:55], v12 offset:34048
    s_setprio 2
    v_mul_f32 v88, v88, |v88|
    v_mul_f32 v89, v89, |v89|
    v_mul_f32 v90, v90, |v90|
    v_mul_f32 v91, v91, |v91|
    s_setprio 0
    s_waitcnt lgkmcnt(10)
    v_mfma_f32_32x32x16_bf16 v[96:111], v[32:35], v[192:195], v[96:111]
    ds_read_b64_tr_b16 v[56:57], v12 offset:34816
    ds_read_b64_tr_b16 v[58:59], v12 offset:35072
    s_setprio 2
    v_mul_f32 v92, v92, |v92|
    v_mul_f32 v93, v93, |v93|
    v_mul_f32 v94, v94, |v94|
    v_mul_f32 v95, v95, |v95|
    s_setprio 0
    s_waitcnt lgkmcnt(10)
    v_mfma_f32_32x32x16_bf16 v[96:111], v[36:39], v[196:199], v[96:111]
    ds_read_b64_tr_b16 v[60:61], v12 offset:35840
    ds_read_b64_tr_b16 v[62:63], v12 offset:36096
    s_setprio 2
    v_cvt_pk_bf16_f32 v80, v80, v81
    v_cvt_pk_bf16_f32 v81, v82, v83
    v_cvt_pk_bf16_f32 v82, v84, v85
    v_cvt_pk_bf16_f32 v83, v86, v87
    s_setprio 0
    s_waitcnt lgkmcnt(10)
    v_mfma_f32_32x32x16_bf16 v[96:111], v[40:43], v[200:203], v[96:111]
    ds_read_b64_tr_b16 v[32:33], v12 offset:40960
    ds_read_b64_tr_b16 v[34:35], v12 offset:41216
    s_setprio 2
    v_cvt_pk_bf16_f32 v84, v88, v89
    v_cvt_pk_bf16_f32 v85, v90, v91
    v_cvt_pk_bf16_f32 v86, v92, v93
    v_cvt_pk_bf16_f32 v87, v94, v95
    s_setprio 0
    s_waitcnt lgkmcnt(10)
    v_mfma_f32_32x32x16_bf16 v[96:111], v[44:47], v[204:207], v[96:111]
    ds_read_b64_tr_b16 v[36:37], v12 offset:41984
    ds_read_b64_tr_b16 v[38:39], v12 offset:42240
    s_setprio 2
    v_pk_max_i16 v80, v80, 0
    v_pk_max_i16 v81, v81, 0
    v_pk_max_i16 v82, v82, 0
    v_pk_max_i16 v83, v83, 0
    s_setprio 0
    s_waitcnt lgkmcnt(10)
    v_mfma_f32_32x32x16_bf16 v[96:111], v[48:51], v[208:211], v[96:111]
    ds_read_b64_tr_b16 v[40:41], v12 offset:43008
    ds_read_b64_tr_b16 v[42:43], v12 offset:43264
    s_setprio 2
    v_pk_max_i16 v84, v84, 0
    v_pk_max_i16 v85, v85, 0
    v_pk_max_i16 v86, v86, 0
    v_pk_max_i16 v87, v87, 0
    s_setprio 0
    s_waitcnt lgkmcnt(10)
    v_mfma_f32_32x32x16_bf16 v[96:111], v[52:55], v[212:215], v[96:111]
    ds_read_b64_tr_b16 v[44:45], v12 offset:44032
    ds_read_b64_tr_b16 v[46:47], v12 offset:44288
    s_waitcnt lgkmcnt(10)
    v_mfma_f32_32x32x16_bf16 v[96:111], v[56:59], v[216:219], v[96:111]
    ds_read_b64_tr_b16 v[48:49], v28 offset:16384
    ds_read_b64_tr_b16 v[50:51], v28 offset:16640
    s_waitcnt lgkmcnt(10)
    v_mfma_f32_32x32x16_bf16 v[96:111], v[60:63], v[220:223], v[96:111]
    ds_read_b64_tr_b16 v[52:53], v28 offset:17408
    ds_read_b64_tr_b16 v[54:55], v28 offset:17664
    s_waitcnt lgkmcnt(10)
    v_mfma_f32_32x32x16_bf16 v[96:111], v[32:35], v[224:227], v[96:111]
    ds_read_b64_tr_b16 v[56:57], v28 offset:18432
    ds_read_b64_tr_b16 v[58:59], v28 offset:18688
    s_waitcnt lgkmcnt(10)
    v_mfma_f32_32x32x16_bf16 v[96:111], v[36:39], v[228:231], v[96:111]
    ds_read_b64_tr_b16 v[60:61], v28 offset:19456
    ds_read_b64_tr_b16 v[62:63], v28 offset:19712
    s_waitcnt lgkmcnt(10)
    v_mfma_f32_32x32x16_bf16 v[96:111], v[40:43], v[232:235], v[96:111]
    ds_read_b64_tr_b16 v[32:33], v29 offset:8192
    ds_read_b64_tr_b16 v[34:35], v29 offset:8448
    s_waitcnt lgkmcnt(10)
    v_mfma_f32_32x32x16_bf16 v[96:111], v[44:47], v[236:239], v[96:111]
    ds_read_b64_tr_b16 v[36:37], v29 offset:9216
    ds_read_b64_tr_b16 v[38:39], v29 offset:9472
    s_waitcnt lgkmcnt(10)
    v_mfma_f32_32x32x16_bf16 v[96:111], v[48:51], v[240:243], v[96:111]
    ds_read_b64_tr_b16 v[40:41], v29 offset:10240
    ds_read_b64_tr_b16 v[42:43], v29 offset:10496
    s_waitcnt vmcnt(0)
    s_mov_b64 exec, 1
    ds_add_u32 v17, v22 offset:80
    s_mov_b64 exec, -1
    s_waitcnt lgkmcnt(11)
    v_mfma_f32_32x32x16_bf16 v[96:111], v[52:55], v[244:247], v[96:111]
    ds_read_b64_tr_b16 v[44:45], v29 offset:11264
    ds_read_b64_tr_b16 v[46:47], v29 offset:11520
    s_waitcnt lgkmcnt(11)
    v_mfma_f32_32x32x16_bf16 v[96:111], v[56:59], v[248:251], v[96:111]
    ds_read_b64_tr_b16 v[48:49], v12 offset:4096
    ds_read_b64_tr_b16 v[50:51], v12 offset:4352
    s_waitcnt lgkmcnt(11)
    v_mfma_f32_32x32x16_bf16 v[96:111], v[60:63], v[252:255], v[96:111]
    ds_read_b64_tr_b16 v[52:53], v12 offset:5120
    ds_read_b64_tr_b16 v[54:55], v12 offset:5376
    s_cmp_ge_u32 s32, 8
    s_cbranch_scc1 g_f3
    s_waitcnt lgkmcnt(11)
    v_mfma_f32_32x32x16_bf16 v[112:127], v[32:35], v[128:131], v[112:127]
    ds_read_b64_tr_b16 v[56:57], v12 offset:6144
    ds_read_b64_tr_b16 v[58:59], v12 offset:6400
    s_waitcnt lgkmcnt(11)
    v_mfma_f32_32x32x16_bf16 v[112:127], v[36:39], v[132:135], v[112:127]
    ds_read_b64_tr_b16 v[60:61], v12 offset:7168
    ds_read_b64_tr_b16 v[62:63], v12 offset:7424
    ds_read_b32 v20, v17 offset:80
    s_waitcnt lgkmcnt(12)
    v_mfma_f32_32x32x16_bf16 v[112:127], v[40:43], v[136:139], v[112:127]
    ds_read_b64_tr_b16 v[32:33], v12 offset:12288
    ds_read_b64_tr_b16 v[34:35], v12 offset:12544
    s_waitcnt lgkmcnt(11)
    v_mfma_f32_32x32x16_bf16 v[112:127], v[44:47], v[140:143], v[112:127]
    ds_read_b64_tr_b16 v[36:37], v12 offset:13312
    ds_read_b64_tr_b16 v[38:39], v12 offset:13568
    s_setprio 2
    v_mul_f32 v96, v96, |v96|
    v_mul_f32 v97, v97, |v97|
    v_mul_f32 v98, v98, |v98|
    v_mul_f32 v99, v99, |v99|
    s_setprio 0
    s_waitcnt lgkmcnt(11)
    v_mfma_f32_32x32x16_bf16 v[112:127], v[48:51], v[144:147], v[112:127]
    ds_read_b64_tr_b16 v[40:41], v12 offset:14336
    ds_read_b64_tr_b16 v[42:43], v12 offset:14592
    s_setprio 2
    v_mul_f32 v100, v100, |v100|
    v_mul_f32 v101, v101, |v101|
    v_mul_f32 v102, v102, |v102|
    v_mul_f32 v103, v103, |v103|
    s_setprio 0
    s_waitcnt lgkmcnt(11)
    v_mfma_f32_32x32x16_bf16 v[112:127], v[52:55], v[148:151], v[112:127]
    ds_read_b64_tr_b16 v[44:45], v12 offset:15360
    ds_read_b64_tr_b16 v[46:47], v12 offset:15616
    s_setprio 2
    v_mul_f32 v104, v104, |v104|
    v_mul_f32 v105, v105, |v105|
    v_mul_f32 v106, v106, |v106|
    v_mul_f32 v107, v107, |v107|
    s_setprio 0
    s_waitcnt lgkmcnt(11)
    v_mfma_f32_32x32x16_bf16 v[112:127], v[56:59], v[152:155], v[112:127]
    ds_read_b64_tr_b16 v[48:49], v12 offset:20480
    ds_read_b64_tr_b16 v[50:51], v12 offset:20736
    s_setprio 2
    v_mul_f32 v108, v108, |v108|
    v_mul_f32 v109, v109, |v109|
    v_mul_f32 v110, v110, |v110|
    v_mul_f32 v111, v111, |v111|
    s_setprio 0
    s_waitcnt lgkmcnt(11)
    v_mfma_f32_32x32x16_bf16 v[112:127], v[60:63], v[156:159], v[112:127]
    ds_read_b64_tr_b16 v[52:53], v12 offset:21504
    ds_read_b64_tr_b16 v[54:55], v12 offset:21760
    s_setprio 2
    v_cvt_pk_bf16_f32 v96, v96, v97
    v_cvt_pk_bf16_f32 v97, v98, v99
    v_cvt_pk_bf16_f32 v98, v100, v101
    v_cvt_pk_bf16_f32 v99, v102, v103
    s_setprio 0
    s_waitcnt lgkmcnt(10)
    v_mfma_f32_32x32x16_bf16 v[112:127], v[32:35], v[160:163], v[112:127]
    ds_read_b64_tr_b16 v[56:57], v12 offset:22528
    ds_read_b64_tr_b16 v[58:59], v12 offset:22784
    v_cmp_gt_u32 vcc, 4, v20
    s_waitcnt lgkmcnt(10)
    v_mfma_f32_32x32x16_bf16 v[112:127], v[36:39], v[164:167], v[112:127]
    ds_read_b64_tr_b16 v[60:61], v12 offset:23552
    ds_read_b64_tr_b16 v[62:63], v12 offset:23808
    s_cbranch_vccnz g_w1s104
g_w1ok104:
    s_waitcnt lgkmcnt(10)
    v_mfma_f32_32x32x16_bf16 v[112:127], v[40:43], v[168:171], v[112:127]
    ds_read_b64_tr_b16 v[32:33], v12 offset:28672
    ds_read_b64_tr_b16 v[34:35], v12 offset:28928
    s_setprio 2
    v_cvt_pk_bf16_f32 v100, v104, v105
    v_cvt_pk_bf16_f32 v101, v106, v107
    v_cvt_pk_bf16_f32 v102, v108, v109
    v_cvt_pk_bf16_f32 v103, v110, v111
    s_setprio 0
    s_waitcnt lgkmcnt(10)
    v_mfma_f32_32x32x16_bf16 v[112:127], v[44:47], v[172:175], v[112:127]
    ds_read_b64_tr_b16 v[36:37], v12 offset:29696
    ds_read_b64_tr_b16 v[38:39], v12 offset:29952
    s_setprio 2
    v_pk_max_i16 v96, v96, 0
    v_pk_max_i16 v97, v97, 0
    v_pk_max_i16 v98, v98, 0
    v_pk_max_i16 v99, v99, 0
    s_setprio 0
    s_waitcnt lgkmcnt(10)
    v_mfma_f32_32x32x16_bf16 v[112:127], v[48:51], v[176:179], v[112:127]
    ds_read_b64_tr_b16 v[40:41], v12 offset:30720
    ds_read_b64_tr_b16 v[42:43], v12 offset:30976
    s_setprio 2
    v_pk_max_i16 v100, v100, 0
    v_pk_max_i16 v101, v101, 0
    v_pk_max_i16 v102, v102, 0
    v_pk_max_i16 v103, v103, 0
    s_setprio 0
    buffer_load_dword v23, v31, s[12:15], s23 offen sc1
    s_waitcnt lgkmcnt(10)
    v_mfma_f32_32x32x16_bf16 v[112:127], v[52:55], v[180:183], v[112:127]
    ds_read_b64_tr_b16 v[44:45], v12 offset:31744
    ds_read_b64_tr_b16 v[46:47], v12 offset:32000
    s_waitcnt lgkmcnt(10)
    v_mfma_f32_32x32x16_bf16 v[112:127], v[56:59], v[184:187], v[112:127]
    ds_read_b64_tr_b16 v[48:49], v12 offset:36864
    ds_read_b64_tr_b16 v[50:51], v12 offset:37120
    s_waitcnt lgkmcnt(10)
    v_mfma_f32_32x32x16_bf16 v[112:127], v[60:63], v[188:191], v[112:127]
    ds_read_b64_tr_b16 v[52:53], v12 offset:37888
    ds_read_b64_tr_b16 v[54:55], v12 offset:38144
    s_waitcnt lgkmcnt(10)
    v_mfma_f32_32x32x16_bf16 v[112:127], v[32:35], v[192:195], v[112:127]
    ds_read_b64_tr_b16 v[56:57], v12 offset:38912
    ds_read_b64_tr_b16 v[58:59], v12 offset:39168
    s_waitcnt lgkmcnt(10)
    v_mfma_f32_32x32x16_bf16 v[112:127], v[36:39], v[196:199], v[112:127]
    ds_read_b64_tr_b16 v[60:61], v12 offset:39936
    ds_read_b64_tr_b16 v[62:63], v12 offset:40192
    s_waitcnt lgkmcnt(10)
    v_mfma_f32_32x32x16_bf16 v[112:127], v[40:43], v[200:203], v[112:127]
    ds_read_b64_tr_b16 v[32:33], v12 offset:45056
    ds_read_b64_tr_b16 v[34:35], v12 offset:45312
    s_waitcnt lgkmcnt(10)
    v_mfma_f32_32x32x16_bf16 v[112:127], v[44:47], v[204:207], v[112:127]
    ds_read_b64_tr_b16 v[36:37], v12 offset:46080
    ds_read_b64_tr_b16 v[38:39], v12 offset:46336
    s_waitcnt lgkmcnt(10)
    v_mfma_f32_32x32x16_bf16 v[112:127], v[48:51], v[208:211], v[112:127]
    ds_read_b64_tr_b16 v[40:41], v12 offset:47104
    ds_read_b64_tr_b16 v[42:43], v12 offset:47360
    s_waitcnt lgkmcnt(10)
    v_mfma_f32_32x32x16_bf16 v[112:127], v[52:55], v[212:215], v[112:127]
    ds_read_b64_tr_b16 v[44:45], v12 offset:48128
    ds_read_b64_tr_b16 v[46:47], v12 offset:48384
    s_waitcnt lgkmcnt(10)
    v_mfma_f32_32x32x16_bf16 v[112:127], v[56:59], v[216:219], v[112:127]
    ds_read_b64_tr_b16 v[48:49], v29 offset:16384
    ds_read_b64_tr_b16 v[50:51], v29 offset:16640
    s_waitcnt lgkmcnt(10)
    v_mfma_f32_32x32x16_bf16 v[112:127], v[60:63], v[220:223], v[112:127]
    ds_read_b64_tr_b16 v[52:53], v29 offset:17408
    ds_read_b64_tr_b16 v[54:55], v29 offset:17664
    s_waitcnt lgkmcnt(10)
    v_mfma_f32_32x32x16_bf16 v[112:127], v[32:35], v[224:227], v[112:127]
    ds_read_b64_tr_b16 v[56:57], v29 offset:18432
    ds_read_b64_tr_b16 v[58:59], v29 offset:18688
    s_waitcnt lgkmcnt(10)
    v_mfma_f32_32x32x16_bf16 v[112:127], v[36:39], v[228:231], v[112:127]
    ds_read_b64_tr_b16 v[60:61], v29 offset:19456
    ds_read_b64_tr_b16 v[62:63], v29 offset:19712
    s_waitcnt lgkmcnt(10)
    v_mfma_f32_32x32x16_bf16 v[112:127], v[40:43], v[232:235], v[112:127]
    s_waitcnt lgkmcnt(8)
    v_mfma_f32_32x32x16_bf16 v[112:127], v[44:47], v[236:239], v[112:127]
    s_waitcnt lgkmcnt(6)
    v_mfma_f32_32x32x16_bf16 v[112:127], v[48:51], v[240:243], v[112:127]
    s_waitcnt lgkmcnt(4)
    v_mfma_f32_32x32x16_bf16 v[112:127], v[52:55], v[244:247], v[112:127]
    s_waitcnt lgkmcnt(2)
    v_mfma_f32_32x32x16_bf16 v[112:127], v[56:59], v[248:251], v[112:127]
    s_waitcnt lgkmcnt(0)
    v_mfma_f32_32x32x16_bf16 v[112:127], v[60:63], v[252:255], v[112:127]
    s_setprio 2
    s_mov_b64 exec, 1
    ds_add_u32 v17, v22 offset:4
    s_mov_b64 exec, -1
    s_nop 7
    s_nop 3
    v_mul_f32 v112, v112, |v112|
    v_mul_f32 v113, v113, |v113|
    v_mul_f32 v114, v114, |v114|
    v_mul_f32 v115, v115, |v115|
    v_mul_f32 v116, v116, |v116|
    v_mul_f32 v117, v117, |v117|
    v_mul_f32 v118, v118, |v118|
    v_mul_f32 v119, v119, |v119|
    v_mul_f32 v120, v120, |v120|
    v_mul_f32 v121, v121, |v121|
    v_mul_f32 v122, v122, |v122|
    v_mul_f32 v123, v123, |v123|
    v_mul_f32 v124, v124, |v124|
    v_mul_f32 v125, v125, |v125|
    v_mul_f32 v126, v126, |v126|
    v_mul_f32 v127, v127, |v127|
    v_cvt_pk_bf16_f32 v112, v112, v113
    v_cvt_pk_bf16_f32 v113, v114, v115
    v_cvt_pk_bf16_f32 v114, v116, v117
    v_cvt_pk_bf16_f32 v115, v118, v119
    v_cvt_pk_bf16_f32 v116, v120, v121
    v_cvt_pk_bf16_f32 v117, v122, v123
    v_cvt_pk_bf16_f32 v118, v124, v125
    v_cvt_pk_bf16_f32 v119, v126, v127
    v_pk_max_i16 v112, v112, 0
    v_pk_max_i16 v113, v113, 0
    v_pk_max_i16 v114, v114, 0
    v_pk_max_i16 v115, v115, 0
    v_pk_max_i16 v116, v116, 0
    v_pk_max_i16 v117, v117, 0
    v_pk_max_i16 v118, v118, 0
    v_pk_max_i16 v119, v119, 0
    s_waitcnt vmcnt(0)
    s_branch g_chk
g_pubkv:
    s_waitcnt vmcnt(0)
    s_mov_b64 exec, 1
    ds_add_rtn_u32 v18, v17, v22 offset:56
    s_waitcnt lgkmcnt(0)
    v_cmp_eq_u32 vcc, 3, v18
    s_mov_b64 exec, 1
    v_lshlrev_b32 v18, 14, v1
    s_nop 2
    s_cbranch_vccz g_pub7253
    buffer_store_dword v22, v18, s[12:15], s35 offen sc1
g_pub7253:
    s_mov_b64 exec, -1
    s_mov_b32 s37, 1
    s_cmp_eq_u32 s21, 999
    s_cbranch_scc1 g_fl999
    s_cmp_eq_u32 s21, 8
    s_cbranch_scc1 g_fl8
    s_cmp_eq_u32 s21, 13
    s_cbranch_scc1 g_fl13
    s_cmp_eq_u32 s21, 18
    s_cbranch_scc1 g_fl18
    s_cmp_eq_u32 s21, 22
    s_cbranch_scc1 g_fl22
    s_cmp_eq_u32 s21, 27
    s_cbranch_scc1 g_fl27
    s_cmp_eq_u32 s21, 31
    s_cbranch_scc1 g_fl31
    s_cmp_eq_u32 s21, 35
    s_cbranch_scc1 g_fl35
    s_cmp_eq_u32 s21, 39
    s_cbranch_scc1 g_fl39
    s_cmp_eq_u32 s21, 43
    s_cbranch_scc1 g_fl43
    s_cmp_eq_u32 s21, 48
    s_cbranch_scc1 g_fl48
    s_cmp_eq_u32 s21, 53
    s_cbranch_scc1 g_fl53
    s_branch g_fl58
g_w1s24:
    s_cmp_lg_u32 s37, 0
    s_movk_i32 s21, 999
    s_cbranch_scc0 g_pubkv
g_fl999:
    v_mov_b32 v19, 143412
    s_mov_b32 s97, 0
g_w124_ld:
    ds_read_b32 v21, v19
    s_waitcnt lgkmcnt(0)
    v_readfirstlane_b32 s20, v21
    s_nop 3
    s_cmp_ge_u32 s20, 4
    s_cbranch_scc1 g_w124_ok
    s_add_u32 s97, s97, 1
    s_cmp_gt_u32 s97, 262144
    s_cbranch_scc1 g_w124_ok
    s_sleep 1
    s_branch g_w124_ld
g_w124_ok:
    s_branch g_w1ok24
g_w1s56:
    v_mov_b32 v19, 143424
    s_mov_b32 s97, 0
g_w156_ld:
    ds_read_b32 v21, v19
    s_waitcnt lgkmcnt(0)
    v_readfirstlane_b32 s20, v21
    s_nop 3
    s_cmp_ge_u32 s20, 4
    s_cbranch_scc1 g_w156_ok
    s_add_u32 s97, s97, 1
    s_cmp_gt_u32 s97, 262144
    s_cbranch_scc1 g_w156_ok
    s_sleep 1
    s_branch g_w156_ld
g_w156_ok:
    s_branch g_w1ok56
g_w1s59:
    v_mov_b32 v19, 143368
    s_mov_b32 s97, 0
g_w159_ld:
    ds_read_b32 v21, v19
    s_waitcnt lgkmcnt(0)
    v_readfirstlane_b32 s20, v21
    s_nop 3
    s_cmp_ge_u32 s20, 4
    s_cbranch_scc1 g_w159_ok
    s_add_u32 s97, s97, 1
    s_cmp_gt_u32 s97, 262144
    s_cbranch_scc1 g_w159_ok
    s_sleep 1
    s_branch g_w159_ld
g_w159_ok:
    s_branch g_w1ok59
g_w1s72:
    v_mov_b32 v19, 143428
    s_mov_b32 s97, 0
g_w172_ld:
    ds_read_b32 v21, v19
    s_waitcnt lgkmcnt(0)
    v_readfirstlane_b32 s20, v21
    s_nop 3
    s_cmp_ge_u32 s20, 4
    s_cbranch_scc1 g_w172_ok
    s_add_u32 s97, s97, 1
    s_cmp_gt_u32 s97, 262144
    s_cbranch_scc1 g_w172_ok
    s_sleep 1
    s_branch g_w172_ld
g_w172_ok:
    s_branch g_w1ok72
g_w1s104:
    v_mov_b32 v19, 143440
    s_mov_b32 s97, 0
g_w1104_ld:
    ds_read_b32 v21, v19
    s_waitcnt lgkmcnt(0)
    v_readfirstlane_b32 s20, v21
    s_nop 3
    s_cmp_ge_u32 s20, 4
    s_cbranch_scc1 g_w1104_ok
    s_add_u32 s97, s97, 1
    s_cmp_gt_u32 s97, 262144
    s_cbranch_scc1 g_w1104_ok
    s_sleep 1
    s_branch g_w1104_ld
g_w1104_ok:
    s_branch g_w1ok104
g_f3:
    s_setprio 2
    buffer_load_dword v23, v31, s[12:15], s23 offen sc1
    s_waitcnt lgkmcnt(0)
    s_mov_b64 exec, 1
    ds_add_u32 v17, v22 offset:4
    s_mov_b64 exec, -1
    s_nop 7
    v_mul_f32 v96, v96, |v96|
    v_mul_f32 v97, v97, |v97|
    v_mul_f32 v98, v98, |v98|
    v_mul_f32 v99, v99, |v99|
    v_mul_f32 v100, v100, |v100|
    v_mul_f32 v101, v101, |v101|
    v_mul_f32 v102, v102, |v102|
    v_mul_f32 v103, v103, |v103|
    v_mul_f32 v104, v104, |v104|
    v_mul_f32 v105, v105, |v105|
    v_mul_f32 v106, v106, |v106|
    v_mul_f32 v107, v107, |v107|
    v_mul_f32 v108, v108, |v108|
    v_mul_f32 v109, v109, |v109|
    v_mul_f32 v110, v110, |v110|
    v_mul_f32 v111, v111, |v111|
    v_cvt_pk_bf16_f32 v96, v96, v97
    v_cvt_pk_bf16_f32 v97, v98, v99
    v_cvt_pk_bf16_f32 v98, v100, v101
    v_cvt_pk_bf16_f32 v99, v102, v103
    v_cvt_pk_bf16_f32 v100, v104, v105
    v_cvt_pk_bf16_f32 v101, v106, v107
    v_cvt_pk_bf16_f32 v102, v108, v109
    v_cvt_pk_bf16_f32 v103, v110, v111
    v_pk_max_i16 v96, v96, 0
    v_pk_max_i16 v97, v97, 0
    v_pk_max_i16 v98, v98, 0
    v_pk_max_i16 v99, v99, 0
    v_pk_max_i16 v100, v100, 0
    v_pk_max_i16 v101, v101, 0
    v_pk_max_i16 v102, v102, 0
    v_pk_max_i16 v103, v103, 0
    s_waitcnt vmcnt(0)
g_chk:
    s_mov_b32 s97, 0
g_as_ld:
    ds_read_b32 v9, v17 offset:88
    s_waitcnt lgkmcnt(0)
    v_readfirstlane_b32 s20, v9
    s_nop 3
    s_cmp_ge_u32 s20, 4
    s_cbranch_scc1 g_as_ok
    s_add_u32 s97, s97, 1
    s_cmp_gt_u32 s97, 262144
    s_cbranch_scc1 g_as_ok
    s_sleep 4
    s_branch g_as_ld
g_as_ok:
    v_cmp_ne_u32 vcc, 1, v23
    s_nop 4
    s_cbranch_vccz g_kv_ok
    s_mov_b32 s96, 0
g_kv_ld:
    buffer_load_dword v23, v31, s[12:15], s23 offen sc1
    s_waitcnt vmcnt(0)
g_kv_chk:
    v_cmp_ne_u32 vcc, 1, v23
    s_nop 4
    s_cbranch_vccz g_kv_ok
    s_add_u32 s96, s96, 1
    s_cmp_gt_u32 s96, 32768
    s_cbranch_scc1 g_kv_ok
    s_sleep 12
    s_branch g_kv_ld
g_kv_ok:
    s_mov_b32 s97, 0
g_f7_ld:
    ds_read_b32 v9, v17 offset:4
    s_waitcnt lgkmcnt(0)
    v_readfirstlane_b32 s20, v9
    s_nop 3
    s_cmp_ge_u32 s20, 4
    s_cbranch_scc1 g_f7_ok
    s_add_u32 s97, s97, 1
    s_cmp_gt_u32 s97, 262144
    s_cbranch_scc1 g_f7_ok
    s_sleep 2
    s_branch g_f7_ld
g_f7_ok:
    s_add_u32 s21, s41, 0
    s_and_b32 s21, s21, 15
    s_lshl_b32 s21, s21, 12
    s_add_u32 s21, s21, s22
    s_add_u32 m0, s40, 0
    s_add_u32 s20, s21, 0
    buffer_load_dwordx4 v3, s[12:15], s20 offen offset:0 sc1 lds
    buffer_load_dwordx4 v3, s[12:15], s20 offen offset:1024 sc1 lds
    buffer_load_dwordx4 v3, s[12:15], s20 offen offset:2048 sc1 lds
    buffer_load_dwordx4 v3, s[12:15], s20 offen offset:3072 sc1 lds
    s_add_u32 m0, s40, 4096
    s_add_u32 s20, s21, 65536
    buffer_load_dwordx4 v3, s[12:15], s20 offen offset:0 sc1 lds
    buffer_load_dwordx4 v3, s[12:15], s20 offen offset:1024 sc1 lds
    buffer_load_dwordx4 v3, s[12:15], s20 offen offset:2048 sc1 lds
    buffer_load_dwordx4 v3, s[12:15], s20 offen offset:3072 sc1 lds
    s_waitcnt vmcnt(0)
    s_mov_b64 exec, 1
    ds_add_u32 v17, v22 offset:2240
    s_mov_b64 exec, -1
    s_cmp_lg_u32 s28, 0
    s_cbranch_scc1 g_no2
    buffer_load_dwordx4 v[136:139], v4, s[4:7], s47 offen offset:0
    buffer_load_dwordx4 v[140:143], v4, s[4:7], s47 offen offset:64
g_no2:
    buffer_load_dwordx4 v[128:131], v4, s[8:11], s46 offen offset:0
    buffer_load_dwordx4 v[132:135], v4, s[8:11], s46 offen offset:64
    buffer_store_dwordx4 v[64:67], v3, s[12:15], s90 offen offset:0 sc1
    buffer_store_dwordx4 v[68:71], v3, s[12:15], s90 offen offset:1024 sc1
    buffer_store_dwordx4 v[80:83], v3, s[12:15], s90 offen offset:2048 sc1
    buffer_store_dwordx4 v[84:87], v3, s[12:15], s90 offen offset:3072 sc1
    buffer_store_dwordx4 v[96:99], v3, s[12:15], s91 offen offset:0 sc1
    buffer_store_dwordx4 v[100:103], v3, s[12:15], s91 offen offset:1024 sc1
    s_waitcnt vmcnt(6)
    ds_write_b128 v2, v[128:131]
    ds_write_b128 v2, v[132:135] offset:1024
    ds_read_b64_tr_b16 v[128:129], v7 offset:0
    ds_read_b64_tr_b16 v[130:131], v7 offset:512
    ds_read_b64_tr_b16 v[132:133], v7 offset:1024
    ds_read_b64_tr_b16 v[134:135], v7 offset:1536
    s_add_u32 s20, s48, 147456
    s_waitcnt lgkmcnt(2)
    buffer_store_dwordx4 v[128:131], v3, s[12:15], s48 offen sc1
    s_waitcnt lgkmcnt(0)
    buffer_store_dwordx4 v[132:135], v3, s[12:15], s20 offen sc1
    s_cmp_ge_u32 s32, 8
    s_cbranch_scc1 g_hst
    buffer_store_dwordx4 v[112:115], v3, s[12:15], s91 offen offset:2048 sc1
    buffer_store_dwordx4 v[116:119], v3, s[12:15], s91 offen offset:3072 sc1
    s_cmp_lg_u32 s32, s30
    s_cbranch_scc1 g_nogate
    v_lshlrev_b32 v8, 2, v5
    v_add_u32 v9, 143872, v8
    ds_read_b32 v9, v9
    s_lshl_b32 s20, s34, 7
    s_add_u32 s20, s20, 15736832
    s_mov_b32 exec_hi, 0
    s_waitcnt lgkmcnt(0)
    buffer_store_dword v9, v8, s[12:15], s20 offen sc1
    s_mov_b64 exec, -1
g_nogate:
    s_cmp_lg_u32 s28, 0
    s_cbranch_scc1 g_hst
    ds_write_b128 v2, v[136:139]
    ds_write_b128 v2, v[140:143] offset:1024
    ds_read_b64_tr_b16 v[136:137], v7 offset:0
    ds_read_b64_tr_b16 v[138:139], v7 offset:512
    ds_read_b64_tr_b16 v[140:141], v7 offset:1024
    ds_read_b64_tr_b16 v[142:143], v7 offset:1536
    s_add_u32 s20, s49, 147456
    s_waitcnt lgkmcnt(2)
    buffer_store_dwordx4 v[136:139], v3, s[12:15], s49 offen sc1
    s_waitcnt lgkmcnt(0)
    buffer_store_dwordx4 v[140:143], v3, s[12:15], s20 offen sc1
g_hst:
    v_mov_b64 v[152:153], -1
    v_mov_b64 v[154:155], -1
    s_add_u32 s20, s42, 32768
    buffer_store_dwordx4 v[152:155], v3, s[12:15], s42 offen sc1
    buffer_store_dwordx4 v[152:155], v3, s[12:15], s20 offen sc1
    s_add_u32 s21, s41, 1
    s_and_b32 s21, s21, 15
    s_lshl_b32 s21, s21, 12
    s_add_u32 s21, s21, s22
    s_add_u32 m0, s43, 0
    s_add_u32 s20, s21, 0
    buffer_load_dwordx4 v3, s[12:15], s20 offen offset:0 sc1 lds
    buffer_load_dwordx4 v3, s[12:15], s20 offen offset:1024 sc1 lds
    buffer_load_dwordx4 v3, s[12:15], s20 offen offset:2048 sc1 lds
    buffer_load_dwordx4 v3, s[12:15], s20 offen offset:3072 sc1 lds
    s_add_u32 m0, s43, 4096
    s_add_u32 s20, s21, 65536
    buffer_load_dwordx4 v3, s[12:15], s20 offen offset:0 sc1 lds
    buffer_load_dwordx4 v3, s[12:15], s20 offen offset:1024 sc1 lds
    buffer_load_dwordx4 v3, s[12:15], s20 offen offset:2048 sc1 lds
    buffer_load_dwordx4 v3, s[12:15], s20 offen offset:3072 sc1 lds
    s_add_u32 s21, s41, 2
    s_and_b32 s21, s21, 15
    s_lshl_b32 s21, s21, 12
    s_add_u32 s21, s21, s22
    s_add_u32 m0, s43, 8192
    s_add_u32 s20, s21, 0
    buffer_load_dwordx4 v3, s[12:15], s20 offen offset:0 sc1 lds
    buffer_load_dwordx4 v3, s[12:15], s20 offen offset:1024 sc1 lds
    buffer_load_dwordx4 v3, s[12:15], s20 offen offset:2048 sc1 lds
    buffer_load_dwordx4 v3, s[12:15], s20 offen offset:3072 sc1 lds
    s_add_u32 m0, s43, 12288
    s_add_u32 s20, s21, 65536
    buffer_load_dwordx4 v3, s[12:15], s20 offen offset:0 sc1 lds
    buffer_load_dwordx4 v3, s[12:15], s20 offen offset:1024 sc1 lds
    buffer_load_dwordx4 v3, s[12:15], s20 offen offset:2048 sc1 lds
    buffer_load_dwordx4 v3, s[12:15], s20 offen offset:3072 sc1 lds
    s_waitcnt vmcnt(16)
    s_mov_b64 exec, 1
    ds_add_rtn_u32 v10, v17, v22 offset:60
    s_waitcnt lgkmcnt(0)
    v_readfirstlane_b32 s20, v10
    s_nop 3
    s_cmp_lg_u32 s20, 3
    s_cbranch_scc1 g_nohpub
    s_mov_b64 exec, 0xff
    v_lshlrev_b32 v10, 11, v1
    buffer_atomic_add v22, v10, s[12:15], s36 offen sc1
g_nohpub:
    s_mov_b64 exec, -1
    s_setprio 0
    s_mov_b32 s16, s54
    s_and_b32 s17, s55, 0xffff
    s_mov_b32 s18, 1024
    s_mov_b32 s19, 0x00020000
    s_mov_b32 s24, s58
    s_and_b32 s25, s59, 0xffff
    s_mov_b32 s26, 2097152
    s_mov_b32 s27, 0x00020000
    s_lshl_b32 s31, s28, 2
    s_lshr_b32 s20, s29, 3
    s_add_u32 s31, s31, s20
    s_and_b32 s32, s29, 7
    s_and_b32 s38, s30, 1
    s_lshr_b32 s39, s30, 1
    s_lshl_b32 s41, s31, 1
    s_add_u32 s41, s41, s38
    s_xor_b32 s42, s41, 1
    s_lshl_b32 s40, s32, 1
    s_add_u32 s40, s40, s39
    s_xor_b32 s43, s40, 1
    s_mul_i32 s21, s30, 28
    s_lshl_b32 s20, s21, 10
    s_add_u32 s20, s20, 32768
    s_lshl_b32 s36, s39, 14
    s_mul_i32 s98, s40, 147456
    s_add_u32 s98, s98, 15990784
    s_add_u32 s33, s98, s20
    s_add_u32 s98, s98, s36
    s_mul_i32 s99, s43, 147456
    s_add_u32 s99, s99, 15990784
    s_add_u32 s35, s99, s20
    s_add_u32 s99, s99, s36
    s_mul_i32 s22, s41, 112
    s_add_u32 s22, s22, s21
    s_lshl_b32 s22, s22, 10
    s_add_u32 s22, s22, 8388608
    s_mul_i32 s23, s42, 112
    s_add_u32 s23, s23, s21
    s_lshl_b32 s23, s23, 10
    s_add_u32 s23, s23, 8388608
    s_lshl_b32 s21, s41, 5
    s_lshl_b32 s20, s39, 4
    s_add_u32 s21, s21, s20
    s_lshl_b32 s21, s21, 10
    s_add_u32 s21, s21, 6291456
    s_sub_u32 s98, s98, s21
    s_sub_u32 s99, s99, s21
    s_add_u32 s20, s32, 0
    s_and_b32 s20, s20, 7
    s_lshl_b32 s20, s20, 11
    s_add_u32 s44, s21, s20
    s_add_u32 s20, s32, 1
    s_and_b32 s20, s20, 7
    s_lshl_b32 s20, s20, 11
    s_add_u32 s45, s21, s20
    s_add_u32 s20, s32, 2
    s_and_b32 s20, s20, 7
    s_lshl_b32 s20, s20, 11
    s_add_u32 s46, s21, s20
    s_add_u32 s20, s32, 3
    s_and_b32 s20, s20, 7
    s_lshl_b32 s20, s20, 11
    s_add_u32 s47, s21, s20
    s_add_u32 s20, s32, 4
    s_and_b32 s20, s20, 7
    s_lshl_b32 s20, s20, 11
    s_add_u32 s50, s21, s20
    s_add_u32 s20, s32, 5
    s_and_b32 s20, s20, 7
    s_lshl_b32 s20, s20, 11
    s_add_u32 s51, s21, s20
    s_add_u32 s20, s32, 6
    s_and_b32 s20, s20, 7
    s_lshl_b32 s20, s20, 11
    s_add_u32 s52, s21, s20
    s_add_u32 s20, s32, 7
    s_and_b32 s20, s20, 7
    s_lshl_b32 s20, s20, 11
    s_add_u32 s53, s21, s20
    s_lshl_b32 s34, s40, 6
    s_lshl_b32 s36, s41, 7
    s_add_u32 s36, s36, 15736832
    s_lshl_b32 s48, s30, 2
    s_add_u32 s48, s48, 143376
    s_lshl_b32 s49, s41, 15
    s_add_u32 s49, s49, s34
    s_sub_u32 s37, 56623104, s3
    v_lshlrev_b32 v9, 1, v5
    buffer_load_ushort v100, v9, s[16:19], s34 offen
    v_lshlrev_b32 v8, 2, v5
    v_cmp_eq_u32 vcc, 0, v6
    v_mov_b32 v97, 0x3f80
    v_cndmask_b32 v96, 0, v97, vcc
    v_mov_b32 v97, 0
    v_mov_b64 v[98:99], 0
    v_mov_b32 v101, 0
    v_mov_b64 v[102:103], 0
    s_waitcnt vmcnt(0)
    s_mov_b64 exec, 1
    ds_add_u32 v17, v22 offset:2256
    s_mov_b64 exec, -1
    v_mfma_f32_32x32x16_bf16 v[80:95], v[100:103], v[96:99], 0
    v_mov_b32 v13, s48
    v_xor_b32 v106, 4, v13
    v_xor_b32 v107, 0x1000, v2
    v_mov_b32 v108, 1
    v_mov_b32 v109, 2
    v_mov_b32 v12, 3
    v_xor_b32 v4, 8, v13
    v_xor_b32 v7, 0x2000, v2
    v_mov_b32 v15, 143360
    v_lshlrev_b32 v5, 10, v5
    v_lshl_add_u32 v5, v6, 4, v5
    s_mov_b32 s96, 0
g_hw_ld:
    buffer_load_dword v9, v14, s[12:15], s37 offen sc1
    s_waitcnt vmcnt(0)
g_hw_chk:
    v_cmp_ne_u32 vcc, 16, v9
    s_nop 4
    s_cbranch_vccz g_hw_ok
    s_add_u32 s96, s96, 1
    s_cmp_gt_u32 s96, 32768
    s_cbranch_scc1 g_hw_ok
    s_sleep 24
    s_branch g_hw_ld
g_hw_ok:
    buffer_load_dwordx4 v[128:131], v3, s[12:15], s33 offen offset:0 sc1
    buffer_load_dwordx4 v[132:135], v3, s[12:15], s35 offen offset:0 sc1
    buffer_load_dwordx4 v[136:139], v3, s[12:15], s22 offen offset:0 sc1
    buffer_load_dwordx4 v[140:143], v3, s[12:15], s23 offen offset:0 sc1
    buffer_load_dwordx4 v[144:147], v3, s[12:15], s33 offen offset:1024 sc1
    buffer_load_dwordx4 v[148:151], v3, s[12:15], s35 offen offset:1024 sc1
    buffer_load_dwordx4 v[152:155], v3, s[12:15], s22 offen offset:1024 sc1
    buffer_load_dwordx4 v[156:159], v3, s[12:15], s23 offen offset:1024 sc1
    buffer_load_dwordx4 v[160:163], v3, s[12:15], s33 offen offset:2048 sc1
    buffer_load_dwordx4 v[164:167], v3, s[12:15], s35 offen offset:2048 sc1
    buffer_load_dwordx4 v[168:171], v3, s[12:15], s22 offen offset:2048 sc1
    buffer_load_dwordx4 v[172:175], v3, s[12:15], s23 offen offset:2048 sc1
    buffer_load_dwordx4 v[176:179], v3, s[12:15], s33 offen offset:3072 sc1
    buffer_load_dwordx4 v[180:183], v3, s[12:15], s35 offen offset:3072 sc1
    s_add_u32 s33, s33, 4096
    s_add_u32 s35, s35, 4096
    buffer_load_dwordx4 v[184:187], v3, s[12:15], s22 offen offset:3072 sc1
    buffer_load_dwordx4 v[188:191], v3, s[12:15], s23 offen offset:3072 sc1
    s_add_u32 s22, s22, 4096
    s_add_u32 s23, s23, 4096
    buffer_load_dwordx4 v[192:195], v3, s[12:15], s33 offen offset:0 sc1
    buffer_load_dwordx4 v[196:199], v3, s[12:15], s35 offen offset:0 sc1
    buffer_load_dwordx4 v[200:203], v3, s[12:15], s22 offen offset:0 sc1
    buffer_load_dwordx4 v[204:207], v3, s[12:15], s23 offen offset:0 sc1
    buffer_load_dwordx4 v[208:211], v3, s[12:15], s33 offen offset:1024 sc1
    buffer_load_dwordx4 v[212:215], v3, s[12:15], s35 offen offset:1024 sc1
    buffer_load_dwordx4 v[216:219], v3, s[12:15], s22 offen offset:1024 sc1
    buffer_load_dwordx4 v[220:223], v3, s[12:15], s23 offen offset:1024 sc1
    buffer_load_dwordx4 v[224:227], v3, s[12:15], s33 offen offset:2048 sc1
    buffer_load_dwordx4 v[228:231], v3, s[12:15], s35 offen offset:2048 sc1
    buffer_load_dwordx4 v[232:235], v3, s[12:15], s22 offen offset:2048 sc1
    buffer_load_dwordx4 v[236:239], v3, s[12:15], s23 offen offset:2048 sc1
    s_add_u32 s20, s98, s53
    buffer_load_dwordx4 v[240:243], v3, s[12:15], s20 offen offset:0 sc1
    s_add_u32 s20, s99, s53
    buffer_load_dwordx4 v[244:247], v3, s[12:15], s20 offen offset:0 sc1
    s_add_u32 s20, s98, s53
    buffer_load_dwordx4 v[248:251], v3, s[12:15], s20 offen offset:1024 sc1
    s_add_u32 s20, s99, s53
    buffer_load_dwordx4 v[252:255], v3, s[12:15], s20 offen offset:1024 sc1
    buffer_load_dword v10, v8, s[12:15], s36 offen sc1
    s_waitcnt vmcnt(29)
    v_mfma_f32_32x32x16_bf16 v[16:31], v[128:131], v[136:139], v[80:95]
    v_mfma_f32_32x32x16_bf16 v[32:47], v[128:131], v[140:143], 0
    v_mfma_f32_32x32x16_bf16 v[48:63], v[132:135], v[136:139], 0
    v_mfma_f32_32x32x16_bf16 v[64:79], v[132:135], v[140:143], 0
    buffer_load_dwordx4 v[128:131], v3, s[12:15], s33 offen offset:3072 sc1
    buffer_load_dwordx4 v[132:135], v3, s[12:15], s35 offen offset:3072 sc1
    s_add_u32 s33, s33, 4096
    s_add_u32 s35, s35, 4096
    buffer_load_dwordx4 v[136:139], v3, s[12:15], s22 offen offset:3072 sc1
    buffer_load_dwordx4 v[140:143], v3, s[12:15], s23 offen offset:3072 sc1
    s_add_u32 s22, s22, 4096
    s_add_u32 s23, s23, 4096
    s_waitcnt vmcnt(29)
    v_mfma_f32_32x32x16_bf16 v[16:31], v[144:147], v[152:155], v[16:31]
    v_mfma_f32_32x32x16_bf16 v[32:47], v[144:147], v[156:159], v[32:47]
    v_mfma_f32_32x32x16_bf16 v[48:63], v[148:151], v[152:155], v[48:63]
    v_mfma_f32_32x32x16_bf16 v[64:79], v[148:151], v[156:159], v[64:79]
    buffer_load_dwordx4 v[144:147], v3, s[12:15], s33 offen offset:0 sc1
    buffer_load_dwordx4 v[148:151], v3, s[12:15], s35 offen offset:0 sc1
    buffer_load_dwordx4 v[152:155], v3, s[12:15], s22 offen offset:0 sc1
    buffer_load_dwordx4 v[156:159], v3, s[12:15], s23 offen offset:0 sc1
    s_waitcnt vmcnt(29)
    v_mfma_f32_32x32x16_bf16 v[16:31], v[160:163], v[168:171], v[16:31]
    v_mfma_f32_32x32x16_bf16 v[32:47], v[160:163], v[172:175], v[32:47]
    v_mfma_f32_32x32x16_bf16 v[48:63], v[164:167], v[168:171], v[48:63]
    v_mfma_f32_32x32x16_bf16 v[64:79], v[164:167], v[172:175], v[64:79]
    buffer_load_dwordx4 v[160:163], v3, s[12:15], s33 offen offset:1024 sc1
    buffer_load_dwordx4 v[164:167], v3, s[12:15], s35 offen offset:1024 sc1
    buffer_load_dwordx4 v[168:171], v3, s[12:15], s22 offen offset:1024 sc1
    buffer_load_dwordx4 v[172:175], v3, s[12:15], s23 offen offset:1024 sc1
    s_waitcnt vmcnt(29)
    v_mfma_f32_32x32x16_bf16 v[16:31], v[176:179], v[184:187], v[16:31]
    v_mfma_f32_32x32x16_bf16 v[32:47], v[176:179], v[188:191], v[32:47]
    v_mfma_f32_32x32x16_bf16 v[48:63], v[180:183], v[184:187], v[48:63]
    v_mfma_f32_32x32x16_bf16 v[64:79], v[180:183], v[188:191], v[64:79]
    buffer_load_dwordx4 v[176:179], v3, s[12:15], s33 offen offset:2048 sc1
    buffer_load_dwordx4 v[180:183], v3, s[12:15], s35 offen offset:2048 sc1
    buffer_load_dwordx4 v[184:187], v3, s[12:15], s22 offen offset:2048 sc1
    buffer_load_dwordx4 v[188:191], v3, s[12:15], s23 offen offset:2048 sc1
    s_waitcnt vmcnt(29)
    v_mfma_f32_32x32x16_bf16 v[16:31], v[192:195], v[200:203], v[16:31]
    v_mfma_f32_32x32x16_bf16 v[32:47], v[192:195], v[204:207], v[32:47]
    v_mfma_f32_32x32x16_bf16 v[48:63], v[196:199], v[200:203], v[48:63]
    v_mfma_f32_32x32x16_bf16 v[64:79], v[196:199], v[204:207], v[64:79]
    buffer_load_dwordx4 v[192:195], v3, s[12:15], s33 offen offset:3072 sc1
    buffer_load_dwordx4 v[196:199], v3, s[12:15], s35 offen offset:3072 sc1
    s_add_u32 s33, s33, 4096
    s_add_u32 s35, s35, 4096
    buffer_load_dwordx4 v[200:203], v3, s[12:15], s22 offen offset:3072 sc1
    buffer_load_dwordx4 v[204:207], v3, s[12:15], s23 offen offset:3072 sc1
    s_add_u32 s22, s22, 4096
    s_add_u32 s23, s23, 4096
    s_waitcnt vmcnt(29)
    v_mfma_f32_32x32x16_bf16 v[16:31], v[208:211], v[216:219], v[16:31]
    v_mfma_f32_32x32x16_bf16 v[32:47], v[208:211], v[220:223], v[32:47]
    v_mfma_f32_32x32x16_bf16 v[48:63], v[212:215], v[216:219], v[48:63]
    v_mfma_f32_32x32x16_bf16 v[64:79], v[212:215], v[220:223], v[64:79]
    buffer_load_dwordx4 v[208:211], v3, s[12:15], s33 offen offset:0 sc1
    buffer_load_dwordx4 v[212:215], v3, s[12:15], s35 offen offset:0 sc1
    buffer_load_dwordx4 v[216:219], v3, s[12:15], s22 offen offset:0 sc1
    buffer_load_dwordx4 v[220:223], v3, s[12:15], s23 offen offset:0 sc1
    s_waitcnt vmcnt(29)
    v_mfma_f32_32x32x16_bf16 v[16:31], v[224:227], v[232:235], v[16:31]
    v_mfma_f32_32x32x16_bf16 v[32:47], v[224:227], v[236:239], v[32:47]
    v_mfma_f32_32x32x16_bf16 v[48:63], v[228:231], v[232:235], v[48:63]
    v_mfma_f32_32x32x16_bf16 v[64:79], v[228:231], v[236:239], v[64:79]
    buffer_load_dwordx4 v[224:227], v3, s[12:15], s33 offen offset:1024 sc1
    buffer_load_dwordx4 v[228:231], v3, s[12:15], s35 offen offset:1024 sc1
    buffer_load_dwordx4 v[232:235], v3, s[12:15], s22 offen offset:1024 sc1
    buffer_load_dwordx4 v[236:239], v3, s[12:15], s23 offen offset:1024 sc1
    s_waitcnt vmcnt(24)
    v_mfma_f32_32x32x16_bf16 v[16:31], v[128:131], v[136:139], v[16:31]
    v_mfma_f32_32x32x16_bf16 v[32:47], v[128:131], v[140:143], v[32:47]
    v_mfma_f32_32x32x16_bf16 v[48:63], v[132:135], v[136:139], v[48:63]
    v_mfma_f32_32x32x16_bf16 v[64:79], v[132:135], v[140:143], v[64:79]
    buffer_load_dwordx4 v[128:131], v3, s[12:15], s33 offen offset:2048 sc1
    buffer_load_dwordx4 v[132:135], v3, s[12:15], s35 offen offset:2048 sc1
    buffer_load_dwordx4 v[136:139], v3, s[12:15], s22 offen offset:2048 sc1
    buffer_load_dwordx4 v[140:143], v3, s[12:15], s23 offen offset:2048 sc1
    s_waitcnt vmcnt(24)
    v_mfma_f32_32x32x16_bf16 v[16:31], v[144:147], v[152:155], v[16:31]
    v_mfma_f32_32x32x16_bf16 v[32:47], v[144:147], v[156:159], v[32:47]
    v_mfma_f32_32x32x16_bf16 v[48:63], v[148:151], v[152:155], v[48:63]
    v_mfma_f32_32x32x16_bf16 v[64:79], v[148:151], v[156:159], v[64:79]
    buffer_load_dwordx4 v[144:147], v3, s[12:15], s33 offen offset:3072 sc1
    buffer_load_dwordx4 v[148:151], v3, s[12:15], s35 offen offset:3072 sc1
    s_add_u32 s33, s33, 4096
    s_add_u32 s35, s35, 4096
    buffer_load_dwordx4 v[152:155], v3, s[12:15], s22 offen offset:3072 sc1
    buffer_load_dwordx4 v[156:159], v3, s[12:15], s23 offen offset:3072 sc1
    s_add_u32 s22, s22, 4096
    s_add_u32 s23, s23, 4096
    s_waitcnt vmcnt(24)
    v_mfma_f32_32x32x16_bf16 v[16:31], v[160:163], v[168:171], v[16:31]
    v_mfma_f32_32x32x16_bf16 v[32:47], v[160:163], v[172:175], v[32:47]
    v_mfma_f32_32x32x16_bf16 v[48:63], v[164:167], v[168:171], v[48:63]
    v_mfma_f32_32x32x16_bf16 v[64:79], v[164:167], v[172:175], v[64:79]
    buffer_load_dwordx4 v[160:163], v3, s[12:15], s33 offen offset:0 sc1
    buffer_load_dwordx4 v[164:167], v3, s[12:15], s35 offen offset:0 sc1
    buffer_load_dwordx4 v[168:171], v3, s[12:15], s22 offen offset:0 sc1
    buffer_load_dwordx4 v[172:175], v3, s[12:15], s23 offen offset:0 sc1
    s_waitcnt vmcnt(24)
    v_mfma_f32_32x32x16_bf16 v[16:31], v[176:179], v[184:187], v[16:31]
    v_mfma_f32_32x32x16_bf16 v[32:47], v[176:179], v[188:191], v[32:47]
    v_mfma_f32_32x32x16_bf16 v[48:63], v[180:183], v[184:187], v[48:63]
    v_mfma_f32_32x32x16_bf16 v[64:79], v[180:183], v[188:191], v[64:79]
    buffer_load_dwordx4 v[176:179], v3, s[12:15], s33 offen offset:1024 sc1
    buffer_load_dwordx4 v[180:183], v3, s[12:15], s35 offen offset:1024 sc1
    buffer_load_dwordx4 v[184:187], v3, s[12:15], s22 offen offset:1024 sc1
    buffer_load_dwordx4 v[188:191], v3, s[12:15], s23 offen offset:1024 sc1
    s_waitcnt vmcnt(24)
    v_mfma_f32_32x32x16_bf16 v[16:31], v[192:195], v[200:203], v[16:31]
    v_mfma_f32_32x32x16_bf16 v[32:47], v[192:195], v[204:207], v[32:47]
    v_mfma_f32_32x32x16_bf16 v[48:63], v[196:199], v[200:203], v[48:63]
    v_mfma_f32_32x32x16_bf16 v[64:79], v[196:199], v[204:207], v[64:79]
    buffer_load_dwordx4 v[192:195], v3, s[12:15], s33 offen offset:2048 sc1
    buffer_load_dwordx4 v[196:199], v3, s[12:15], s35 offen offset:2048 sc1
    buffer_load_dwordx4 v[200:203], v3, s[12:15], s22 offen offset:2048 sc1
    buffer_load_dwordx4 v[204:207], v3, s[12:15], s23 offen offset:2048 sc1
    s_waitcnt vmcnt(24)
    v_mfma_f32_32x32x16_bf16 v[16:31], v[208:211], v[216:219], v[16:31]
    v_mfma_f32_32x32x16_bf16 v[32:47], v[208:211], v[220:223], v[32:47]
    v_mfma_f32_32x32x16_bf16 v[48:63], v[212:215], v[216:219], v[48:63]
    v_mfma_f32_32x32x16_bf16 v[64:79], v[212:215], v[220:223], v[64:79]
    buffer_load_dwordx4 v[208:211], v3, s[12:15], s33 offen offset:3072 sc1
    buffer_load_dwordx4 v[212:215], v3, s[12:15], s35 offen offset:3072 sc1
    s_add_u32 s33, s33, 4096
    s_add_u32 s35, s35, 4096
    buffer_load_dwordx4 v[216:219], v3, s[12:15], s22 offen offset:3072 sc1
    buffer_load_dwordx4 v[220:223], v3, s[12:15], s23 offen offset:3072 sc1
    s_add_u32 s22, s22, 4096
    s_add_u32 s23, s23, 4096
    s_waitcnt vmcnt(24)
    v_mfma_f32_32x32x16_bf16 v[16:31], v[224:227], v[232:235], v[16:31]
    v_mfma_f32_32x32x16_bf16 v[32:47], v[224:227], v[236:239], v[32:47]
    v_mfma_f32_32x32x16_bf16 v[48:63], v[228:231], v[232:235], v[48:63]
    v_mfma_f32_32x32x16_bf16 v[64:79], v[228:231], v[236:239], v[64:79]
    buffer_load_dwordx4 v[224:227], v3, s[12:15], s33 offen offset:0 sc1
    buffer_load_dwordx4 v[228:231], v3, s[12:15], s35 offen offset:0 sc1
    buffer_load_dwordx4 v[232:235], v3, s[12:15], s22 offen offset:0 sc1
    buffer_load_dwordx4 v[236:239], v3, s[12:15], s23 offen offset:0 sc1
    s_waitcnt vmcnt(24)
    v_mfma_f32_32x32x16_bf16 v[16:31], v[128:131], v[136:139], v[16:31]
    v_mfma_f32_32x32x16_bf16 v[32:47], v[128:131], v[140:143], v[32:47]
    v_mfma_f32_32x32x16_bf16 v[48:63], v[132:135], v[136:139], v[48:63]
    v_mfma_f32_32x32x16_bf16 v[64:79], v[132:135], v[140:143], v[64:79]
    buffer_load_dwordx4 v[128:131], v3, s[12:15], s33 offen offset:1024 sc1
    buffer_load_dwordx4 v[132:135], v3, s[12:15], s35 offen offset:1024 sc1
    buffer_load_dwordx4 v[136:139], v3, s[12:15], s22 offen offset:1024 sc1
    buffer_load_dwordx4 v[140:143], v3, s[12:15], s23 offen offset:1024 sc1
    s_waitcnt vmcnt(24)
    v_mfma_f32_32x32x16_bf16 v[16:31], v[144:147], v[152:155], v[16:31]
    v_mfma_f32_32x32x16_bf16 v[32:47], v[144:147], v[156:159], v[32:47]
    v_mfma_f32_32x32x16_bf16 v[48:63], v[148:151], v[152:155], v[48:63]
    v_mfma_f32_32x32x16_bf16 v[64:79], v[148:151], v[156:159], v[64:79]
    buffer_load_dwordx4 v[144:147], v3, s[12:15], s33 offen offset:2048 sc1
    buffer_load_dwordx4 v[148:151], v3, s[12:15], s35 offen offset:2048 sc1
    buffer_load_dwordx4 v[152:155], v3, s[12:15], s22 offen offset:2048 sc1
    buffer_load_dwordx4 v[156:159], v3, s[12:15], s23 offen offset:2048 sc1
    s_waitcnt vmcnt(24)
    v_mfma_f32_32x32x16_bf16 v[16:31], v[160:163], v[168:171], v[16:31]
    v_mfma_f32_32x32x16_bf16 v[32:47], v[160:163], v[172:175], v[32:47]
    v_mfma_f32_32x32x16_bf16 v[48:63], v[164:167], v[168:171], v[48:63]
    v_mfma_f32_32x32x16_bf16 v[64:79], v[164:167], v[172:175], v[64:79]
    buffer_load_dwordx4 v[160:163], v3, s[12:15], s33 offen offset:3072 sc1
    buffer_load_dwordx4 v[164:167], v3, s[12:15], s35 offen offset:3072 sc1
    s_add_u32 s33, s33, 4096
    s_add_u32 s35, s35, 4096
    buffer_load_dwordx4 v[168:171], v3, s[12:15], s22 offen offset:3072 sc1
    buffer_load_dwordx4 v[172:175], v3, s[12:15], s23 offen offset:3072 sc1
    s_add_u32 s22, s22, 4096
    s_add_u32 s23, s23, 4096
    s_waitcnt vmcnt(24)
    v_mfma_f32_32x32x16_bf16 v[16:31], v[176:179], v[184:187], v[16:31]
    v_mfma_f32_32x32x16_bf16 v[32:47], v[176:179], v[188:191], v[32:47]
    v_mfma_f32_32x32x16_bf16 v[48:63], v[180:183], v[184:187], v[48:63]
    v_mfma_f32_32x32x16_bf16 v[64:79], v[180:183], v[188:191], v[64:79]
    buffer_load_dwordx4 v[176:179], v3, s[12:15], s33 offen offset:0 sc1
    buffer_load_dwordx4 v[180:183], v3, s[12:15], s35 offen offset:0 sc1
    buffer_load_dwordx4 v[184:187], v3, s[12:15], s22 offen offset:0 sc1
    buffer_load_dwordx4 v[188:191], v3, s[12:15], s23 offen offset:0 sc1
    s_waitcnt vmcnt(24)
    v_mfma_f32_32x32x16_bf16 v[16:31], v[192:195], v[200:203], v[16:31]
    v_mfma_f32_32x32x16_bf16 v[32:47], v[192:195], v[204:207], v[32:47]
    v_mfma_f32_32x32x16_bf16 v[48:63], v[196:199], v[200:203], v[48:63]
    v_mfma_f32_32x32x16_bf16 v[64:79], v[196:199], v[204:207], v[64:79]
    buffer_load_dwordx4 v[192:195], v3, s[12:15], s33 offen offset:1024 sc1
    buffer_load_dwordx4 v[196:199], v3, s[12:15], s35 offen offset:1024 sc1
    buffer_load_dwordx4 v[200:203], v3, s[12:15], s22 offen offset:1024 sc1
    buffer_load_dwordx4 v[204:207], v3, s[12:15], s23 offen offset:1024 sc1
    s_waitcnt vmcnt(24)
    v_mfma_f32_32x32x16_bf16 v[16:31], v[208:211], v[216:219], v[16:31]
    v_mfma_f32_32x32x16_bf16 v[32:47], v[208:211], v[220:223], v[32:47]
    v_mfma_f32_32x32x16_bf16 v[48:63], v[212:215], v[216:219], v[48:63]
    v_mfma_f32_32x32x16_bf16 v[64:79], v[212:215], v[220:223], v[64:79]
    buffer_load_dwordx4 v[208:211], v3, s[12:15], s33 offen offset:2048 sc1
    buffer_load_dwordx4 v[212:215], v3, s[12:15], s35 offen offset:2048 sc1
    buffer_load_dwordx4 v[216:219], v3, s[12:15], s22 offen offset:2048 sc1
    buffer_load_dwordx4 v[220:223], v3, s[12:15], s23 offen offset:2048 sc1
    s_waitcnt vmcnt(24)
    v_mfma_f32_32x32x16_bf16 v[16:31], v[224:227], v[232:235], v[16:31]
    v_mfma_f32_32x32x16_bf16 v[32:47], v[224:227], v[236:239], v[32:47]
    v_mfma_f32_32x32x16_bf16 v[48:63], v[228:231], v[232:235], v[48:63]
    v_mfma_f32_32x32x16_bf16 v[64:79], v[228:231], v[236:239], v[64:79]
    buffer_load_dwordx4 v[224:227], v3, s[12:15], s33 offen offset:3072 sc1
    buffer_load_dwordx4 v[228:231], v3, s[12:15], s35 offen offset:3072 sc1
    s_add_u32 s33, s33, 4096
    s_add_u32 s35, s35, 4096
    buffer_load_dwordx4 v[232:235], v3, s[12:15], s22 offen offset:3072 sc1
    buffer_load_dwordx4 v[236:239], v3, s[12:15], s23 offen offset:3072 sc1
    s_add_u32 s22, s22, 4096
    s_add_u32 s23, s23, 4096
    s_waitcnt vmcnt(24)
    v_mfma_f32_32x32x16_bf16 v[16:31], v[128:131], v[136:139], v[16:31]
    v_mfma_f32_32x32x16_bf16 v[32:47], v[128:131], v[140:143], v[32:47]
    v_mfma_f32_32x32x16_bf16 v[48:63], v[132:135], v[136:139], v[48:63]
    v_mfma_f32_32x32x16_bf16 v[64:79], v[132:135], v[140:143], v[64:79]
    s_add_u32 s20, s98, s44
    buffer_load_dwordx4 v[128:131], v3, s[12:15], s20 offen offset:0 sc1
    s_add_u32 s20, s99, s44
    buffer_load_dwordx4 v[132:135], v3, s[12:15], s20 offen offset:0 sc1
    s_add_u32 s20, s98, s44
    buffer_load_dwordx4 v[136:139], v3, s[12:15], s20 offen offset:1024 sc1
    s_add_u32 s20, s99, s44
    buffer_load_dwordx4 v[140:143], v3, s[12:15], s20 offen offset:1024 sc1
    s_waitcnt vmcnt(24)
    v_mfma_f32_32x32x16_bf16 v[16:31], v[144:147], v[152:155], v[16:31]
    v_mfma_f32_32x32x16_bf16 v[32:47], v[144:147], v[156:159], v[32:47]
    v_mfma_f32_32x32x16_bf16 v[48:63], v[148:151], v[152:155], v[48:63]
    v_mfma_f32_32x32x16_bf16 v[64:79], v[148:151], v[156:159], v[64:79]
    s_add_u32 s20, s98, s45
    buffer_load_dwordx4 v[144:147], v3, s[12:15], s20 offen offset:0 sc1
    s_add_u32 s20, s99, s45
    buffer_load_dwordx4 v[148:151], v3, s[12:15], s20 offen offset:0 sc1
    s_add_u32 s20, s98, s45
    buffer_load_dwordx4 v[152:155], v3, s[12:15], s20 offen offset:1024 sc1
    s_add_u32 s20, s99, s45
    buffer_load_dwordx4 v[156:159], v3, s[12:15], s20 offen offset:1024 sc1
    s_waitcnt vmcnt(24)
    v_mfma_f32_32x32x16_bf16 v[16:31], v[160:163], v[168:171], v[16:31]
    v_mfma_f32_32x32x16_bf16 v[32:47], v[160:163], v[172:175], v[32:47]
    v_mfma_f32_32x32x16_bf16 v[48:63], v[164:167], v[168:171], v[48:63]
    v_mfma_f32_32x32x16_bf16 v[64:79], v[164:167], v[172:175], v[64:79]
    s_add_u32 s20, s98, s46
    buffer_load_dwordx4 v[160:163], v3, s[12:15], s20 offen offset:0 sc1
    s_add_u32 s20, s99, s46
    buffer_load_dwordx4 v[164:167], v3, s[12:15], s20 offen offset:0 sc1
    s_add_u32 s20, s98, s46
    buffer_load_dwordx4 v[168:171], v3, s[12:15], s20 offen offset:1024 sc1
    s_add_u32 s20, s99, s46
    buffer_load_dwordx4 v[172:175], v3, s[12:15], s20 offen offset:1024 sc1
    s_waitcnt vmcnt(24)
    v_mfma_f32_32x32x16_bf16 v[16:31], v[176:179], v[184:187], v[16:31]
    v_mfma_f32_32x32x16_bf16 v[32:47], v[176:179], v[188:191], v[32:47]
    v_mfma_f32_32x32x16_bf16 v[48:63], v[180:183], v[184:187], v[48:63]
    v_mfma_f32_32x32x16_bf16 v[64:79], v[180:183], v[188:191], v[64:79]
    s_add_u32 s20, s98, s47
    buffer_load_dwordx4 v[176:179], v3, s[12:15], s20 offen offset:0 sc1
    s_add_u32 s20, s99, s47
    buffer_load_dwordx4 v[180:183], v3, s[12:15], s20 offen offset:0 sc1
    s_add_u32 s20, s98, s47
    buffer_load_dwordx4 v[184:187], v3, s[12:15], s20 offen offset:1024 sc1
    s_add_u32 s20, s99, s47
    buffer_load_dwordx4 v[188:191], v3, s[12:15], s20 offen offset:1024 sc1
    s_waitcnt vmcnt(24)
    v_mfma_f32_32x32x16_bf16 v[16:31], v[192:195], v[200:203], v[16:31]
    v_mfma_f32_32x32x16_bf16 v[32:47], v[192:195], v[204:207], v[32:47]
    v_mfma_f32_32x32x16_bf16 v[48:63], v[196:199], v[200:203], v[48:63]
    v_mfma_f32_32x32x16_bf16 v[64:79], v[196:199], v[204:207], v[64:79]
    s_add_u32 s20, s98, s50
    buffer_load_dwordx4 v[192:195], v3, s[12:15], s20 offen offset:0 sc1
    s_add_u32 s20, s99, s50
    buffer_load_dwordx4 v[196:199], v3, s[12:15], s20 offen offset:0 sc1
    s_add_u32 s20, s98, s50
    buffer_load_dwordx4 v[200:203], v3, s[12:15], s20 offen offset:1024 sc1
    s_add_u32 s20, s99, s50
    buffer_load_dwordx4 v[204:207], v3, s[12:15], s20 offen offset:1024 sc1
    s_waitcnt vmcnt(24)
    v_mfma_f32_32x32x16_bf16 v[16:31], v[208:211], v[216:219], v[16:31]
    v_mfma_f32_32x32x16_bf16 v[32:47], v[208:211], v[220:223], v[32:47]
    v_mfma_f32_32x32x16_bf16 v[48:63], v[212:215], v[216:219], v[48:63]
    v_mfma_f32_32x32x16_bf16 v[64:79], v[212:215], v[220:223], v[64:79]
    s_add_u32 s20, s98, s51
    buffer_load_dwordx4 v[208:211], v3, s[12:15], s20 offen offset:0 sc1
    s_add_u32 s20, s99, s51
    buffer_load_dwordx4 v[212:215], v3, s[12:15], s20 offen offset:0 sc1
    s_add_u32 s20, s98, s51
    buffer_load_dwordx4 v[216:219], v3, s[12:15], s20 offen offset:1024 sc1
    s_add_u32 s20, s99, s51
    buffer_load_dwordx4 v[220:223], v3, s[12:15], s20 offen offset:1024 sc1
    s_waitcnt vmcnt(24)
    v_mfma_f32_32x32x16_bf16 v[16:31], v[224:227], v[232:235], v[16:31]
    v_mfma_f32_32x32x16_bf16 v[32:47], v[224:227], v[236:239], v[32:47]
    v_mfma_f32_32x32x16_bf16 v[48:63], v[228:231], v[232:235], v[48:63]
    v_mfma_f32_32x32x16_bf16 v[64:79], v[228:231], v[236:239], v[64:79]
    s_add_u32 s20, s98, s52
    buffer_load_dwordx4 v[224:227], v3, s[12:15], s20 offen offset:0 sc1
    s_add_u32 s20, s99, s52
    buffer_load_dwordx4 v[228:231], v3, s[12:15], s20 offen offset:0 sc1
    s_add_u32 s20, s98, s52
    buffer_load_dwordx4 v[232:235], v3, s[12:15], s20 offen offset:1024 sc1
    s_add_u32 s20, s99, s52
    buffer_load_dwordx4 v[236:239], v3, s[12:15], s20 offen offset:1024 sc1
    s_setprio 0
    v_max_f32 v10, 0xc2700000, v10
    v_mul_f32 v10, 0xbfb8aa3b, v10
    v_exp_f32 v104, v10
    s_nop 0
    v_add_f32 v10, 1.0, v104
    v_rcp_f32 v10, v10
    v_mov_b32 v105, v104
    v_mov_b32 v11, v10
    ds_write_b128 v2, v[32:35] offset:0
    ds_write_b128 v2, v[36:39] offset:1024
    ds_write_b128 v2, v[40:43] offset:2048
    ds_write_b128 v2, v[44:47] offset:3072
    s_waitcnt lgkmcnt(0)
    ds_write_b32 v13, v108
    s_mov_b32 s97, 0
g_r1f_ld:
    ds_read_b32 v9, v106
    s_waitcnt lgkmcnt(0)
    v_readfirstlane_b32 s20, v9
    s_nop 3
    s_cmp_ge_u32 s20, 1
    s_cbranch_scc1 g_r1f_ok
    s_add_u32 s97, s97, 1
    s_cmp_gt_u32 s97, 262144
    s_cbranch_scc1 g_r1f_ok
    s_sleep 1
    s_branch g_r1f_ld
g_r1f_ok:
    ds_read_b128 v[80:83], v107 offset:0
    ds_read_b128 v[84:87], v107 offset:1024
    ds_read_b128 v[88:91], v107 offset:2048
    ds_read_b128 v[92:95], v107 offset:3072
    s_waitcnt lgkmcnt(0)
    ds_write_b32 v106, v108 offset:16
    v_pk_add_f32 v[16:17], v[16:17], v[80:81]
    v_pk_add_f32 v[18:19], v[18:19], v[82:83]
    v_pk_add_f32 v[20:21], v[20:21], v[84:85]
    v_pk_add_f32 v[22:23], v[22:23], v[86:87]
    v_pk_add_f32 v[24:25], v[24:25], v[88:89]
    v_pk_add_f32 v[26:27], v[26:27], v[90:91]
    v_pk_add_f32 v[28:29], v[28:29], v[92:93]
    v_pk_add_f32 v[30:31], v[30:31], v[94:95]
    s_mov_b32 s97, 0
g_r2a_ld:
    ds_read_b32 v9, v13 offset:16
    s_waitcnt lgkmcnt(0)
    v_readfirstlane_b32 s20, v9
    s_nop 3
    s_cmp_ge_u32 s20, 1
    s_cbranch_scc1 g_r2a_ok
    s_add_u32 s97, s97, 1
    s_cmp_gt_u32 s97, 262144
    s_cbranch_scc1 g_r2a_ok
    s_sleep 1
    s_branch g_r2a_ld
g_r2a_ok:
    ds_write_b128 v2, v[64:67] offset:0
    ds_write_b128 v2, v[68:71] offset:1024
    ds_write_b128 v2, v[72:75] offset:2048
    ds_write_b128 v2, v[76:79] offset:3072
    s_waitcnt lgkmcnt(0)
    ds_write_b32 v13, v109
    s_mov_b32 s97, 0
g_r2f_ld:
    ds_read_b32 v9, v106
    s_waitcnt lgkmcnt(0)
    v_readfirstlane_b32 s20, v9
    s_nop 3
    s_cmp_ge_u32 s20, 2
    s_cbranch_scc1 g_r2f_ok
    s_add_u32 s97, s97, 1
    s_cmp_gt_u32 s97, 262144
    s_cbranch_scc1 g_r2f_ok
    s_sleep 1
    s_branch g_r2f_ld
g_r2f_ok:
    ds_read_b128 v[80:83], v107 offset:0
    ds_read_b128 v[84:87], v107 offset:1024
    ds_read_b128 v[88:91], v107 offset:2048
    ds_read_b128 v[92:95], v107 offset:3072
    s_waitcnt lgkmcnt(0)
    ds_write_b32 v106, v109 offset:16
    v_pk_add_f32 v[48:49], v[48:49], v[80:81]
    v_pk_add_f32 v[50:51], v[50:51], v[82:83]
    v_pk_add_f32 v[52:53], v[52:53], v[84:85]
    v_pk_add_f32 v[54:55], v[54:55], v[86:87]
    v_pk_add_f32 v[56:57], v[56:57], v[88:89]
    v_pk_add_f32 v[58:59], v[58:59], v[90:91]
    v_pk_add_f32 v[60:61], v[60:61], v[92:93]
    v_pk_add_f32 v[62:63], v[62:63], v[94:95]
    v_pk_mul_f32 v[16:17], v[16:17], v[104:105]
    v_pk_mul_f32 v[18:19], v[18:19], v[104:105]
    v_pk_mul_f32 v[20:21], v[20:21], v[104:105]
    v_pk_mul_f32 v[22:23], v[22:23], v[104:105]
    v_pk_mul_f32 v[24:25], v[24:25], v[104:105]
    v_pk_mul_f32 v[26:27], v[26:27], v[104:105]
    v_pk_mul_f32 v[28:29], v[28:29], v[104:105]
    v_pk_mul_f32 v[30:31], v[30:31], v[104:105]
    v_pk_mul_f32 v[48:49], v[48:49], v[104:105]
    v_pk_mul_f32 v[50:51], v[50:51], v[104:105]
    v_pk_mul_f32 v[52:53], v[52:53], v[104:105]
    v_pk_mul_f32 v[54:55], v[54:55], v[104:105]
    v_pk_mul_f32 v[56:57], v[56:57], v[104:105]
    v_pk_mul_f32 v[58:59], v[58:59], v[104:105]
    v_pk_mul_f32 v[60:61], v[60:61], v[104:105]
    v_pk_mul_f32 v[62:63], v[62:63], v[104:105]
    s_setprio 0
    s_mov_b32 s97, 0
g_ak_ld:
    ds_read_b32 v9, v13 offset:16
    s_waitcnt lgkmcnt(0)
    v_readfirstlane_b32 s20, v9
    s_nop 3
    s_cmp_ge_u32 s20, 2
    s_cbranch_scc1 g_ak_ok
    s_add_u32 s97, s97, 1
    s_cmp_gt_u32 s97, 262144
    s_cbranch_scc1 g_ak_ok
    s_sleep 2
    s_branch g_ak_ld
g_ak_ok:
    s_mov_b32 s96, 0
    s_mov_b32 s37, 0xffff
    s_mov_b32 s97, 0
g_ad_ld:
    ds_read_b32 v9, v15 offset:48
    s_waitcnt lgkmcnt(0)
    v_readfirstlane_b32 s20, v9
    s_nop 3
    s_cmp_ge_u32 s20, 4
    s_cbranch_scc1 g_ad_ok
    s_add_u32 s97, s97, 1
    s_cmp_gt_u32 s97, 262144
    s_cbranch_scc1 g_ad_ok
    s_sleep 4
    s_branch g_ad_ld
g_ad_ok:
    buffer_load_dwordx4 v[64:67], v3, s[12:15], s44 offen offset:0 sc0 sc1
    buffer_load_dwordx4 v[68:71], v3, s[12:15], s44 offen offset:1024 sc0 sc1
    buffer_load_dwordx4 v[72:75], v3, s[12:15], s45 offen offset:0 sc0 sc1
    buffer_load_dwordx4 v[76:79], v3, s[12:15], s45 offen offset:1024 sc0 sc1
    buffer_load_dwordx4 v[80:83], v3, s[12:15], s46 offen offset:0 sc0 sc1
    buffer_load_dwordx4 v[84:87], v3, s[12:15], s46 offen offset:1024 sc0 sc1
    buffer_load_dwordx4 v[88:91], v3, s[12:15], s47 offen offset:0 sc0 sc1
    buffer_load_dwordx4 v[92:95], v3, s[12:15], s47 offen offset:1024 sc0 sc1
    buffer_load_dwordx4 v[96:99], v3, s[12:15], s50 offen offset:0 sc0 sc1
    buffer_load_dwordx4 v[100:103], v3, s[12:15], s50 offen offset:1024 sc0 sc1
    buffer_load_dwordx4 v[104:107], v3, s[12:15], s51 offen offset:0 sc0 sc1
    buffer_load_dwordx4 v[108:111], v3, s[12:15], s51 offen offset:1024 sc0 sc1
    buffer_load_dwordx4 v[112:115], v3, s[12:15], s52 offen offset:0 sc0 sc1
    buffer_load_dwordx4 v[116:119], v3, s[12:15], s52 offen offset:1024 sc0 sc1
    buffer_load_dwordx4 v[120:123], v3, s[12:15], s53 offen offset:0 sc0 sc1
    buffer_load_dwordx4 v[124:127], v3, s[12:15], s53 offen offset:1024 sc0 sc1
    s_mov_b32 s37, 0
    s_waitcnt vmcnt(14)
    v_max3_u32 v8, v64, v65, v66
    v_max3_u32 v9, v67, v68, v69
    v_max3_u32 v8, v8, v70, v71
    v_max_u32 v8, v8, v9
    v_cmp_eq_u32 s[80:81], -1, v8
    s_waitcnt vmcnt(12)
    v_max3_u32 v8, v72, v73, v74
    v_max3_u32 v9, v75, v76, v77
    v_max3_u32 v8, v8, v78, v79
    v_max_u32 v8, v8, v9
    v_cmp_eq_u32 s[82:83], -1, v8
    s_cmp_lg_u64 s[80:81], 0
    s_cbranch_scc1 g_pb0
    v_mfma_f32_32x32x16_bf16 v[48:63], v[132:135], v[64:67], v[48:63]
    v_mfma_f32_32x32x16_bf16 v[16:31], v[128:131], v[64:67], v[16:31]
    s_waitcnt vmcnt(10)
    v_max3_u32 v8, v80, v81, v82
    v_max3_u32 v9, v83, v84, v85
    v_max3_u32 v8, v8, v86, v87
    v_mfma_f32_32x32x16_bf16 v[48:63], v[140:143], v[68:71], v[48:63]
    v_max_u32 v8, v8, v9
    v_cmp_eq_u32 s[84:85], -1, v8
    v_mfma_f32_32x32x16_bf16 v[16:31], v[136:139], v[68:71], v[16:31]
g_pn0:
    s_cmp_lg_u64 s[82:83], 0
    s_cbranch_scc1 g_pb1
    v_mfma_f32_32x32x16_bf16 v[48:63], v[148:151], v[72:75], v[48:63]
    v_mfma_f32_32x32x16_bf16 v[16:31], v[144:147], v[72:75], v[16:31]
    s_waitcnt vmcnt(8)
    v_max3_u32 v8, v88, v89, v90
    v_max3_u32 v9, v91, v92, v93
    v_max3_u32 v8, v8, v94, v95
    v_mfma_f32_32x32x16_bf16 v[48:63], v[156:159], v[76:79], v[48:63]
    v_max_u32 v8, v8, v9
    v_cmp_eq_u32 s[86:87], -1, v8
    v_mfma_f32_32x32x16_bf16 v[16:31], v[152:155], v[76:79], v[16:31]
g_pn1:
    s_cmp_lg_u64 s[84:85], 0
    s_cbranch_scc1 g_pb2
    v_mfma_f32_32x32x16_bf16 v[48:63], v[164:167], v[80:83], v[48:63]
    v_mfma_f32_32x32x16_bf16 v[16:31], v[160:163], v[80:83], v[16:31]
    s_waitcnt vmcnt(6)
    v_max3_u32 v8, v96, v97, v98
    v_max3_u32 v9, v99, v100, v101
    v_max3_u32 v8, v8, v102, v103
    v_mfma_f32_32x32x16_bf16 v[48:63], v[172:175], v[84:87], v[48:63]
    v_max_u32 v8, v8, v9
    v_cmp_eq_u32 s[80:81], -1, v8
    v_mfma_f32_32x32x16_bf16 v[16:31], v[168:171], v[84:87], v[16:31]
g_pn2:
    s_cmp_lg_u64 s[86:87], 0
    s_cbranch_scc1 g_pb3
    v_mfma_f32_32x32x16_bf16 v[48:63], v[180:183], v[88:91], v[48:63]
    v_mfma_f32_32x32x16_bf16 v[16:31], v[176:179], v[88:91], v[16:31]
    s_waitcnt vmcnt(4)
    v_max3_u32 v8, v104, v105, v106
    v_max3_u32 v9, v107, v108, v109
    v_max3_u32 v8, v8, v110, v111
    v_mfma_f32_32x32x16_bf16 v[48:63], v[188:191], v[92:95], v[48:63]
    v_max_u32 v8, v8, v9
    v_cmp_eq_u32 s[82:83], -1, v8
    v_mfma_f32_32x32x16_bf16 v[16:31], v[184:187], v[92:95], v[16:31]
g_pn3:
    s_cmp_lg_u64 s[80:81], 0
    s_cbranch_scc1 g_pb4
    v_mfma_f32_32x32x16_bf16 v[48:63], v[196:199], v[96:99], v[48:63]
    v_mfma_f32_32x32x16_bf16 v[16:31], v[192:195], v[96:99], v[16:31]
    s_waitcnt vmcnt(2)
    v_max3_u32 v8, v112, v113, v114
    v_max3_u32 v9, v115, v116, v117
    v_max3_u32 v8, v8, v118, v119
    v_mfma_f32_32x32x16_bf16 v[48:63], v[204:207], v[100:103], v[48:63]
    v_max_u32 v8, v8, v9
    v_cmp_eq_u32 s[84:85], -1, v8
    v_mfma_f32_32x32x16_bf16 v[16:31], v[200:203], v[100:103], v[16:31]
g_pn4:
    s_cmp_lg_u64 s[82:83], 0
    s_cbranch_scc1 g_pb5
    v_mfma_f32_32x32x16_bf16 v[48:63], v[212:215], v[104:107], v[48:63]
    v_mfma_f32_32x32x16_bf16 v[16:31], v[208:211], v[104:107], v[16:31]
    s_waitcnt vmcnt(0)
    v_max3_u32 v8, v120, v121, v122
    v_max3_u32 v9, v123, v124, v125
    v_max3_u32 v8, v8, v126, v127
    v_mfma_f32_32x32x16_bf16 v[48:63], v[220:223], v[108:111], v[48:63]
    v_max_u32 v8, v8, v9
    v_cmp_eq_u32 s[86:87], -1, v8
    v_mfma_f32_32x32x16_bf16 v[16:31], v[216:219], v[108:111], v[16:31]
g_pn5:
    s_cmp_lg_u64 s[84:85], 0
    s_cbranch_scc1 g_pb6
    v_mfma_f32_32x32x16_bf16 v[48:63], v[228:231], v[112:115], v[48:63]
    v_mfma_f32_32x32x16_bf16 v[16:31], v[224:227], v[112:115], v[16:31]
    v_mfma_f32_32x32x16_bf16 v[48:63], v[236:239], v[116:119], v[48:63]
    v_mfma_f32_32x32x16_bf16 v[16:31], v[232:235], v[116:119], v[16:31]
g_pn6:
    s_cmp_lg_u64 s[86:87], 0
    s_cbranch_scc1 g_pb7
    v_mfma_f32_32x32x16_bf16 v[48:63], v[244:247], v[120:123], v[48:63]
    v_mfma_f32_32x32x16_bf16 v[16:31], v[240:243], v[120:123], v[16:31]
    v_mfma_f32_32x32x16_bf16 v[48:63], v[252:255], v[124:127], v[48:63]
    v_mfma_f32_32x32x16_bf16 v[16:31], v[248:251], v[124:127], v[16:31]
g_pn7:
    s_cmp_eq_u32 s37, 0
    s_cbranch_scc1 g_odone
g_oround:
    s_bitcmp1_b32 s37, 0
    s_cbranch_scc0 g_ol0
    buffer_load_dwordx4 v[64:67], v3, s[12:15], s44 offen offset:0 sc0 sc1
    buffer_load_dwordx4 v[68:71], v3, s[12:15], s44 offen offset:1024 sc0 sc1
g_ol0:
    s_bitcmp1_b32 s37, 1
    s_cbranch_scc0 g_ol1
    buffer_load_dwordx4 v[72:75], v3, s[12:15], s45 offen offset:0 sc0 sc1
    buffer_load_dwordx4 v[76:79], v3, s[12:15], s45 offen offset:1024 sc0 sc1
g_ol1:
    s_bitcmp1_b32 s37, 2
    s_cbranch_scc0 g_ol2
    buffer_load_dwordx4 v[80:83], v3, s[12:15], s46 offen offset:0 sc0 sc1
    buffer_load_dwordx4 v[84:87], v3, s[12:15], s46 offen offset:1024 sc0 sc1
g_ol2:
    s_bitcmp1_b32 s37, 3
    s_cbranch_scc0 g_ol3
    buffer_load_dwordx4 v[88:91], v3, s[12:15], s47 offen offset:0 sc0 sc1
    buffer_load_dwordx4 v[92:95], v3, s[12:15], s47 offen offset:1024 sc0 sc1
g_ol3:
    s_bitcmp1_b32 s37, 4
    s_cbranch_scc0 g_ol4
    buffer_load_dwordx4 v[96:99], v3, s[12:15], s50 offen offset:0 sc0 sc1
    buffer_load_dwordx4 v[100:103], v3, s[12:15], s50 offen offset:1024 sc0 sc1
g_ol4:
    s_bitcmp1_b32 s37, 5
    s_cbranch_scc0 g_ol5
    buffer_load_dwordx4 v[104:107], v3, s[12:15], s51 offen offset:0 sc0 sc1
    buffer_load_dwordx4 v[108:111], v3, s[12:15], s51 offen offset:1024 sc0 sc1
g_ol5:
    s_bitcmp1_b32 s37, 6
    s_cbranch_scc0 g_ol6
    buffer_load_dwordx4 v[112:115], v3, s[12:15], s52 offen offset:0 sc0 sc1
    buffer_load_dwordx4 v[116:119], v3, s[12:15], s52 offen offset:1024 sc0 sc1
g_ol6:
    s_bitcmp1_b32 s37, 7
    s_cbranch_scc0 g_ol7
    buffer_load_dwordx4 v[120:123], v3, s[12:15], s53 offen offset:0 sc0 sc1
    buffer_load_dwordx4 v[124:127], v3, s[12:15], s53 offen offset:1024 sc0 sc1
g_ol7:
    s_add_u32 s96, s96, 1
    s_waitcnt vmcnt(0)
    s_bitcmp1_b32 s37, 0
    s_cbranch_scc0 g_onext0
    v_max3_u32 v8, v64, v65, v66
    v_max3_u32 v9, v67, v68, v69
    v_max3_u32 v8, v8, v70, v71
    v_max_u32 v8, v8, v9
    v_cmp_eq_u32 vcc, -1, v8
    s_nop 4
    s_cbranch_vccnz g_onext0
    v_mfma_f32_32x32x16_bf16 v[48:63], v[132:135], v[64:67], v[48:63]
    v_mfma_f32_32x32x16_bf16 v[16:31], v[128:131], v[64:67], v[16:31]
    v_mfma_f32_32x32x16_bf16 v[48:63], v[140:143], v[68:71], v[48:63]
    v_mfma_f32_32x32x16_bf16 v[16:31], v[136:139], v[68:71], v[16:31]
    s_bitset0_b32 s37, 0
g_onext0:
    s_bitcmp1_b32 s37, 1
    s_cbranch_scc0 g_onext1
    v_max3_u32 v8, v72, v73, v74
    v_max3_u32 v9, v75, v76, v77
    v_max3_u32 v8, v8, v78, v79
    v_max_u32 v8, v8, v9
    v_cmp_eq_u32 vcc, -1, v8
    s_nop 4
    s_cbranch_vccnz g_onext1
    v_mfma_f32_32x32x16_bf16 v[48:63], v[148:151], v[72:75], v[48:63]
    v_mfma_f32_32x32x16_bf16 v[16:31], v[144:147], v[72:75], v[16:31]
    v_mfma_f32_32x32x16_bf16 v[48:63], v[156:159], v[76:79], v[48:63]
    v_mfma_f32_32x32x16_bf16 v[16:31], v[152:155], v[76:79], v[16:31]
    s_bitset0_b32 s37, 1
g_onext1:
    s_bitcmp1_b32 s37, 2
    s_cbranch_scc0 g_onext2
    v_max3_u32 v8, v80, v81, v82
    v_max3_u32 v9, v83, v84, v85
    v_max3_u32 v8, v8, v86, v87
    v_max_u32 v8, v8, v9
    v_cmp_eq_u32 vcc, -1, v8
    s_nop 4
    s_cbranch_vccnz g_onext2
    v_mfma_f32_32x32x16_bf16 v[48:63], v[164:167], v[80:83], v[48:63]
    v_mfma_f32_32x32x16_bf16 v[16:31], v[160:163], v[80:83], v[16:31]
    v_mfma_f32_32x32x16_bf16 v[48:63], v[172:175], v[84:87], v[48:63]
    v_mfma_f32_32x32x16_bf16 v[16:31], v[168:171], v[84:87], v[16:31]
    s_bitset0_b32 s37, 2
g_onext2:
    s_bitcmp1_b32 s37, 3
    s_cbranch_scc0 g_onext3
    v_max3_u32 v8, v88, v89, v90
    v_max3_u32 v9, v91, v92, v93
    v_max3_u32 v8, v8, v94, v95
    v_max_u32 v8, v8, v9
    v_cmp_eq_u32 vcc, -1, v8
    s_nop 4
    s_cbranch_vccnz g_onext3
    v_mfma_f32_32x32x16_bf16 v[48:63], v[180:183], v[88:91], v[48:63]
    v_mfma_f32_32x32x16_bf16 v[16:31], v[176:179], v[88:91], v[16:31]
    v_mfma_f32_32x32x16_bf16 v[48:63], v[188:191], v[92:95], v[48:63]
    v_mfma_f32_32x32x16_bf16 v[16:31], v[184:187], v[92:95], v[16:31]
    s_bitset0_b32 s37, 3
g_onext3:
    s_bitcmp1_b32 s37, 4
    s_cbranch_scc0 g_onext4
    v_max3_u32 v8, v96, v97, v98
    v_max3_u32 v9, v99, v100, v101
    v_max3_u32 v8, v8, v102, v103
    v_max_u32 v8, v8, v9
    v_cmp_eq_u32 vcc, -1, v8
    s_nop 4
    s_cbranch_vccnz g_onext4
    v_mfma_f32_32x32x16_bf16 v[48:63], v[196:199], v[96:99], v[48:63]
    v_mfma_f32_32x32x16_bf16 v[16:31], v[192:195], v[96:99], v[16:31]
    v_mfma_f32_32x32x16_bf16 v[48:63], v[204:207], v[100:103], v[48:63]
    v_mfma_f32_32x32x16_bf16 v[16:31], v[200:203], v[100:103], v[16:31]
    s_bitset0_b32 s37, 4
g_onext4:
    s_bitcmp1_b32 s37, 5
    s_cbranch_scc0 g_onext5
    v_max3_u32 v8, v104, v105, v106
    v_max3_u32 v9, v107, v108, v109
    v_max3_u32 v8, v8, v110, v111
    v_max_u32 v8, v8, v9
    v_cmp_eq_u32 vcc, -1, v8
    s_nop 4
    s_cbranch_vccnz g_onext5
    v_mfma_f32_32x32x16_bf16 v[48:63], v[212:215], v[104:107], v[48:63]
    v_mfma_f32_32x32x16_bf16 v[16:31], v[208:211], v[104:107], v[16:31]
    v_mfma_f32_32x32x16_bf16 v[48:63], v[220:223], v[108:111], v[48:63]
    v_mfma_f32_32x32x16_bf16 v[16:31], v[216:219], v[108:111], v[16:31]
    s_bitset0_b32 s37, 5
g_onext5:
    s_bitcmp1_b32 s37, 6
    s_cbranch_scc0 g_onext6
    v_max3_u32 v8, v112, v113, v114
    v_max3_u32 v9, v115, v116, v117
    v_max3_u32 v8, v8, v118, v119
    v_max_u32 v8, v8, v9
    v_cmp_eq_u32 vcc, -1, v8
    s_nop 4
    s_cbranch_vccnz g_onext6
    v_mfma_f32_32x32x16_bf16 v[48:63], v[228:231], v[112:115], v[48:63]
    v_mfma_f32_32x32x16_bf16 v[16:31], v[224:227], v[112:115], v[16:31]
    v_mfma_f32_32x32x16_bf16 v[48:63], v[236:239], v[116:119], v[48:63]
    v_mfma_f32_32x32x16_bf16 v[16:31], v[232:235], v[116:119], v[16:31]
    s_bitset0_b32 s37, 6
g_onext6:
    s_bitcmp1_b32 s37, 7
    s_cbranch_scc0 g_onext7
    v_max3_u32 v8, v120, v121, v122
    v_max3_u32 v9, v123, v124, v125
    v_max3_u32 v8, v8, v126, v127
    v_max_u32 v8, v8, v9
    v_cmp_eq_u32 vcc, -1, v8
    s_nop 4
    s_cbranch_vccnz g_onext7
    v_mfma_f32_32x32x16_bf16 v[48:63], v[244:247], v[120:123], v[48:63]
    v_mfma_f32_32x32x16_bf16 v[16:31], v[240:243], v[120:123], v[16:31]
    v_mfma_f32_32x32x16_bf16 v[48:63], v[252:255], v[124:127], v[48:63]
    v_mfma_f32_32x32x16_bf16 v[16:31], v[248:251], v[124:127], v[16:31]
    s_bitset0_b32 s37, 7
g_onext7:
    s_cmp_eq_u32 s37, 0
    s_cbranch_scc1 g_odone
    s_cmp_lt_u32 s96, 32768
    s_cbranch_scc1 g_oround
    s_branch g_odone
g_pb0:
    s_bitset1_b32 s37, 0
    s_waitcnt vmcnt(10)
    v_max3_u32 v8, v80, v81, v82
    v_max3_u32 v9, v83, v84, v85
    v_max3_u32 v8, v8, v86, v87
    v_max_u32 v8, v8, v9
    v_cmp_eq_u32 s[84:85], -1, v8
    s_nop 3
    s_branch g_pn0
g_pb1:
    s_bitset1_b32 s37, 1
    s_waitcnt vmcnt(8)
    v_max3_u32 v8, v88, v89, v90
    v_max3_u32 v9, v91, v92, v93
    v_max3_u32 v8, v8, v94, v95
    v_max_u32 v8, v8, v9
    v_cmp_eq_u32 s[86:87], -1, v8
    s_nop 3
    s_branch g_pn1
g_pb2:
    s_bitset1_b32 s37, 2
    s_waitcnt vmcnt(6)
    v_max3_u32 v8, v96, v97, v98
    v_max3_u32 v9, v99, v100, v101
    v_max3_u32 v8, v8, v102, v103
    v_max_u32 v8, v8, v9
    v_cmp_eq_u32 s[80:81], -1, v8
    s_nop 3
    s_branch g_pn2
g_pb3:
    s_bitset1_b32 s37, 3
    s_waitcnt vmcnt(4)
    v_max3_u32 v8, v104, v105, v106
    v_max3_u32 v9, v107, v108, v109
    v_max3_u32 v8, v8, v110, v111
    v_max_u32 v8, v8, v9
    v_cmp_eq_u32 s[82:83], -1, v8
    s_nop 3
    s_branch g_pn3
g_pb4:
    s_bitset1_b32 s37, 4
    s_waitcnt vmcnt(2)
    v_max3_u32 v8, v112, v113, v114
    v_max3_u32 v9, v115, v116, v117
    v_max3_u32 v8, v8, v118, v119
    v_max_u32 v8, v8, v9
    v_cmp_eq_u32 s[84:85], -1, v8
    s_nop 3
    s_branch g_pn4
g_pb5:
    s_bitset1_b32 s37, 5
    s_waitcnt vmcnt(0)
    v_max3_u32 v8, v120, v121, v122
    v_max3_u32 v9, v123, v124, v125
    v_max3_u32 v8, v8, v126, v127
    v_max_u32 v8, v8, v9
    v_cmp_eq_u32 s[86:87], -1, v8
    s_nop 3
    s_branch g_pn5
g_pb6:
    s_bitset1_b32 s37, 6
    s_branch g_pn6
g_pb7:
    s_bitset1_b32 s37, 7
    s_branch g_pn7
g_odone:
    s_nop 8
    ds_write_b128 v2, v[48:51] offset:0
    ds_write_b128 v2, v[52:55] offset:1024
    ds_write_b128 v2, v[56:59] offset:2048
    ds_write_b128 v2, v[60:63] offset:3072
    ds_write_b32 v13, v12
    s_mov_b32 s97, 0
    ds_read_b32 v9, v4
    ds_read_b128 v[32:35], v7 offset:0
    ds_read_b128 v[36:39], v7 offset:1024
    ds_read_b128 v[40:43], v7 offset:2048
    ds_read_b128 v[44:47], v7 offset:3072
    v_pk_mul_f32 v[16:17], v[16:17], v[10:11]
    v_pk_mul_f32 v[18:19], v[18:19], v[10:11]
    v_pk_mul_f32 v[20:21], v[20:21], v[10:11]
    v_pk_mul_f32 v[22:23], v[22:23], v[10:11]
    v_pk_mul_f32 v[24:25], v[24:25], v[10:11]
    v_pk_mul_f32 v[26:27], v[26:27], v[10:11]
    v_pk_mul_f32 v[28:29], v[28:29], v[10:11]
    v_pk_mul_f32 v[30:31], v[30:31], v[10:11]
g_x3:
    s_waitcnt lgkmcnt(4)
    v_readfirstlane_b32 s20, v9
    s_add_u32 s97, s97, 1
    s_cmp_gt_u32 s97, 262144
    s_cbranch_scc1 g_x3ok
    s_cmp_ge_u32 s20, 3
    s_cbranch_scc1 g_x3ok
    s_waitcnt lgkmcnt(0)
    ds_read_b32 v9, v4
    ds_read_b128 v[32:35], v7 offset:0
    ds_read_b128 v[36:39], v7 offset:1024
    ds_read_b128 v[40:43], v7 offset:2048
    ds_read_b128 v[44:47], v7 offset:3072
    s_branch g_x3
g_x3ok:
    s_waitcnt lgkmcnt(3)
    v_pk_fma_f32 v[16:17], v[32:33], v[10:11], v[16:17]
    v_pk_fma_f32 v[18:19], v[34:35], v[10:11], v[18:19]
    s_waitcnt lgkmcnt(2)
    v_pk_fma_f32 v[20:21], v[36:37], v[10:11], v[20:21]
    v_pk_fma_f32 v[22:23], v[38:39], v[10:11], v[22:23]
    s_waitcnt lgkmcnt(1)
    v_pk_fma_f32 v[24:25], v[40:41], v[10:11], v[24:25]
    v_pk_fma_f32 v[26:27], v[42:43], v[10:11], v[26:27]
    s_waitcnt lgkmcnt(0)
    v_pk_fma_f32 v[28:29], v[44:45], v[10:11], v[28:29]
    v_pk_fma_f32 v[30:31], v[46:47], v[10:11], v[30:31]
    v_cvt_pk_bf16_f32 v64, v16, v17
    v_cvt_pk_bf16_f32 v65, v18, v19
    v_cvt_pk_bf16_f32 v66, v20, v21
    v_cvt_pk_bf16_f32 v67, v22, v23
    v_cvt_pk_bf16_f32 v68, v24, v25
    v_cvt_pk_bf16_f32 v69, v26, v27
    v_cvt_pk_bf16_f32 v70, v28, v29
    v_cvt_pk_bf16_f32 v71, v30, v31
    s_nop 0
    v_permlane32_swap_b32 v64, v66
    v_permlane32_swap_b32 v65, v67
    v_permlane32_swap_b32 v68, v70
    v_permlane32_swap_b32 v69, v71
    s_nop 1
    buffer_store_dwordx4 v[64:67], v5, s[24:27], s49 offen
    buffer_store_dwordx4 v[68:71], v5, s[24:27], s49 offen offset:32
    s_endpgm
k_exit:
    s_endpgm
.section .rodata,"a"
.p2align 6
.amdhsa_kernel gated_mix__mha_block__dense_activation_squared_relu__prompt_kernel
  .amdhsa_next_free_vgpr 256
  .amdhsa_next_free_sgpr 102
  .amdhsa_accum_offset 256
  .amdhsa_group_segment_fixed_size 0
  .amdhsa_kernarg_size 96
  .amdhsa_user_sgpr_count 2
  .amdhsa_user_sgpr_kernarg_segment_ptr 1
  .amdhsa_system_sgpr_workgroup_id_x 1
.end_amdhsa_kernel
```
